```python
import torch

def _softmax(x, axis=-1):
    return torch.softmax(x, dim=axis)
def _gelu(x):
    return torch.nn.functional.gelu(x, approximate="tanh")
def _silu(x):
    return torch.nn.functional.silu(x)
def _sigmoid(x):
    return torch.sigmoid(x)
def _layernorm(x, axis=-1, eps=1e-5):
    m = x.mean(dim=axis, keepdim=True)
    v = x.var(dim=axis, keepdim=True, unbiased=False)
    return (x - m) / torch.sqrt(v + eps)
def _scatter_add(tgt, idx, src, axis=0):
    return tgt.clone().index_add_(axis, idx, src)
def _segment_sum(src, seg, n):
    out = torch.zeros((n,) + src.shape[1:], dtype=src.dtype)
    return out.index_add_(0, seg, src)
def _pad(x, pw):
    flat = tuple(v for pair in reversed(pw) for v in pair)
    return torch.nn.functional.pad(x, flat)

kernel_name = 'parallel_sum__linear_kernel_hedgehog__glu_gated_glu__prompt'

def setup_inputs():

    _w = (lambda a: (lambda t: t.to(torch.bfloat16) if t.is_floating_point() else t)(torch.as_tensor(a)))
    def _A_setup():
        B, S, D, H = 1, 2048, 640, 32
        Dh = D // H
        return {
            "x": _w((lambda *s: torch.randn(*s, dtype=torch.bfloat16) * 0.05)(B, S, D)),
            "wqkv": _w((lambda *s: torch.randn(*s, dtype=torch.bfloat16) * 0.4)(D, 3 * D)),
            "w_phi": _w((lambda *s: torch.randn(*s, dtype=torch.bfloat16) * 0.4)(H, Dh, Dh) * (Dh ** -0.5)),
            "wo": _w((lambda *s: torch.randn(*s, dtype=torch.bfloat16) * 0.1)(D, D)),
        }
    _A_in = _A_setup()

    def _B_setup():
        B, S, D, F = 1, 2048, 640, 1536
        return {
            "x": _w((lambda *s: torch.randn(*s, dtype=torch.bfloat16) * 0.05)(B, S, D)),
            "w_gate": _w((lambda *s: torch.randn(*s, dtype=torch.bfloat16) * 0.05)(D, F)),
            "w_up": _w((lambda *s: torch.randn(*s, dtype=torch.bfloat16) * 0.05)(D, F)),
            "w_down": _w((lambda *s: torch.randn(*s, dtype=torch.bfloat16) * 0.05)(F, D)),
        }
    _B_in = _B_setup()

    return {
        "A_x": _A_in["x"],
        "A_wqkv": _A_in["wqkv"],
        "A_w_phi": _A_in["w_phi"],
        "A_wo": _A_in["wo"],
        "B_x": _B_in["x"],
        "B_w_gate": _B_in["w_gate"],
        "B_w_up": _B_in["w_up"],
        "B_w_down": _B_in["w_down"],
    }

def reference(A_x, A_wqkv, A_w_phi, A_wo, B_x, B_w_gate, B_w_up, B_w_down):
    def _A_ref(x, wqkv, w_phi, wo):
        B, S, D = x.shape
        H = 32; Dh = D // H
        qkv = (lambda x, *d: x.permute(*d))((x @ wqkv).reshape(B, S, 3, H, Dh), 2, 0, 3, 1, 4)
        q, k, v = qkv[0], qkv[1], qkv[2]
        pq = torch.einsum("bhsd,hdf->bhsf", q, w_phi)
        pk = torch.einsum("bhsd,hdf->bhsf", k, w_phi)
        phi_q = torch.concatenate([_softmax(pq, axis=-1), _softmax(-pq, axis=-1)], axis=-1)
        phi_k = torch.concatenate([_softmax(pk, axis=-1), _softmax(-pk, axis=-1)], axis=-1)
        kv = torch.einsum("bhsf,bhsd->bhfd", phi_k, v)
        z  = torch.einsum("bhsf->bhf", phi_k)
        num = torch.einsum("bhqf,bhfd->bhqd", phi_q, kv)
        den = torch.einsum("bhqf,bhf->bhq", phi_q, z)[..., None] + 1e-6
        o = num / den
        return (lambda x, *d: x.permute(*d))(o, 0, 2, 1, 3).reshape(B, S, D) @ wo

    def _B_ref(x, w_gate, w_up, w_down):
        g = torch.einsum("bsd,df->bsf", x, w_gate)
        u = torch.einsum("bsd,df->bsf", x, w_up)
        h = _sigmoid(g) * u
        return torch.einsum("bsf,fd->bsd", h, w_down)

    x = A_x
    xn = _layernorm(x, axis=-1)
    return x + _A_ref(xn, A_wqkv, A_w_phi, A_wo) + _B_ref(xn, B_w_gate, B_w_up, B_w_down)
```

```asm
; @launch grid=(256,1,1) block=(768,1,1) lds=163840
.amdgcn_target "amdgcn-amd-amdhsa--gfx950"
.text
.globl parallel_sum__linear_kernel_hedgehog__glu_gated_glu__prompt_kernel
.p2align 8
.type parallel_sum__linear_kernel_hedgehog__glu_gated_glu__prompt_kernel,@function
parallel_sum__linear_kernel_hedgehog__glu_gated_glu__prompt_kernel:
    s_cmp_ge_u32 s2, 256
    s_cbranch_scc1 K1_done
    s_load_dwordx8 s[4:11], s[0:1], 0
    s_load_dwordx4 s[12:15], s[0:1], 40
    s_load_dwordx8 s[16:23], s[0:1], 56
    s_getpc_b64 s[62:63]
K1_pc:
    v_lshrrev_b32 v2, 6, v0
    s_and_b32 s42, s2, 1
    s_bfe_u32 s43, s2, 0x20001
    v_readfirstlane_b32 s40, v2
    s_lshr_b32 s44, s2, 3
    s_lshl_b32 s41, s42, 7
    s_lshl_b32 s50, s43, 5
    s_add_u32 s41, s41, s50
    s_add_u32 s41, s41, s44
    v_and_b32 v1, 63, v0
    s_mov_b32 s26, 2621440
    s_mov_b32 s27, 0x20000
    s_mov_b32 s31, 0x20000
    s_sub_u32 s48, s40, 8
    s_cmp_lt_u32 s44, 16
    s_cbranch_scc0 K1_dec_mlp
    s_and_b32 s50, s44, 3
    s_lshl2_add_u32 s45, s42, s50
    s_lshr_b32 s52, s44, 3
    s_xor_b32 s52, s52, s43
    s_andn2_b32 s52, 1, s52
    s_bfe_u32 s51, s44, 0x10002
    s_lshl1_add_u32 s51, s51, s52
    s_lshl2_add_u32 s46, s43, s51
    s_add_u32 s47, s50, s51
    s_cmp_ge_u32 s40, 8
    s_cbranch_scc0 K1_attn_comp
K1_attn_ld:
    s_setprio 3
    s_mov_b64 s[56:57], s[62:63]
    v_lshrrev_b32 v10, 3, v1
    v_lshrrev_b32 v11, 4, v1
    v_and_b32 v12, 7, v1
    v_xor_b32 v12, v12, v11
    s_movk_i32 s53, 1280
    v_mul_u32_u24 v10, s53, v10
    v_lshl_add_u32 v2, v12, 4, v10
    v_xor_b32 v3, 64, v2
    v_add_u32 v3, 9216, v3
    v_add_u32 v4, 18432, v2
    v_add_u32 v5, 18432, v3
    s_lshl_b32 s50, s45, 8
    s_lshl_b32 s51, s48, 6
    s_add_u32 s50, s50, s51
    s_mul_i32 s49, s50, 1280
    s_mul_i32 s60, s48, 24576
    s_lshl_b32 s61, s48, 12
    s_add_u32 s61, s61, 98304
    s_mov_b32 s62, s47
    s_sub_u32 s50, s62, 3
    s_cmp_ge_u32 s62, 3
    s_cselect_b32 s62, s50, s62
    s_sub_u32 s50, s62, 3
    s_cmp_ge_u32 s62, 3
    s_cselect_b32 s62, s50, s62
    s_waitcnt lgkmcnt(0)
    s_mov_b32 s24, s4
    s_mov_b32 s25, s5
    s_lshl_b32 s53, s62, 7
    s_add_u32 s53, s53, s49
    s_add_u32 m0, s60, 0
    s_nop 0
    buffer_load_dwordx4 v2, s[24:27], s53 offen offset:0  lds
    buffer_load_dwordx4 v3, s[24:27], s53 offen offset:1024  lds
    buffer_load_dwordx4 v4, s[24:27], s53 offen offset:2048  lds
    buffer_load_dwordx4 v5, s[24:27], s53 offen offset:3072  lds
    s_add_u32 m0, s60, 4096
    s_add_u32 s53, s53, 40960
    buffer_load_dwordx4 v2, s[24:27], s53 offen offset:0  lds
    buffer_load_dwordx4 v3, s[24:27], s53 offen offset:1024  lds
    buffer_load_dwordx4 v4, s[24:27], s53 offen offset:2048  lds
    buffer_load_dwordx4 v5, s[24:27], s53 offen offset:3072  lds
    v_lshlrev_b32 v12, 1, v11
    v_sub_u32 v12, v1, v12
    s_movk_i32 s53, 3840
    s_mul_i32 s50, s46, 80
    s_mul_i32 s51, s48, 61440
    s_add_u32 s50, s50, s51
    v_mul_u32_u24 v13, s53, v11
    v_add_u32 v13, s50, v13
    s_movk_i32 s51, 1200
    v_and_b32 v14, 15, v12
    v_min_u32 v14, 14, v14
    v_mul_u32_u24 v15, 52, v14
    v_lshrrev_b32 v15, 8, v15
    v_lshl_add_u32 v14, v14, 4, v13
    v_mad_u32_u24 v6, v15, s51, v14
    v_xor_b32 v12, 8, v12
    v_and_b32 v14, 15, v12
    v_min_u32 v14, 14, v14
    v_mul_u32_u24 v15, 52, v14
    v_lshrrev_b32 v15, 8, v15
    v_lshl_add_u32 v14, v14, 4, v13
    v_mad_u32_u24 v8, v15, s51, v14
    v_add_u32 v7, 14336, v6
    v_add_u32 v9, 43008, v8
    v_add_u32 v8, 28672, v8
    s_mov_b32 s30, 2457600
    s_mov_b32 s28, s6
    s_mov_b32 s29, s7
    s_add_u32 m0, s61, 0
    s_mul_i32 s52, s62, 245760
    buffer_load_dwordx4 v6, s[28:31], s52 offen offset:0  lds
    buffer_load_dwordx4 v7, s[28:31], s52 offen offset:1024  lds
    buffer_load_dwordx4 v8, s[28:31], s52 offen offset:2048  lds
    buffer_load_dwordx4 v9, s[28:31], s52 offen offset:3072  lds
    s_add_u32 s62, s62, 1
    s_cmp_eq_u32 s62, 3
    s_cselect_b32 s62, 0, s62
    s_add_u32 m0, s61, 16384
    s_mul_i32 s52, s62, 245760
    buffer_load_dwordx4 v6, s[28:31], s52 offen offset:0  lds
    buffer_load_dwordx4 v7, s[28:31], s52 offen offset:1024  lds
    buffer_load_dwordx4 v8, s[28:31], s52 offen offset:2048  lds
    buffer_load_dwordx4 v9, s[28:31], s52 offen offset:3072  lds
    s_waitcnt vmcnt(4)
    s_barrier
    s_lshl_b32 s53, s62, 7
    s_add_u32 s53, s53, s49
    s_add_u32 m0, s60, 8192
    s_nop 0
    buffer_load_dwordx4 v2, s[24:27], s53 offen offset:0  lds
    buffer_load_dwordx4 v3, s[24:27], s53 offen offset:1024  lds
    buffer_load_dwordx4 v4, s[24:27], s53 offen offset:2048  lds
    buffer_load_dwordx4 v5, s[24:27], s53 offen offset:3072  lds
    s_add_u32 m0, s60, 12288
    s_add_u32 s53, s53, 40960
    buffer_load_dwordx4 v2, s[24:27], s53 offen offset:0  lds
    buffer_load_dwordx4 v3, s[24:27], s53 offen offset:1024  lds
    buffer_load_dwordx4 v4, s[24:27], s53 offen offset:2048  lds
    buffer_load_dwordx4 v5, s[24:27], s53 offen offset:3072  lds
    s_add_u32 s62, s62, 1
    s_cmp_eq_u32 s62, 3
    s_cselect_b32 s62, 0, s62
    s_add_u32 m0, s61, 32768
    s_mul_i32 s52, s62, 245760
    buffer_load_dwordx4 v6, s[28:31], s52 offen offset:0  lds
    buffer_load_dwordx4 v7, s[28:31], s52 offen offset:1024  lds
    buffer_load_dwordx4 v8, s[28:31], s52 offen offset:2048  lds
    buffer_load_dwordx4 v9, s[28:31], s52 offen offset:3072  lds
    s_lshl_b32 s53, s62, 7
    s_add_u32 s53, s53, s49
    s_add_u32 m0, s60, 16384
    s_nop 0
    buffer_load_dwordx4 v2, s[24:27], s53 offen offset:0  lds
    buffer_load_dwordx4 v3, s[24:27], s53 offen offset:1024  lds
    buffer_load_dwordx4 v4, s[24:27], s53 offen offset:2048  lds
    buffer_load_dwordx4 v5, s[24:27], s53 offen offset:3072  lds
    s_add_u32 m0, s60, 20480
    s_add_u32 s53, s53, 40960
    buffer_load_dwordx4 v2, s[24:27], s53 offen offset:0  lds
    buffer_load_dwordx4 v3, s[24:27], s53 offen offset:1024  lds
    buffer_load_dwordx4 v4, s[24:27], s53 offen offset:2048  lds
    buffer_load_dwordx4 v5, s[24:27], s53 offen offset:3072  lds
    s_waitcnt vmcnt(12)
    s_barrier
    s_mov_b32 s62, s47
    s_sub_u32 s50, s62, 3
    s_cmp_ge_u32 s62, 3
    s_cselect_b32 s62, s50, s62
    s_sub_u32 s50, s62, 3
    s_cmp_ge_u32 s62, 3
    s_cselect_b32 s62, s50, s62
    s_add_u32 s62, s62, 3
    s_add_u32 m0, s61, 0
    s_mul_i32 s52, s62, 245760
    buffer_load_dwordx4 v6, s[28:31], s52 offen offset:0  lds
    buffer_load_dwordx4 v7, s[28:31], s52 offen offset:1024  lds
    buffer_load_dwordx4 v8, s[28:31], s52 offen offset:2048  lds
    buffer_load_dwordx4 v9, s[28:31], s52 offen offset:3072  lds
    s_lshl_b32 s53, s62, 7
    s_add_u32 s53, s53, s49
    s_add_u32 m0, s60, 0
    s_nop 0
    buffer_load_dwordx4 v2, s[24:27], s53 offen offset:0  lds
    buffer_load_dwordx4 v3, s[24:27], s53 offen offset:1024  lds
    buffer_load_dwordx4 v4, s[24:27], s53 offen offset:2048  lds
    buffer_load_dwordx4 v5, s[24:27], s53 offen offset:3072  lds
    s_add_u32 m0, s60, 4096
    s_add_u32 s53, s53, 40960
    buffer_load_dwordx4 v2, s[24:27], s53 offen offset:0  lds
    buffer_load_dwordx4 v3, s[24:27], s53 offen offset:1024  lds
    buffer_load_dwordx4 v4, s[24:27], s53 offen offset:2048  lds
    buffer_load_dwordx4 v5, s[24:27], s53 offen offset:3072  lds
    s_mov_b32 s24, s4
    s_mov_b32 s25, s5
    s_mov_b32 s32, s22
    s_mov_b32 s33, s23
    s_mov_b32 s36, s20
    s_mov_b32 s37, s21
    s_mov_b32 s34, 0x1000000
    s_mov_b32 s35, 0x20000
    s_mov_b32 s38, 256
    s_mov_b32 s39, 0x20000
    v_lshlrev_b32 v30, 2, v1
    v_lshlrev_b32 v29, 4, v1
    s_lshl3_add_u32 s50, s45, 4
    s_lshl_b64 s[54:55], 15, s50
    s_and_b32 s50, s46, 3
    s_lshl3_add_u32 s50, s43, s50
    s_bitset1_b32 s54, s50
    s_bitset1_b32 s55, s50
    s_mov_b64 s[54:55], -1
    s_lshl_b32 s59, s48, 9
    s_lshl_b32 s58, s45, 11
    s_add_u32 s58, s58, s59
    s_add_u32 s58, s58, 9437184
    s_add_u32 s59, s59, 159744
    v_add_u32 v27, s59, v29
    s_waitcnt vmcnt(12)
    s_barrier
    s_add_u32 s62, s62, 1
    s_cmp_eq_u32 s62, 6
    s_cselect_b32 s62, 3, s62
    s_add_u32 m0, s61, 16384
    s_mul_i32 s52, s62, 245760
    buffer_load_dwordx4 v6, s[28:31], s52 offen offset:0  lds
    buffer_load_dwordx4 v7, s[28:31], s52 offen offset:1024  lds
    buffer_load_dwordx4 v8, s[28:31], s52 offen offset:2048  lds
    buffer_load_dwordx4 v9, s[28:31], s52 offen offset:3072  lds
    s_lshl_b32 s53, s62, 7
    s_add_u32 s53, s53, s49
    s_add_u32 m0, s60, 8192
    s_nop 0
    buffer_load_dwordx4 v2, s[24:27], s53 offen offset:0  lds
    buffer_load_dwordx4 v3, s[24:27], s53 offen offset:1024  lds
    buffer_load_dwordx4 v4, s[24:27], s53 offen offset:2048  lds
    buffer_load_dwordx4 v5, s[24:27], s53 offen offset:3072  lds
    s_add_u32 m0, s60, 12288
    s_add_u32 s53, s53, 40960
    buffer_load_dwordx4 v2, s[24:27], s53 offen offset:0  lds
    buffer_load_dwordx4 v3, s[24:27], s53 offen offset:1024  lds
    buffer_load_dwordx4 v4, s[24:27], s53 offen offset:2048  lds
    buffer_load_dwordx4 v5, s[24:27], s53 offen offset:3072  lds
    s_waitcnt vmcnt(12)
    s_barrier
    s_add_u32 s62, s62, 1
    s_cmp_eq_u32 s62, 6
    s_cselect_b32 s62, 3, s62
    s_add_u32 m0, s61, 32768
    s_mul_i32 s52, s62, 245760
    buffer_load_dwordx4 v6, s[28:31], s52 offen offset:0  lds
    buffer_load_dwordx4 v7, s[28:31], s52 offen offset:1024  lds
    buffer_load_dwordx4 v8, s[28:31], s52 offen offset:2048  lds
    buffer_load_dwordx4 v9, s[28:31], s52 offen offset:3072  lds
    s_lshl_b32 s53, s62, 7
    s_add_u32 s53, s53, s49
    s_add_u32 m0, s60, 16384
    s_nop 0
    buffer_load_dwordx4 v2, s[24:27], s53 offen offset:0  lds
    buffer_load_dwordx4 v3, s[24:27], s53 offen offset:1024  lds
    buffer_load_dwordx4 v4, s[24:27], s53 offen offset:2048  lds
    buffer_load_dwordx4 v5, s[24:27], s53 offen offset:3072  lds
    s_add_u32 m0, s60, 20480
    s_add_u32 s53, s53, 40960
    buffer_load_dwordx4 v2, s[24:27], s53 offen offset:0  lds
    buffer_load_dwordx4 v3, s[24:27], s53 offen offset:1024  lds
    buffer_load_dwordx4 v4, s[24:27], s53 offen offset:2048  lds
    buffer_load_dwordx4 v5, s[24:27], s53 offen offset:3072  lds
    s_waitcnt vmcnt(12)
    s_barrier
    s_and_b32 s62, s47, 3
    s_add_u32 s62, s62, 6
    s_add_u32 m0, s61, 0
    s_mul_i32 s52, s62, 245760
    buffer_load_dwordx4 v6, s[28:31], s52 offen offset:0  lds
    buffer_load_dwordx4 v7, s[28:31], s52 offen offset:1024  lds
    buffer_load_dwordx4 v8, s[28:31], s52 offen offset:2048  lds
    buffer_load_dwordx4 v9, s[28:31], s52 offen offset:3072  lds
    s_lshl_b32 s53, s62, 7
    s_add_u32 s53, s53, s49
    s_add_u32 m0, s60, 0
    s_nop 0
    buffer_load_dwordx4 v2, s[24:27], s53 offen offset:0  lds
    buffer_load_dwordx4 v3, s[24:27], s53 offen offset:1024  lds
    buffer_load_dwordx4 v4, s[24:27], s53 offen offset:2048  lds
    buffer_load_dwordx4 v5, s[24:27], s53 offen offset:3072  lds
    s_add_u32 m0, s60, 4096
    s_add_u32 s53, s53, 40960
    buffer_load_dwordx4 v2, s[24:27], s53 offen offset:0  lds
    buffer_load_dwordx4 v3, s[24:27], s53 offen offset:1024  lds
    buffer_load_dwordx4 v4, s[24:27], s53 offen offset:2048  lds
    buffer_load_dwordx4 v5, s[24:27], s53 offen offset:3072  lds
    s_waitcnt vmcnt(12)
    s_barrier
    s_add_u32 s62, s62, 1
    s_cmp_eq_u32 s62, 10
    s_cselect_b32 s62, 6, s62
    s_add_u32 m0, s61, 16384
    s_mul_i32 s52, s62, 245760
    buffer_load_dwordx4 v6, s[28:31], s52 offen offset:0  lds
    buffer_load_dwordx4 v7, s[28:31], s52 offen offset:1024  lds
    buffer_load_dwordx4 v8, s[28:31], s52 offen offset:2048  lds
    buffer_load_dwordx4 v9, s[28:31], s52 offen offset:3072  lds
    s_lshl_b32 s53, s62, 7
    s_add_u32 s53, s53, s49
    s_add_u32 m0, s60, 8192
    s_nop 0
    buffer_load_dwordx4 v2, s[24:27], s53 offen offset:0  lds
    buffer_load_dwordx4 v3, s[24:27], s53 offen offset:1024  lds
    buffer_load_dwordx4 v4, s[24:27], s53 offen offset:2048  lds
    buffer_load_dwordx4 v5, s[24:27], s53 offen offset:3072  lds
    s_add_u32 m0, s60, 12288
    s_add_u32 s53, s53, 40960
    buffer_load_dwordx4 v2, s[24:27], s53 offen offset:0  lds
    buffer_load_dwordx4 v3, s[24:27], s53 offen offset:1024  lds
    buffer_load_dwordx4 v4, s[24:27], s53 offen offset:2048  lds
    buffer_load_dwordx4 v5, s[24:27], s53 offen offset:3072  lds
    s_waitcnt vmcnt(12)
    s_barrier
    buffer_load_dword v31, v30, s[36:39], 0 offen sc1
    s_add_u32 s62, s62, 1
    s_cmp_eq_u32 s62, 10
    s_cselect_b32 s62, 6, s62
    s_add_u32 m0, s61, 32768
    s_mul_i32 s52, s62, 245760
    buffer_load_dwordx4 v6, s[28:31], s52 offen offset:0  lds
    buffer_load_dwordx4 v7, s[28:31], s52 offen offset:1024  lds
    buffer_load_dwordx4 v8, s[28:31], s52 offen offset:2048  lds
    buffer_load_dwordx4 v9, s[28:31], s52 offen offset:3072  lds
    s_lshl_b32 s53, s62, 7
    s_add_u32 s53, s53, s49
    s_add_u32 m0, s60, 16384
    s_nop 0
    buffer_load_dwordx4 v2, s[24:27], s53 offen offset:0  lds
    buffer_load_dwordx4 v3, s[24:27], s53 offen offset:1024  lds
    buffer_load_dwordx4 v4, s[24:27], s53 offen offset:2048  lds
    buffer_load_dwordx4 v5, s[24:27], s53 offen offset:3072  lds
    s_add_u32 m0, s60, 20480
    s_add_u32 s53, s53, 40960
    buffer_load_dwordx4 v2, s[24:27], s53 offen offset:0  lds
    buffer_load_dwordx4 v3, s[24:27], s53 offen offset:1024  lds
    buffer_load_dwordx4 v4, s[24:27], s53 offen offset:2048  lds
    buffer_load_dwordx4 v5, s[24:27], s53 offen offset:3072  lds
    s_waitcnt vmcnt(13)
    s_barrier
    s_add_u32 s62, s62, 1
    s_cmp_eq_u32 s62, 10
    s_cselect_b32 s62, 6, s62
    s_add_u32 m0, s61, 0
    s_mul_i32 s52, s62, 245760
    buffer_load_dwordx4 v6, s[28:31], s52 offen offset:0  lds
    buffer_load_dwordx4 v7, s[28:31], s52 offen offset:1024  lds
    buffer_load_dwordx4 v8, s[28:31], s52 offen offset:2048  lds
    buffer_load_dwordx4 v9, s[28:31], s52 offen offset:3072  lds
    s_lshl_b32 s53, s62, 7
    s_add_u32 s53, s53, s49
    s_add_u32 m0, s60, 0
    s_nop 0
    buffer_load_dwordx4 v2, s[24:27], s53 offen offset:0  lds
    buffer_load_dwordx4 v3, s[24:27], s53 offen offset:1024  lds
    buffer_load_dwordx4 v4, s[24:27], s53 offen offset:2048  lds
    buffer_load_dwordx4 v5, s[24:27], s53 offen offset:3072  lds
    s_add_u32 m0, s60, 4096
    s_add_u32 s53, s53, 40960
    buffer_load_dwordx4 v2, s[24:27], s53 offen offset:0  lds
    buffer_load_dwordx4 v3, s[24:27], s53 offen offset:1024  lds
    buffer_load_dwordx4 v4, s[24:27], s53 offen offset:2048  lds
    buffer_load_dwordx4 v5, s[24:27], s53 offen offset:3072  lds
    s_waitcnt vmcnt(24)
    s_mov_b32 s51, 0
K1_pl_1:
    v_and_b32 v31, 0x01010101, v31
    s_mov_b32 s50, 0x01010101
    v_cmp_ne_u32 vcc, s50, v31
    s_add_u32 s51, s51, 1
    s_and_b64 vcc, vcc, s[54:55]
    s_cbranch_scc0 K1_ok_2
    s_cmp_ge_u32 s51, 65536
    s_cbranch_scc1 K1_ok_2
    s_sleep 16
    buffer_load_dword v31, v30, s[36:39], 0 offen sc1
    s_waitcnt vmcnt(0)
    s_branch K1_pl_1
K1_ok_2:
    s_mov_b32 exec_hi, 0
    buffer_load_dwordx4 v[48:51], v29, s[32:35], s58 offen sc1
    s_mov_b64 exec, -1
    s_waitcnt vmcnt(13)
    s_barrier
    s_waitcnt vmcnt(0)
    s_mov_b32 exec_hi, 0
    ds_write_b128 v27, v[48:51]
    s_mov_b64 exec, -1
    s_waitcnt lgkmcnt(0)
    s_barrier
    s_lshl2_add_u32 s50, s44, s48
    s_lshl_b32 s50, s50, 13
    v_lshlrev_b32 v12, 7, v1
    v_add_u32 v12, s50, v12
    v_add_u32 v13, 0x2000, v12
    s_and_b32 s52, s2, 7
    s_mov_b32 s51, 819200
    s_sub_u32 s53, s52, 6
    s_cmp_ge_u32 s52, 6
    s_cselect_b32 s52, s53, s52
    s_cmp_lt_u32 s52, 4
    s_cselect_b32 s28, s16, s10
    s_cselect_b32 s29, s17, s11
    s_cselect_b32 s30, 1966080, s51
    s_and_b32 s53, s52, 3
    s_lshl_b32 s53, s53, 19
    buffer_load_dword v16, v12, s[28:31], s53 offen
    s_add_u32 s52, s52, 1
    s_sub_u32 s53, s52, 6
    s_cmp_ge_u32 s52, 6
    s_cselect_b32 s52, s53, s52
    s_cmp_lt_u32 s52, 4
    s_cselect_b32 s28, s16, s10
    s_cselect_b32 s29, s17, s11
    s_cselect_b32 s30, 1966080, s51
    s_and_b32 s53, s52, 3
    s_lshl_b32 s53, s53, 19
    buffer_load_dword v16, v12, s[28:31], s53 offen
    s_add_u32 s52, s52, 1
    s_sub_u32 s53, s52, 6
    s_cmp_ge_u32 s52, 6
    s_cselect_b32 s52, s53, s52
    s_cmp_lt_u32 s52, 4
    s_cselect_b32 s28, s16, s10
    s_cselect_b32 s29, s17, s11
    s_cselect_b32 s30, 1966080, s51
    s_and_b32 s53, s52, 3
    s_lshl_b32 s53, s53, 19
    buffer_load_dword v16, v12, s[28:31], s53 offen
    s_add_u32 s52, s52, 1
    s_sub_u32 s53, s52, 6
    s_cmp_ge_u32 s52, 6
    s_cselect_b32 s52, s53, s52
    s_cmp_lt_u32 s52, 4
    s_cselect_b32 s28, s16, s10
    s_cselect_b32 s29, s17, s11
    s_cselect_b32 s30, 1966080, s51
    s_and_b32 s53, s52, 3
    s_lshl_b32 s53, s53, 19
    buffer_load_dword v16, v12, s[28:31], s53 offen
    s_add_u32 s52, s52, 1
    s_barrier
    s_sub_u32 s53, s52, 6
    s_cmp_ge_u32 s52, 6
    s_cselect_b32 s52, s53, s52
    s_cmp_lt_u32 s52, 4
    s_cselect_b32 s28, s16, s10
    s_cselect_b32 s29, s17, s11
    s_cselect_b32 s30, 1966080, s51
    s_and_b32 s53, s52, 3
    s_lshl_b32 s53, s53, 19
    buffer_load_dword v16, v12, s[28:31], s53 offen
    s_add_u32 s52, s52, 1
    s_sub_u32 s53, s52, 6
    s_cmp_ge_u32 s52, 6
    s_cselect_b32 s52, s53, s52
    s_cmp_lt_u32 s52, 4
    s_cselect_b32 s28, s16, s10
    s_cselect_b32 s29, s17, s11
    s_cselect_b32 s30, 1966080, s51
    s_and_b32 s53, s52, 3
    s_lshl_b32 s53, s53, 19
    buffer_load_dword v16, v12, s[28:31], s53 offen
    s_add_u32 s52, s52, 1
    s_setprio 0
    s_barrier
    s_barrier
    s_barrier
    s_mov_b32 s63, 1
    s_branch P2_ld
K1_dec_mlp:
    s_and_b32 s47, s44, 7
    s_lshl3_add_u32 s45, s42, s47
    s_bfe_u32 s51, s44, 0x10003
    s_lshl1_add_u32 s46, s43, s51
    s_cmp_ge_u32 s40, 8
    s_cbranch_scc0 K1_mlp_comp
K1_mlp_ld:
    v_lshrrev_b32 v10, 3, v1
    v_lshrrev_b32 v11, 4, v1
    v_and_b32 v12, 7, v1
    v_xor_b32 v13, v12, v11
    s_movk_i32 s53, 1280
    s_lshl_b32 s50, s45, 7
    s_lshl4_add_u32 s50, s48, s50
    s_mul_i32 s50, s50, 1280
    v_mul_u32_u24 v14, s53, v10
    v_add_u32 v14, s50, v14
    v_lshl_add_u32 v4, v13, 4, v14
    v_xor_b32 v5, 64, v4
    v_add_u32 v5, 9216, v5
    v_and_b32 v13, 2, v10
    v_xor_b32 v13, v12, v13
    s_movk_i32 s53, 3072
    s_and_b32 s50, s48, 1
    s_mul_i32 s51, s50, 49152
    s_mul_i32 s52, s46, 384
    s_add_u32 s51, s51, s52
    v_mul_u32_u24 v14, s53, v10
    v_add_u32 v14, s51, v14
    v_lshl_add_u32 v2, v13, 4, v14
    v_xor_b32 v3, 64, v2
    v_add_u32 v3, 23552, v3
    s_lshr_b32 s49, s48, 1
    s_mul_i32 s60, s49, 12288
    s_lshl_b32 s50, s50, 11
    s_add_u32 s60, s60, s50
    s_lshl_b32 s61, s48, 11
    s_add_u32 s61, s61, 98304
    s_mov_b32 s30, 1966080
    s_cmp_eq_u32 s49, 0
    s_waitcnt lgkmcnt(0)
    s_cselect_b32 s28, s12, s14
    s_cselect_b32 s29, s13, s15
    s_mov_b32 s24, s4
    s_mov_b32 s25, s5
    s_mov_b32 s62, s47
    s_sub_u32 s50, s62, 3
    s_cmp_ge_u32 s62, 3
    s_cselect_b32 s62, s50, s62
    s_sub_u32 s50, s62, 3
    s_cmp_ge_u32 s62, 3
    s_cselect_b32 s62, s50, s62
    s_add_u32 m0, s61, 0
    s_lshl_b32 s53, s62, 7
    buffer_load_dwordx4 v4, s[24:27], s53 offen  lds
    buffer_load_dwordx4 v5, s[24:27], s53 offen offset:1024  lds
    s_add_u32 m0, s61, 8192
    s_lshl_b32 s53, s62, 7
    s_add_u32 s53, s53, 81920
    buffer_load_dwordx4 v4, s[24:27], s53 offen  lds
    buffer_load_dwordx4 v5, s[24:27], s53 offen offset:1024  lds
    s_mul_i32 s52, s62, 196608
    s_add_u32 m0, s60, 0
    s_nop 0
    buffer_load_dwordx4 v2, s[28:31], s52 offen  lds
    buffer_load_dwordx4 v3, s[28:31], s52 offen offset:1024  lds
    s_add_u32 m0, s60, 4096
    s_add_u32 s52, s52, 128
    buffer_load_dwordx4 v2, s[28:31], s52 offen  lds
    buffer_load_dwordx4 v3, s[28:31], s52 offen offset:1024  lds
    s_add_u32 m0, s60, 8192
    s_add_u32 s52, s52, 128
    buffer_load_dwordx4 v2, s[28:31], s52 offen  lds
    buffer_load_dwordx4 v3, s[28:31], s52 offen offset:1024  lds
    s_add_u32 s52, s52, 98048
    s_add_u32 m0, s60, 24576
    s_nop 0
    buffer_load_dwordx4 v2, s[28:31], s52 offen  lds
    buffer_load_dwordx4 v3, s[28:31], s52 offen offset:1024  lds
    s_add_u32 m0, s60, 28672
    s_add_u32 s52, s52, 128
    buffer_load_dwordx4 v2, s[28:31], s52 offen  lds
    buffer_load_dwordx4 v3, s[28:31], s52 offen offset:1024  lds
    s_add_u32 m0, s60, 32768
    s_add_u32 s52, s52, 128
    buffer_load_dwordx4 v2, s[28:31], s52 offen  lds
    buffer_load_dwordx4 v3, s[28:31], s52 offen offset:1024  lds
    s_add_u32 s62, s62, 1
    s_cmp_eq_u32 s62, 3
    s_cselect_b32 s62, 0, s62
    s_add_u32 m0, s61, 16384
    s_lshl_b32 s53, s62, 7
    buffer_load_dwordx4 v4, s[24:27], s53 offen  lds
    buffer_load_dwordx4 v5, s[24:27], s53 offen offset:1024  lds
    s_mov_b32 s24, s4
    s_mov_b32 s25, s5
    s_mov_b32 s32, s22
    s_mov_b32 s33, s23
    s_mov_b32 s36, s20
    s_mov_b32 s37, s21
    s_mov_b32 s34, 0x1000000
    s_mov_b32 s35, 0x20000
    s_mov_b32 s38, 256
    s_mov_b32 s39, 0x20000
    v_bfe_u32 v13, v1, 2, 2
    v_lshl_add_u32 v14, v11, 3, v13
    v_lshlrev_b32 v14, 7, v14
    v_and_b32 v15, 3, v1
    v_lshl_add_u32 v14, v15, 3, v14
    v_bfe_u32 v15, v1, 3, 2
    s_mul_i32 s50, s48, 3
    s_add_u32 s51, s50, 0
    s_and_b32 s53, s51, 3
    s_lshr_b32 s51, s51, 2
    s_lshl_b32 s51, s51, 12
    v_xor_b32 v16, s53, v15
    v_lshl_add_u32 v16, v16, 5, v14
    v_add_u32 v20, s51, v16
    v_add_u32 v23, 49152, v20
    s_add_u32 s51, s50, 1
    s_and_b32 s53, s51, 3
    s_lshr_b32 s51, s51, 2
    s_lshl_b32 s51, s51, 12
    v_xor_b32 v16, s53, v15
    v_lshl_add_u32 v16, v16, 5, v14
    v_add_u32 v21, s51, v16
    v_add_u32 v24, 49152, v21
    s_add_u32 s51, s50, 2
    s_and_b32 s53, s51, 3
    s_lshr_b32 s51, s51, 2
    s_lshl_b32 s51, s51, 12
    v_xor_b32 v16, s53, v15
    v_lshl_add_u32 v16, v16, 5, v14
    v_add_u32 v22, s51, v16
    v_add_u32 v25, 49152, v22
    v_mov_b32 v64, 0
    v_mov_b32 v65, 0
    v_mov_b32 v66, 0
    v_mov_b32 v67, 0
    v_mov_b32 v68, 0
    v_mov_b32 v69, 0
    v_mov_b32 v70, 0
    v_mov_b32 v71, 0
    v_mov_b32 v72, 0
    v_mov_b32 v73, 0
    v_mov_b32 v74, 0
    v_mov_b32 v75, 0
    v_mov_b32 v76, 0
    v_mov_b32 v77, 0
    v_mov_b32 v78, 0
    v_mov_b32 v79, 0
    v_mov_b32 v80, 0
    v_mov_b32 v81, 0
    v_mov_b32 v82, 0
    v_mov_b32 v83, 0
    v_mov_b32 v84, 0
    v_mov_b32 v85, 0
    v_mov_b32 v86, 0
    v_mov_b32 v87, 0
    v_mov_b32 v112, 0x3f803f80
    v_mov_b32 v113, 0x3f803f80
    v_mov_b32 v114, 0x3f803f80
    v_mov_b32 v115, 0x3f803f80
    v_lshlrev_b32 v30, 2, v1
    v_lshlrev_b32 v29, 4, v1
    s_mov_b64 s[54:55], -1
    s_lshl3_add_u32 s58, s42, s46
    s_mul_i32 s58, s58, 12288
    s_mul_i32 s59, s48, 384
    s_add_u32 s58, s58, s59
    s_add_u32 s49, s58, 9502720
    s_add_u32 s59, s59, 147456
    v_add_u32 v28, s59, v29
    s_lshl_b32 s57, s48, 8
    s_lshl_b32 s56, s45, 10
    s_add_u32 s56, s56, s57
    s_add_u32 s56, s56, 9437184
    s_add_u32 s57, s57, 159744
    v_add_u32 v27, s57, v29
    v_lshlrev_b32 v26, 4, v11
    s_waitcnt vmcnt(8)
    s_barrier
    s_setprio 3
    s_add_u32 m0, s61, 24576
    s_lshl_b32 s53, s62, 7
    s_add_u32 s53, s53, 81920
    buffer_load_dwordx4 v4, s[24:27], s53 offen  lds
    buffer_load_dwordx4 v5, s[24:27], s53 offen offset:1024  lds
    s_mul_i32 s52, s62, 196608
    s_add_u32 m0, s60, 49152
    s_nop 0
    buffer_load_dwordx4 v2, s[28:31], s52 offen  lds
    buffer_load_dwordx4 v3, s[28:31], s52 offen offset:1024  lds
    s_add_u32 m0, s60, 53248
    s_add_u32 s52, s52, 128
    buffer_load_dwordx4 v2, s[28:31], s52 offen  lds
    buffer_load_dwordx4 v3, s[28:31], s52 offen offset:1024  lds
    s_add_u32 m0, s60, 57344
    s_add_u32 s52, s52, 128
    buffer_load_dwordx4 v2, s[28:31], s52 offen  lds
    buffer_load_dwordx4 v3, s[28:31], s52 offen offset:1024  lds
    s_bitcmp1_b32 7, s47
    s_cbranch_scc0 K1_cs_3
    ds_read_b64_tr_b16 v[88:89], v20 offset:0
    ds_read_b64_tr_b16 v[90:91], v20 offset:512
    ds_read_b64_tr_b16 v[92:93], v20 offset:12288
    ds_read_b64_tr_b16 v[94:95], v20 offset:12800
    ds_read_b64_tr_b16 v[96:97], v21 offset:0
    ds_read_b64_tr_b16 v[98:99], v21 offset:512
    ds_read_b64_tr_b16 v[100:101], v21 offset:12288
    ds_read_b64_tr_b16 v[102:103], v21 offset:12800
    ds_read_b64_tr_b16 v[104:105], v22 offset:0
    ds_read_b64_tr_b16 v[106:107], v22 offset:512
    ds_read_b64_tr_b16 v[108:109], v22 offset:12288
    ds_read_b64_tr_b16 v[110:111], v22 offset:12800
    s_waitcnt lgkmcnt(10)
    v_mfma_f32_16x16x32_bf16 v[64:67], v[88:91], v[112:115], v[64:67]
    s_waitcnt lgkmcnt(8)
    v_mfma_f32_16x16x32_bf16 v[68:71], v[92:95], v[112:115], v[68:71]
    s_waitcnt lgkmcnt(6)
    v_mfma_f32_16x16x32_bf16 v[72:75], v[96:99], v[112:115], v[72:75]
    s_waitcnt lgkmcnt(4)
    v_mfma_f32_16x16x32_bf16 v[76:79], v[100:103], v[112:115], v[76:79]
    s_waitcnt lgkmcnt(2)
    v_mfma_f32_16x16x32_bf16 v[80:83], v[104:107], v[112:115], v[80:83]
    s_waitcnt lgkmcnt(0)
    v_mfma_f32_16x16x32_bf16 v[84:87], v[108:111], v[112:115], v[84:87]
K1_cs_3:
    s_waitcnt vmcnt(10)
    s_barrier
    s_add_u32 s52, s52, 98048
    s_add_u32 m0, s60, 73728
    s_nop 0
    buffer_load_dwordx4 v2, s[28:31], s52 offen  lds
    buffer_load_dwordx4 v3, s[28:31], s52 offen offset:1024  lds
    s_add_u32 m0, s60, 77824
    s_add_u32 s52, s52, 128
    buffer_load_dwordx4 v2, s[28:31], s52 offen  lds
    buffer_load_dwordx4 v3, s[28:31], s52 offen offset:1024  lds
    s_add_u32 m0, s60, 81920
    s_add_u32 s52, s52, 128
    buffer_load_dwordx4 v2, s[28:31], s52 offen  lds
    buffer_load_dwordx4 v3, s[28:31], s52 offen offset:1024  lds
    s_add_u32 s62, s62, 1
    s_cmp_eq_u32 s62, 3
    s_cselect_b32 s62, 0, s62
    s_add_u32 m0, s61, 32768
    s_lshl_b32 s53, s62, 7
    buffer_load_dwordx4 v4, s[24:27], s53 offen  lds
    buffer_load_dwordx4 v5, s[24:27], s53 offen offset:1024  lds
    s_add_u32 m0, s61, 40960
    s_lshl_b32 s53, s62, 7
    s_add_u32 s53, s53, 81920
    buffer_load_dwordx4 v4, s[24:27], s53 offen  lds
    buffer_load_dwordx4 v5, s[24:27], s53 offen offset:1024  lds
    s_mul_i32 s52, s62, 196608
    s_add_u32 m0, s60, 0
    s_nop 0
    buffer_load_dwordx4 v2, s[28:31], s52 offen  lds
    buffer_load_dwordx4 v3, s[28:31], s52 offen offset:1024  lds
    s_add_u32 m0, s60, 4096
    s_add_u32 s52, s52, 128
    buffer_load_dwordx4 v2, s[28:31], s52 offen  lds
    buffer_load_dwordx4 v3, s[28:31], s52 offen offset:1024  lds
    s_add_u32 m0, s60, 8192
    s_add_u32 s52, s52, 128
    buffer_load_dwordx4 v2, s[28:31], s52 offen  lds
    buffer_load_dwordx4 v3, s[28:31], s52 offen offset:1024  lds
    s_bitcmp1_b32 7, s47
    s_cbranch_scc0 K1_cs_4
    ds_read_b64_tr_b16 v[88:89], v20 offset:24576
    ds_read_b64_tr_b16 v[90:91], v20 offset:25088
    ds_read_b64_tr_b16 v[92:93], v20 offset:36864
    ds_read_b64_tr_b16 v[94:95], v20 offset:37376
    ds_read_b64_tr_b16 v[96:97], v21 offset:24576
    ds_read_b64_tr_b16 v[98:99], v21 offset:25088
    ds_read_b64_tr_b16 v[100:101], v21 offset:36864
    ds_read_b64_tr_b16 v[102:103], v21 offset:37376
    ds_read_b64_tr_b16 v[104:105], v22 offset:24576
    ds_read_b64_tr_b16 v[106:107], v22 offset:25088
    ds_read_b64_tr_b16 v[108:109], v22 offset:36864
    ds_read_b64_tr_b16 v[110:111], v22 offset:37376
    s_waitcnt lgkmcnt(10)
    v_mfma_f32_16x16x32_bf16 v[64:67], v[88:91], v[112:115], v[64:67]
    s_waitcnt lgkmcnt(8)
    v_mfma_f32_16x16x32_bf16 v[68:71], v[92:95], v[112:115], v[68:71]
    s_waitcnt lgkmcnt(6)
    v_mfma_f32_16x16x32_bf16 v[72:75], v[96:99], v[112:115], v[72:75]
    s_waitcnt lgkmcnt(4)
    v_mfma_f32_16x16x32_bf16 v[76:79], v[100:103], v[112:115], v[76:79]
    s_waitcnt lgkmcnt(2)
    v_mfma_f32_16x16x32_bf16 v[80:83], v[104:107], v[112:115], v[80:83]
    s_waitcnt lgkmcnt(0)
    v_mfma_f32_16x16x32_bf16 v[84:87], v[108:111], v[112:115], v[84:87]
K1_cs_4:
    s_waitcnt vmcnt(16)
    s_barrier
    s_add_u32 s52, s52, 98048
    s_add_u32 m0, s60, 24576
    s_nop 0
    buffer_load_dwordx4 v2, s[28:31], s52 offen  lds
    buffer_load_dwordx4 v3, s[28:31], s52 offen offset:1024  lds
    s_add_u32 m0, s60, 28672
    s_add_u32 s52, s52, 128
    buffer_load_dwordx4 v2, s[28:31], s52 offen  lds
    buffer_load_dwordx4 v3, s[28:31], s52 offen offset:1024  lds
    s_add_u32 m0, s60, 32768
    s_add_u32 s52, s52, 128
    buffer_load_dwordx4 v2, s[28:31], s52 offen  lds
    buffer_load_dwordx4 v3, s[28:31], s52 offen offset:1024  lds
    s_mov_b32 s62, s47
    s_sub_u32 s50, s62, 3
    s_cmp_ge_u32 s62, 3
    s_cselect_b32 s62, s50, s62
    s_sub_u32 s50, s62, 3
    s_cmp_ge_u32 s62, 3
    s_cselect_b32 s62, s50, s62
    s_add_u32 s62, s62, 3
    s_add_u32 m0, s61, 0
    s_lshl_b32 s53, s62, 7
    buffer_load_dwordx4 v4, s[24:27], s53 offen  lds
    buffer_load_dwordx4 v5, s[24:27], s53 offen offset:1024  lds
    s_waitcnt vmcnt(18)
    s_barrier
    s_add_u32 m0, s61, 8192
    s_lshl_b32 s53, s62, 7
    s_add_u32 s53, s53, 81920
    buffer_load_dwordx4 v4, s[24:27], s53 offen  lds
    buffer_load_dwordx4 v5, s[24:27], s53 offen offset:1024  lds
    s_mul_i32 s52, s62, 196608
    s_add_u32 m0, s60, 49152
    s_nop 0
    buffer_load_dwordx4 v2, s[28:31], s52 offen  lds
    buffer_load_dwordx4 v3, s[28:31], s52 offen offset:1024  lds
    s_add_u32 m0, s60, 53248
    s_add_u32 s52, s52, 128
    buffer_load_dwordx4 v2, s[28:31], s52 offen  lds
    buffer_load_dwordx4 v3, s[28:31], s52 offen offset:1024  lds
    s_add_u32 m0, s60, 57344
    s_add_u32 s52, s52, 128
    buffer_load_dwordx4 v2, s[28:31], s52 offen  lds
    buffer_load_dwordx4 v3, s[28:31], s52 offen offset:1024  lds
    s_waitcnt vmcnt(16)
    s_barrier
    s_add_u32 s52, s52, 98048
    s_add_u32 m0, s60, 73728
    s_nop 0
    buffer_load_dwordx4 v2, s[28:31], s52 offen  lds
    buffer_load_dwordx4 v3, s[28:31], s52 offen offset:1024  lds
    s_add_u32 m0, s60, 77824
    s_add_u32 s52, s52, 128
    buffer_load_dwordx4 v2, s[28:31], s52 offen  lds
    buffer_load_dwordx4 v3, s[28:31], s52 offen offset:1024  lds
    s_add_u32 m0, s60, 81920
    s_add_u32 s52, s52, 128
    buffer_load_dwordx4 v2, s[28:31], s52 offen  lds
    buffer_load_dwordx4 v3, s[28:31], s52 offen offset:1024  lds
    s_add_u32 s62, s62, 1
    s_cmp_eq_u32 s62, 6
    s_cselect_b32 s62, 3, s62
    s_add_u32 m0, s61, 16384
    s_lshl_b32 s53, s62, 7
    buffer_load_dwordx4 v4, s[24:27], s53 offen  lds
    buffer_load_dwordx4 v5, s[24:27], s53 offen offset:1024  lds
    s_waitcnt vmcnt(18)
    s_barrier
    s_add_u32 m0, s61, 24576
    s_lshl_b32 s53, s62, 7
    s_add_u32 s53, s53, 81920
    buffer_load_dwordx4 v4, s[24:27], s53 offen  lds
    buffer_load_dwordx4 v5, s[24:27], s53 offen offset:1024  lds
    s_mul_i32 s52, s62, 196608
    s_add_u32 m0, s60, 0
    s_nop 0
    buffer_load_dwordx4 v2, s[28:31], s52 offen  lds
    buffer_load_dwordx4 v3, s[28:31], s52 offen offset:1024  lds
    s_add_u32 m0, s60, 4096
    s_add_u32 s52, s52, 128
    buffer_load_dwordx4 v2, s[28:31], s52 offen  lds
    buffer_load_dwordx4 v3, s[28:31], s52 offen offset:1024  lds
    s_add_u32 m0, s60, 8192
    s_add_u32 s52, s52, 128
    buffer_load_dwordx4 v2, s[28:31], s52 offen  lds
    buffer_load_dwordx4 v3, s[28:31], s52 offen offset:1024  lds
    s_waitcnt vmcnt(16)
    s_barrier
    s_bitcmp1_b32 56, s47
    s_cbranch_scc0 K1_cs_5
    ds_read_b64_tr_b16 v[88:89], v23 offset:0
    ds_read_b64_tr_b16 v[90:91], v23 offset:512
    ds_read_b64_tr_b16 v[92:93], v23 offset:12288
    ds_read_b64_tr_b16 v[94:95], v23 offset:12800
    ds_read_b64_tr_b16 v[96:97], v24 offset:0
    ds_read_b64_tr_b16 v[98:99], v24 offset:512
    ds_read_b64_tr_b16 v[100:101], v24 offset:12288
    ds_read_b64_tr_b16 v[102:103], v24 offset:12800
    ds_read_b64_tr_b16 v[104:105], v25 offset:0
    ds_read_b64_tr_b16 v[106:107], v25 offset:512
    ds_read_b64_tr_b16 v[108:109], v25 offset:12288
    ds_read_b64_tr_b16 v[110:111], v25 offset:12800
    s_waitcnt lgkmcnt(10)
    v_mfma_f32_16x16x32_bf16 v[64:67], v[88:91], v[112:115], v[64:67]
    s_waitcnt lgkmcnt(8)
    v_mfma_f32_16x16x32_bf16 v[68:71], v[92:95], v[112:115], v[68:71]
    s_waitcnt lgkmcnt(6)
    v_mfma_f32_16x16x32_bf16 v[72:75], v[96:99], v[112:115], v[72:75]
    s_waitcnt lgkmcnt(4)
    v_mfma_f32_16x16x32_bf16 v[76:79], v[100:103], v[112:115], v[76:79]
    s_waitcnt lgkmcnt(2)
    v_mfma_f32_16x16x32_bf16 v[80:83], v[104:107], v[112:115], v[80:83]
    s_waitcnt lgkmcnt(0)
    v_mfma_f32_16x16x32_bf16 v[84:87], v[108:111], v[112:115], v[84:87]
K1_cs_5:
    s_add_u32 s52, s52, 98048
    s_add_u32 m0, s60, 24576
    s_nop 0
    buffer_load_dwordx4 v2, s[28:31], s52 offen  lds
    buffer_load_dwordx4 v3, s[28:31], s52 offen offset:1024  lds
    s_add_u32 m0, s60, 28672
    s_add_u32 s52, s52, 128
    buffer_load_dwordx4 v2, s[28:31], s52 offen  lds
    buffer_load_dwordx4 v3, s[28:31], s52 offen offset:1024  lds
    s_add_u32 m0, s60, 32768
    s_add_u32 s52, s52, 128
    buffer_load_dwordx4 v2, s[28:31], s52 offen  lds
    buffer_load_dwordx4 v3, s[28:31], s52 offen offset:1024  lds
    s_add_u32 s62, s62, 1
    s_cmp_eq_u32 s62, 6
    s_cselect_b32 s62, 3, s62
    s_add_u32 m0, s61, 32768
    s_lshl_b32 s53, s62, 7
    buffer_load_dwordx4 v4, s[24:27], s53 offen  lds
    buffer_load_dwordx4 v5, s[24:27], s53 offen offset:1024  lds
    s_waitcnt vmcnt(18)
    s_barrier
    s_bitcmp1_b32 56, s47
    s_cbranch_scc0 K1_cs_6
    ds_read_b64_tr_b16 v[88:89], v23 offset:24576
    ds_read_b64_tr_b16 v[90:91], v23 offset:25088
    ds_read_b64_tr_b16 v[92:93], v23 offset:36864
    ds_read_b64_tr_b16 v[94:95], v23 offset:37376
    ds_read_b64_tr_b16 v[96:97], v24 offset:24576
    ds_read_b64_tr_b16 v[98:99], v24 offset:25088
    ds_read_b64_tr_b16 v[100:101], v24 offset:36864
    ds_read_b64_tr_b16 v[102:103], v24 offset:37376
    ds_read_b64_tr_b16 v[104:105], v25 offset:24576
    ds_read_b64_tr_b16 v[106:107], v25 offset:25088
    ds_read_b64_tr_b16 v[108:109], v25 offset:36864
    ds_read_b64_tr_b16 v[110:111], v25 offset:37376
    s_waitcnt lgkmcnt(10)
    v_mfma_f32_16x16x32_bf16 v[64:67], v[88:91], v[112:115], v[64:67]
    s_waitcnt lgkmcnt(8)
    v_mfma_f32_16x16x32_bf16 v[68:71], v[92:95], v[112:115], v[68:71]
    s_waitcnt lgkmcnt(6)
    v_mfma_f32_16x16x32_bf16 v[72:75], v[96:99], v[112:115], v[72:75]
    s_waitcnt lgkmcnt(4)
    v_mfma_f32_16x16x32_bf16 v[76:79], v[100:103], v[112:115], v[76:79]
    s_waitcnt lgkmcnt(2)
    v_mfma_f32_16x16x32_bf16 v[80:83], v[104:107], v[112:115], v[80:83]
    s_waitcnt lgkmcnt(0)
    v_mfma_f32_16x16x32_bf16 v[84:87], v[108:111], v[112:115], v[84:87]
K1_cs_6:
    s_add_u32 m0, s61, 40960
    s_lshl_b32 s53, s62, 7
    s_add_u32 s53, s53, 81920
    buffer_load_dwordx4 v4, s[24:27], s53 offen  lds
    buffer_load_dwordx4 v5, s[24:27], s53 offen offset:1024  lds
    s_mul_i32 s52, s62, 196608
    s_add_u32 m0, s60, 49152
    s_nop 0
    buffer_load_dwordx4 v2, s[28:31], s52 offen  lds
    buffer_load_dwordx4 v3, s[28:31], s52 offen offset:1024  lds
    s_add_u32 m0, s60, 53248
    s_add_u32 s52, s52, 128
    buffer_load_dwordx4 v2, s[28:31], s52 offen  lds
    buffer_load_dwordx4 v3, s[28:31], s52 offen offset:1024  lds
    s_add_u32 m0, s60, 57344
    s_add_u32 s52, s52, 128
    buffer_load_dwordx4 v2, s[28:31], s52 offen  lds
    buffer_load_dwordx4 v3, s[28:31], s52 offen offset:1024  lds
    s_waitcnt vmcnt(16)
    s_barrier
    s_add_u32 s52, s52, 98048
    s_add_u32 m0, s60, 73728
    s_nop 0
    buffer_load_dwordx4 v2, s[28:31], s52 offen  lds
    buffer_load_dwordx4 v3, s[28:31], s52 offen offset:1024  lds
    s_add_u32 m0, s60, 77824
    s_add_u32 s52, s52, 128
    buffer_load_dwordx4 v2, s[28:31], s52 offen  lds
    buffer_load_dwordx4 v3, s[28:31], s52 offen offset:1024  lds
    s_add_u32 m0, s60, 81920
    s_add_u32 s52, s52, 128
    buffer_load_dwordx4 v2, s[28:31], s52 offen  lds
    buffer_load_dwordx4 v3, s[28:31], s52 offen offset:1024  lds
    s_and_b32 s62, s47, 3
    s_add_u32 s62, s62, 6
    s_add_u32 m0, s61, 0
    s_lshl_b32 s53, s62, 7
    buffer_load_dwordx4 v4, s[24:27], s53 offen  lds
    buffer_load_dwordx4 v5, s[24:27], s53 offen offset:1024  lds
    s_waitcnt vmcnt(18)
    s_barrier
    s_add_u32 m0, s61, 8192
    s_lshl_b32 s53, s62, 7
    s_add_u32 s53, s53, 81920
    buffer_load_dwordx4 v4, s[24:27], s53 offen  lds
    buffer_load_dwordx4 v5, s[24:27], s53 offen offset:1024  lds
    s_mul_i32 s52, s62, 196608
    s_add_u32 m0, s60, 0
    s_nop 0
    buffer_load_dwordx4 v2, s[28:31], s52 offen  lds
    buffer_load_dwordx4 v3, s[28:31], s52 offen offset:1024  lds
    s_add_u32 m0, s60, 4096
    s_add_u32 s52, s52, 128
    buffer_load_dwordx4 v2, s[28:31], s52 offen  lds
    buffer_load_dwordx4 v3, s[28:31], s52 offen offset:1024  lds
    s_add_u32 m0, s60, 8192
    s_add_u32 s52, s52, 128
    buffer_load_dwordx4 v2, s[28:31], s52 offen  lds
    buffer_load_dwordx4 v3, s[28:31], s52 offen offset:1024  lds
    s_waitcnt vmcnt(16)
    s_barrier
    s_add_u32 s52, s52, 98048
    s_add_u32 m0, s60, 24576
    s_nop 0
    buffer_load_dwordx4 v2, s[28:31], s52 offen  lds
    buffer_load_dwordx4 v3, s[28:31], s52 offen offset:1024  lds
    s_add_u32 m0, s60, 28672
    s_add_u32 s52, s52, 128
    buffer_load_dwordx4 v2, s[28:31], s52 offen  lds
    buffer_load_dwordx4 v3, s[28:31], s52 offen offset:1024  lds
    s_add_u32 m0, s60, 32768
    s_add_u32 s52, s52, 128
    buffer_load_dwordx4 v2, s[28:31], s52 offen  lds
    buffer_load_dwordx4 v3, s[28:31], s52 offen offset:1024  lds
    s_add_u32 s62, s62, 1
    s_cmp_eq_u32 s62, 10
    s_cselect_b32 s62, 6, s62
    s_add_u32 m0, s61, 16384
    s_lshl_b32 s53, s62, 7
    buffer_load_dwordx4 v4, s[24:27], s53 offen  lds
    buffer_load_dwordx4 v5, s[24:27], s53 offen offset:1024  lds
    s_waitcnt vmcnt(18)
    s_barrier
    buffer_load_dword v31, v30, s[36:39], 0 offen sc1
    s_add_u32 m0, s61, 24576
    s_lshl_b32 s53, s62, 7
    s_add_u32 s53, s53, 81920
    buffer_load_dwordx4 v4, s[24:27], s53 offen  lds
    buffer_load_dwordx4 v5, s[24:27], s53 offen offset:1024  lds
    s_mul_i32 s52, s62, 196608
    s_add_u32 m0, s60, 49152
    s_nop 0
    buffer_load_dwordx4 v2, s[28:31], s52 offen  lds
    buffer_load_dwordx4 v3, s[28:31], s52 offen offset:1024  lds
    s_add_u32 m0, s60, 53248
    s_add_u32 s52, s52, 128
    buffer_load_dwordx4 v2, s[28:31], s52 offen  lds
    buffer_load_dwordx4 v3, s[28:31], s52 offen offset:1024  lds
    s_add_u32 m0, s60, 57344
    s_add_u32 s52, s52, 128
    buffer_load_dwordx4 v2, s[28:31], s52 offen  lds
    buffer_load_dwordx4 v3, s[28:31], s52 offen offset:1024  lds
    s_waitcnt vmcnt(17)
    s_barrier
    s_bitcmp1_b32 195, s47
    s_cbranch_scc0 K1_cs_7
    ds_read_b64_tr_b16 v[88:89], v20 offset:0
    ds_read_b64_tr_b16 v[90:91], v20 offset:512
    ds_read_b64_tr_b16 v[92:93], v20 offset:12288
    ds_read_b64_tr_b16 v[94:95], v20 offset:12800
    ds_read_b64_tr_b16 v[96:97], v21 offset:0
    ds_read_b64_tr_b16 v[98:99], v21 offset:512
    ds_read_b64_tr_b16 v[100:101], v21 offset:12288
    ds_read_b64_tr_b16 v[102:103], v21 offset:12800
    ds_read_b64_tr_b16 v[104:105], v22 offset:0
    ds_read_b64_tr_b16 v[106:107], v22 offset:512
    ds_read_b64_tr_b16 v[108:109], v22 offset:12288
    ds_read_b64_tr_b16 v[110:111], v22 offset:12800
    s_waitcnt lgkmcnt(10)
    v_mfma_f32_16x16x32_bf16 v[64:67], v[88:91], v[112:115], v[64:67]
    s_waitcnt lgkmcnt(8)
    v_mfma_f32_16x16x32_bf16 v[68:71], v[92:95], v[112:115], v[68:71]
    s_waitcnt lgkmcnt(6)
    v_mfma_f32_16x16x32_bf16 v[72:75], v[96:99], v[112:115], v[72:75]
    s_waitcnt lgkmcnt(4)
    v_mfma_f32_16x16x32_bf16 v[76:79], v[100:103], v[112:115], v[76:79]
    s_waitcnt lgkmcnt(2)
    v_mfma_f32_16x16x32_bf16 v[80:83], v[104:107], v[112:115], v[80:83]
    s_waitcnt lgkmcnt(0)
    v_mfma_f32_16x16x32_bf16 v[84:87], v[108:111], v[112:115], v[84:87]
K1_cs_7:
    s_add_u32 s52, s52, 98048
    s_add_u32 m0, s60, 73728
    s_nop 0
    buffer_load_dwordx4 v2, s[28:31], s52 offen  lds
    buffer_load_dwordx4 v3, s[28:31], s52 offen offset:1024  lds
    s_add_u32 m0, s60, 77824
    s_add_u32 s52, s52, 128
    buffer_load_dwordx4 v2, s[28:31], s52 offen  lds
    buffer_load_dwordx4 v3, s[28:31], s52 offen offset:1024  lds
    s_add_u32 m0, s60, 81920
    s_add_u32 s52, s52, 128
    buffer_load_dwordx4 v2, s[28:31], s52 offen  lds
    buffer_load_dwordx4 v3, s[28:31], s52 offen offset:1024  lds
    s_add_u32 s62, s62, 1
    s_cmp_eq_u32 s62, 10
    s_cselect_b32 s62, 6, s62
    s_add_u32 m0, s61, 32768
    s_lshl_b32 s53, s62, 7
    buffer_load_dwordx4 v4, s[24:27], s53 offen  lds
    buffer_load_dwordx4 v5, s[24:27], s53 offen offset:1024  lds
    s_waitcnt vmcnt(19)
    s_barrier
    s_bitcmp1_b32 195, s47
    s_cbranch_scc0 K1_cs_8
    ds_read_b64_tr_b16 v[88:89], v20 offset:24576
    ds_read_b64_tr_b16 v[90:91], v20 offset:25088
    ds_read_b64_tr_b16 v[92:93], v20 offset:36864
    ds_read_b64_tr_b16 v[94:95], v20 offset:37376
    ds_read_b64_tr_b16 v[96:97], v21 offset:24576
    ds_read_b64_tr_b16 v[98:99], v21 offset:25088
    ds_read_b64_tr_b16 v[100:101], v21 offset:36864
    ds_read_b64_tr_b16 v[102:103], v21 offset:37376
    ds_read_b64_tr_b16 v[104:105], v22 offset:24576
    ds_read_b64_tr_b16 v[106:107], v22 offset:25088
    ds_read_b64_tr_b16 v[108:109], v22 offset:36864
    ds_read_b64_tr_b16 v[110:111], v22 offset:37376
    s_waitcnt lgkmcnt(10)
    v_mfma_f32_16x16x32_bf16 v[64:67], v[88:91], v[112:115], v[64:67]
    s_waitcnt lgkmcnt(8)
    v_mfma_f32_16x16x32_bf16 v[68:71], v[92:95], v[112:115], v[68:71]
    s_waitcnt lgkmcnt(6)
    v_mfma_f32_16x16x32_bf16 v[72:75], v[96:99], v[112:115], v[72:75]
    s_waitcnt lgkmcnt(4)
    v_mfma_f32_16x16x32_bf16 v[76:79], v[100:103], v[112:115], v[76:79]
    s_waitcnt lgkmcnt(2)
    v_mfma_f32_16x16x32_bf16 v[80:83], v[104:107], v[112:115], v[80:83]
    s_waitcnt lgkmcnt(0)
    v_mfma_f32_16x16x32_bf16 v[84:87], v[108:111], v[112:115], v[84:87]
K1_cs_8:
    s_add_u32 m0, s61, 40960
    s_lshl_b32 s53, s62, 7
    s_add_u32 s53, s53, 81920
    buffer_load_dwordx4 v4, s[24:27], s53 offen  lds
    buffer_load_dwordx4 v5, s[24:27], s53 offen offset:1024  lds
    s_mul_i32 s52, s62, 196608
    s_add_u32 m0, s60, 0
    s_nop 0
    buffer_load_dwordx4 v2, s[28:31], s52 offen  lds
    buffer_load_dwordx4 v3, s[28:31], s52 offen offset:1024  lds
    s_add_u32 m0, s60, 4096
    s_add_u32 s52, s52, 128
    buffer_load_dwordx4 v2, s[28:31], s52 offen  lds
    buffer_load_dwordx4 v3, s[28:31], s52 offen offset:1024  lds
    s_add_u32 m0, s60, 8192
    s_add_u32 s52, s52, 128
    buffer_load_dwordx4 v2, s[28:31], s52 offen  lds
    buffer_load_dwordx4 v3, s[28:31], s52 offen offset:1024  lds
    s_waitcnt vmcnt(24)
    s_mov_b32 s51, 0
K1_pl_9:
    v_and_b32 v31, 0x01010101, v31
    s_mov_b32 s50, 0x01010101
    v_cmp_ne_u32 vcc, s50, v31
    s_add_u32 s51, s51, 1
    s_and_b64 vcc, vcc, s[54:55]
    s_cbranch_scc0 K1_ok_10
    s_cmp_ge_u32 s51, 65536
    s_cbranch_scc1 K1_ok_10
    s_sleep 16
    buffer_load_dword v31, v30, s[36:39], 0 offen sc1
    s_waitcnt vmcnt(0)
    s_branch K1_pl_9
K1_ok_10:
    s_waitcnt vmcnt(16)
    s_barrier
    s_add_u32 s52, s52, 98048
    s_add_u32 m0, s60, 24576
    s_nop 0
    buffer_load_dwordx4 v2, s[28:31], s52 offen  lds
    buffer_load_dwordx4 v3, s[28:31], s52 offen offset:1024  lds
    s_add_u32 m0, s60, 28672
    s_add_u32 s52, s52, 128
    buffer_load_dwordx4 v2, s[28:31], s52 offen  lds
    buffer_load_dwordx4 v3, s[28:31], s52 offen offset:1024  lds
    s_add_u32 m0, s60, 32768
    s_add_u32 s52, s52, 128
    buffer_load_dwordx4 v2, s[28:31], s52 offen  lds
    buffer_load_dwordx4 v3, s[28:31], s52 offen offset:1024  lds
    s_add_u32 s62, s62, 1
    s_cmp_eq_u32 s62, 10
    s_cselect_b32 s62, 6, s62
    s_add_u32 m0, s61, 0
    s_lshl_b32 s53, s62, 7
    buffer_load_dwordx4 v4, s[24:27], s53 offen  lds
    buffer_load_dwordx4 v5, s[24:27], s53 offen offset:1024  lds
    s_mul_i32 s50, s47, 1536
    s_add_u32 s51, s50, s49
    s_mov_b32 vcc_lo, 0x20002
    s_mov_b32 vcc_hi, 0x20002
    v_cndmask_b32 v64, v64, v68, vcc
    v_cndmask_b32 v65, v65, v69, vcc
    v_cndmask_b32 v66, v66, v70, vcc
    v_cndmask_b32 v67, v67, v71, vcc
    s_mov_b32 vcc_lo, 0x40004
    s_mov_b32 vcc_hi, 0x40004
    v_cndmask_b32 v64, v64, v72, vcc
    v_cndmask_b32 v65, v65, v73, vcc
    v_cndmask_b32 v66, v66, v74, vcc
    v_cndmask_b32 v67, v67, v75, vcc
    s_mov_b32 vcc_lo, 0x80008
    s_mov_b32 vcc_hi, 0x80008
    v_cndmask_b32 v64, v64, v76, vcc
    v_cndmask_b32 v65, v65, v77, vcc
    v_cndmask_b32 v66, v66, v78, vcc
    v_cndmask_b32 v67, v67, v79, vcc
    s_mov_b32 vcc_lo, 0x100010
    s_mov_b32 vcc_hi, 0x100010
    v_cndmask_b32 v64, v64, v80, vcc
    v_cndmask_b32 v65, v65, v81, vcc
    v_cndmask_b32 v66, v66, v82, vcc
    v_cndmask_b32 v67, v67, v83, vcc
    s_mov_b32 vcc_lo, 0x200020
    s_mov_b32 vcc_hi, 0x200020
    v_cndmask_b32 v64, v64, v84, vcc
    v_cndmask_b32 v65, v65, v85, vcc
    v_cndmask_b32 v66, v66, v86, vcc
    v_cndmask_b32 v67, v67, v87, vcc
    v_and_b32 v18, 15, v1
    v_lshl_add_u32 v18, v18, 6, v26
    s_mov_b32 exec_lo, 0x003f003f
    s_mov_b32 exec_hi, 0x003f003f
    buffer_store_dwordx4 v[64:67], v18, s[32:35], s51 offen sc1
    s_mov_b64 exec, -1
    s_waitcnt vmcnt(19)
    s_barrier
    s_add_u32 m0, s61, 8192
    s_lshl_b32 s53, s62, 7
    s_add_u32 s53, s53, 81920
    buffer_load_dwordx4 v4, s[24:27], s53 offen  lds
    buffer_load_dwordx4 v5, s[24:27], s53 offen offset:1024  lds
    s_mul_i32 s52, s62, 196608
    s_add_u32 m0, s60, 49152
    s_nop 0
    buffer_load_dwordx4 v2, s[28:31], s52 offen  lds
    buffer_load_dwordx4 v3, s[28:31], s52 offen offset:1024  lds
    s_add_u32 m0, s60, 53248
    s_add_u32 s52, s52, 128
    buffer_load_dwordx4 v2, s[28:31], s52 offen  lds
    buffer_load_dwordx4 v3, s[28:31], s52 offen offset:1024  lds
    s_add_u32 m0, s60, 57344
    s_add_u32 s52, s52, 128
    buffer_load_dwordx4 v2, s[28:31], s52 offen  lds
    buffer_load_dwordx4 v3, s[28:31], s52 offen offset:1024  lds
    s_waitcnt vmcnt(17)
    s_barrier
    s_add_u32 s52, s52, 98048
    s_add_u32 m0, s60, 73728
    s_nop 0
    buffer_load_dwordx4 v2, s[28:31], s52 offen  lds
    buffer_load_dwordx4 v3, s[28:31], s52 offen offset:1024  lds
    s_add_u32 m0, s60, 77824
    s_add_u32 s52, s52, 128
    buffer_load_dwordx4 v2, s[28:31], s52 offen  lds
    buffer_load_dwordx4 v3, s[28:31], s52 offen offset:1024  lds
    s_add_u32 m0, s60, 81920
    s_add_u32 s52, s52, 128
    buffer_load_dwordx4 v2, s[28:31], s52 offen  lds
    buffer_load_dwordx4 v3, s[28:31], s52 offen offset:1024  lds
    s_mov_b64 exec, 0xffff
    buffer_load_dwordx4 v[116:119], v29, s[32:35], s56 offen sc1
    s_mov_b64 exec, -1
    s_lshl2_add_u32 s42, s42, s43
    s_add_u32 s43, s42, 1
    s_sub_u32 s50, s44, 2
    s_mul_i32 s51, s50, 26
    s_lshr_b32 s51, s51, 8
    s_mul_i32 s46, s51, 10
    s_sub_u32 s46, s50, s46
    s_mul_i32 s45, s51, 6
    s_sub_u32 s45, s45, 6
    s_cmp_eq_u32 s51, 0
    s_cselect_b32 s45, 12, s45
    s_lshl4_add_u32 s45, s42, s45
    s_cmp_lt_u32 s44, 2
    s_cselect_b32 s41, 1, 0
    v_lshlrev_b32 v13, 4, v1
    v_lshrrev_b32 v7, 3, v1
    v_and_b32 v8, 2, v7
    v_lshlrev_b32 v8, 1, v8
    v_and_b32 v9, 7, v1
    v_xor_b32 v8, v8, v9
    v_lshlrev_b32 v8, 4, v8
    s_movk_i32 s50, 1280
    v_mad_u32_u24 v8, v7, s50, v8
    s_mul_i32 s50, s48, 20480
    s_lshl_b32 s51, s46, 7
    s_add_u32 s50, s50, s51
    v_add_u32 v5, s50, v8
    v_add_u32 v6, 9216, v5
    s_lshl_b32 s61, s48, 11
    s_lshl_b32 s56, s46, 1
    s_mov_b32 s57, s56
    s_mul_i32 s58, s46, 359
    s_lshr_b32 s58, s58, 8
    s_add_u32 s58, s58, 20
    s_mov_b32 s28, s16
    s_mov_b32 s29, s17
    s_mov_b32 s30, 1966080
    s_mov_b32 s59, 819200
    s_mul_i32 s53, s57, 81920
    s_add_u32 m0, s61, 114688
    s_nop 0
    buffer_load_dwordx4 v5, s[28:31], s53 offen lds
    buffer_load_dwordx4 v6, s[28:31], s53 offen offset:1024 lds
    s_add_u32 s57, s57, 1
    s_cmp_eq_u32 s57, 20
    s_cselect_b32 s57, 0, s57
    s_mul_i32 s53, s57, 81920
    s_add_u32 m0, s61, 122880
    s_nop 0
    buffer_load_dwordx4 v5, s[28:31], s53 offen lds
    buffer_load_dwordx4 v6, s[28:31], s53 offen offset:1024 lds
    s_waitcnt vmcnt(22)
    s_barrier
    s_add_u32 s57, s57, 1
    s_cmp_eq_u32 s57, 20
    s_cselect_b32 s57, 0, s57
    s_mul_i32 s53, s57, 81920
    s_add_u32 m0, s61, 0
    s_nop 0
    buffer_load_dwordx4 v5, s[28:31], s53 offen lds
    buffer_load_dwordx4 v6, s[28:31], s53 offen offset:1024 lds
    s_add_u32 s57, s57, 1
    s_cmp_eq_u32 s57, 20
    s_cselect_b32 s57, 0, s57
    s_mul_i32 s53, s57, 81920
    s_add_u32 m0, s61, 8192
    s_nop 0
    buffer_load_dwordx4 v5, s[28:31], s53 offen lds
    buffer_load_dwordx4 v6, s[28:31], s53 offen offset:1024 lds
    s_add_u32 s57, s57, 1
    s_cmp_eq_u32 s57, 20
    s_cselect_b32 s57, 0, s57
    s_mul_i32 s53, s57, 81920
    s_add_u32 m0, s61, 16384
    s_nop 0
    buffer_load_dwordx4 v5, s[28:31], s53 offen lds
    buffer_load_dwordx4 v6, s[28:31], s53 offen offset:1024 lds
    s_waitcnt vmcnt(17)
    s_barrier
    s_mov_b64 exec, 0xffffff
    s_mov_b32 s52, s49
    buffer_load_dwordx4 v[32:35], v29, s[32:35], s52 offen offset:0 sc1
    buffer_load_dwordx4 v[36:39], v29, s[32:35], s52 offen offset:1536 sc1
    s_add_u32 s52, s52, 3072
    buffer_load_dwordx4 v[40:43], v29, s[32:35], s52 offen offset:0 sc1
    buffer_load_dwordx4 v[44:47], v29, s[32:35], s52 offen offset:1536 sc1
    s_add_u32 s52, s52, 3072
    buffer_load_dwordx4 v[48:51], v29, s[32:35], s52 offen offset:0 sc1
    buffer_load_dwordx4 v[52:55], v29, s[32:35], s52 offen offset:1536 sc1
    s_add_u32 s52, s52, 3072
    buffer_load_dwordx4 v[56:59], v29, s[32:35], s52 offen offset:0 sc1
    buffer_load_dwordx4 v[60:63], v29, s[32:35], s52 offen offset:1536 sc1
    s_add_u32 s52, s52, 3072
    s_mov_b64 exec, -1
    s_add_u32 s57, s57, 1
    s_cmp_eq_u32 s57, 20
    s_cselect_b32 s57, 0, s57
    s_mul_i32 s53, s57, 81920
    s_add_u32 m0, s61, 24576
    s_nop 0
    buffer_load_dwordx4 v5, s[28:31], s53 offen lds
    buffer_load_dwordx4 v6, s[28:31], s53 offen offset:1024 lds
    s_add_u32 s57, s57, 1
    s_cmp_eq_u32 s57, 20
    s_cselect_b32 s57, 0, s57
    s_mul_i32 s53, s57, 81920
    s_add_u32 m0, s61, 32768
    s_nop 0
    buffer_load_dwordx4 v5, s[28:31], s53 offen lds
    buffer_load_dwordx4 v6, s[28:31], s53 offen offset:1024 lds
    s_add_u32 s57, s57, 1
    s_cmp_eq_u32 s57, 20
    s_cselect_b32 s57, 0, s57
    s_mul_i32 s53, s57, 81920
    s_add_u32 m0, s61, 40960
    s_nop 0
    buffer_load_dwordx4 v5, s[28:31], s53 offen lds
    buffer_load_dwordx4 v6, s[28:31], s53 offen offset:1024 lds
    s_add_u32 s57, s57, 1
    s_cmp_eq_u32 s57, 20
    s_cselect_b32 s57, 0, s57
    s_mul_i32 s53, s57, 81920
    s_add_u32 m0, s61, 131072
    s_nop 0
    buffer_load_dwordx4 v5, s[28:31], s53 offen lds
    buffer_load_dwordx4 v6, s[28:31], s53 offen offset:1024 lds
    s_add_u32 s57, s57, 1
    s_cmp_eq_u32 s57, 20
    s_cselect_b32 s57, 0, s57
    s_mul_i32 s53, s57, 81920
    s_add_u32 m0, s61, 139264
    s_nop 0
    buffer_load_dwordx4 v5, s[28:31], s53 offen lds
    buffer_load_dwordx4 v6, s[28:31], s53 offen offset:1024 lds
    s_waitcnt vmcnt(29)
    s_barrier
    s_mov_b64 exec, 0xffffff
    s_mov_b32 s51, 0
    s_waitcnt vmcnt(10)
K1_cl_11:
    v_max3_u32 v26, v32, v33, v34
    v_max3_u32 v26, v26, v35, v36
    v_max3_u32 v26, v26, v37, v38
    v_max3_u32 v26, v26, v39, v40
    v_max3_u32 v26, v26, v41, v42
    v_max3_u32 v26, v26, v43, v44
    v_max3_u32 v26, v26, v45, v46
    v_max3_u32 v26, v26, v47, v48
    v_max3_u32 v26, v26, v49, v50
    v_max3_u32 v26, v26, v51, v52
    v_max3_u32 v26, v26, v53, v54
    v_max3_u32 v26, v26, v55, v56
    v_max3_u32 v26, v26, v57, v58
    v_max3_u32 v26, v26, v59, v60
    v_max3_u32 v26, v26, v61, v62
    v_max_u32 v26, v26, v63
    v_cmp_eq_u32 vcc, -1, v26
    s_add_u32 s51, s51, 1
    s_cmp_eq_u64 vcc, 0
    s_cbranch_scc1 K1_co_12
    s_cmp_ge_u32 s51, 65536
    s_cbranch_scc1 K1_co_12
    s_sleep 4
    s_mov_b32 s52, s49
    buffer_load_dwordx4 v[32:35], v29, s[32:35], s52 offen offset:0 sc1
    buffer_load_dwordx4 v[36:39], v29, s[32:35], s52 offen offset:1536 sc1
    s_add_u32 s52, s52, 3072
    buffer_load_dwordx4 v[40:43], v29, s[32:35], s52 offen offset:0 sc1
    buffer_load_dwordx4 v[44:47], v29, s[32:35], s52 offen offset:1536 sc1
    s_add_u32 s52, s52, 3072
    buffer_load_dwordx4 v[48:51], v29, s[32:35], s52 offen offset:0 sc1
    buffer_load_dwordx4 v[52:55], v29, s[32:35], s52 offen offset:1536 sc1
    s_add_u32 s52, s52, 3072
    buffer_load_dwordx4 v[56:59], v29, s[32:35], s52 offen offset:0 sc1
    buffer_load_dwordx4 v[60:63], v29, s[32:35], s52 offen offset:1536 sc1
    s_add_u32 s52, s52, 3072
    s_waitcnt vmcnt(0)
    s_branch K1_cl_11
K1_co_12:
    v_pk_add_f32 v[32:33], v[32:33], v[36:37]
    v_pk_add_f32 v[34:35], v[34:35], v[38:39]
    v_pk_add_f32 v[32:33], v[32:33], v[40:41]
    v_pk_add_f32 v[34:35], v[34:35], v[42:43]
    v_pk_add_f32 v[32:33], v[32:33], v[44:45]
    v_pk_add_f32 v[34:35], v[34:35], v[46:47]
    v_pk_add_f32 v[32:33], v[32:33], v[48:49]
    v_pk_add_f32 v[34:35], v[34:35], v[50:51]
    v_pk_add_f32 v[32:33], v[32:33], v[52:53]
    v_pk_add_f32 v[34:35], v[34:35], v[54:55]
    v_pk_add_f32 v[32:33], v[32:33], v[56:57]
    v_pk_add_f32 v[34:35], v[34:35], v[58:59]
    v_pk_add_f32 v[32:33], v[32:33], v[60:61]
    v_pk_add_f32 v[34:35], v[34:35], v[62:63]
    ds_write_b128 v28, v[32:35]
    s_mov_b64 exec, 0xffff
    ds_write_b128 v27, v[116:119]
    s_mov_b64 exec, -1
    s_waitcnt lgkmcnt(0)
    s_barrier
    s_mov_b32 s63, 0
    s_branch P2_ld10
K1_mlp_comp:
    s_lshl_b32 s50, s42, 6
    s_lshl4_add_u32 s50, s43, s50
    s_add_u32 s50, s50, s44
    s_sub_u32 s50, s50, 16
    s_lshl3_add_u32 s59, s50, s40
    s_lshl_b32 s59, s59, 1
    s_mul_i32 s50, s59, 1280
    v_lshrrev_b32 v36, 5, v1
    v_and_b32 v37, 31, v1
    v_lshlrev_b32 v37, 3, v37
    s_movk_i32 s51, 1280
    v_mad_u32_u24 v37, v36, s51, v37
    s_waitcnt lgkmcnt(0)
    s_mov_b32 s24, s4
    s_mov_b32 s25, s5
    buffer_load_dwordx2 v[40:41], v37, s[24:27], s50 offen offset:0
    buffer_load_dwordx2 v[42:43], v37, s[24:27], s50 offen offset:256
    buffer_load_dwordx2 v[44:45], v37, s[24:27], s50 offen offset:512
    buffer_load_dwordx2 v[46:47], v37, s[24:27], s50 offen offset:768
    buffer_load_dwordx2 v[48:49], v37, s[24:27], s50 offen offset:1024
    s_cmp_lg_u32 s40, 7
    s_cbranch_scc1 K1_cpf_13
    s_and_b32 s50, s44, 7
    s_lshl_b32 s50, s50, 13
    v_lshlrev_b32 v37, 7, v1
    v_add_u32 v37, s50, v37
    v_min_u32 v37, K1_done-K1_pc, v37
    global_load_dword v50, v37, s[62:63]
K1_cpf_13:
    s_lshr_b32 s48, s40, 2
    s_and_b32 s49, s40, 3
    v_lshrrev_b32 v12, 4, v1
    v_bfe_u32 v13, v1, 2, 2
    v_lshl_add_u32 v14, v12, 3, v13
    v_lshlrev_b32 v14, 7, v14
    v_and_b32 v15, 3, v1
    v_lshl_add_u32 v14, v15, 3, v14
    v_bfe_u32 v15, v1, 3, 2
    s_mul_i32 s50, s49, 3
    s_add_u32 s51, s50, 0
    s_and_b32 s52, s51, 3
    s_lshr_b32 s51, s51, 2
    s_lshl_b32 s51, s51, 12
    v_xor_b32 v16, s52, v15
    v_lshl_add_u32 v16, v16, 5, v14
    v_add_u32 v2, s51, v16
    v_add_u32 v5, 49152, v2
    s_add_u32 s51, s50, 1
    s_and_b32 s52, s51, 3
    s_lshr_b32 s51, s51, 2
    s_lshl_b32 s51, s51, 12
    v_xor_b32 v16, s52, v15
    v_lshl_add_u32 v16, v16, 5, v14
    v_add_u32 v3, s51, v16
    v_add_u32 v6, 49152, v3
    s_add_u32 s51, s50, 2
    s_and_b32 s52, s51, 3
    s_lshr_b32 s51, s51, 2
    s_lshl_b32 s51, s51, 12
    v_xor_b32 v16, s52, v15
    v_lshl_add_u32 v16, v16, 5, v14
    v_add_u32 v4, s51, v16
    v_add_u32 v7, 49152, v4
    v_and_b32 v10, 15, v1
    v_bfe_u32 v15, v1, 1, 3
    v_xor_b32 v15, v15, v12
    s_lshl_b32 s50, s48, 13
    s_add_u32 s50, s50, 98304
    v_lshlrev_b32 v14, 7, v10
    v_add_u32 v14, s50, v14
    v_lshl_add_u32 v8, v15, 4, v14
    v_xor_b32 v9, 64, v8
    v_lshlrev_b32 v11, 6, v10
    v_lshl_add_u32 v11, v12, 4, v11
    s_lshl3_add_u32 s56, s42, s46
    s_mul_i32 s56, s56, 12288
    s_add_u32 s56, s56, 9502720
    s_mul_i32 s57, s47, 1536
    s_lshl3_add_u32 s58, s48, s47
    s_mul_i32 s50, s49, 384
    s_add_u32 s57, s57, s50
    s_add_u32 s57, s57, s56
    v_mov_b32 v20, -1
    v_mov_b32 v21, -1
    v_mov_b32 v22, -1
    v_mov_b32 v23, -1
    s_waitcnt lgkmcnt(0)
    s_mov_b32 s24, s4
    s_mov_b32 s25, s5
    s_mov_b32 s32, s22
    s_mov_b32 s33, s23
    s_mov_b32 s36, s20
    s_mov_b32 s37, s21
    s_mov_b32 s34, 0x1000000
    s_mov_b32 s35, 0x20000
    s_mov_b32 s38, 256
    s_mov_b32 s39, 0x20000
    v_mov_b32 v72, 0
    v_mov_b32 v73, 0
    v_mov_b32 v74, 0
    v_mov_b32 v75, 0
    v_mov_b32 v76, 0
    v_mov_b32 v77, 0
    v_mov_b32 v78, 0
    v_mov_b32 v79, 0
    v_mov_b32 v80, 0
    v_mov_b32 v81, 0
    v_mov_b32 v82, 0
    v_mov_b32 v83, 0
    v_mov_b32 v84, 0
    v_mov_b32 v85, 0
    v_mov_b32 v86, 0
    v_mov_b32 v87, 0
    v_mov_b32 v88, 0
    v_mov_b32 v89, 0
    v_mov_b32 v90, 0
    v_mov_b32 v91, 0
    v_mov_b32 v92, 0
    v_mov_b32 v93, 0
    v_mov_b32 v94, 0
    v_mov_b32 v95, 0
    v_mov_b32 v96, 0
    v_mov_b32 v97, 0
    v_mov_b32 v98, 0
    v_mov_b32 v99, 0
    v_mov_b32 v100, 0
    v_mov_b32 v101, 0
    v_mov_b32 v102, 0
    v_mov_b32 v103, 0
    v_mov_b32 v104, 0
    v_mov_b32 v105, 0
    v_mov_b32 v106, 0
    v_mov_b32 v107, 0
    v_mov_b32 v108, 0
    v_mov_b32 v109, 0
    v_mov_b32 v110, 0
    v_mov_b32 v111, 0
    v_mov_b32 v112, 0
    v_mov_b32 v113, 0
    v_mov_b32 v114, 0
    v_mov_b32 v115, 0
    v_mov_b32 v116, 0
    v_mov_b32 v117, 0
    v_mov_b32 v118, 0
    v_mov_b32 v119, 0
    v_mov_b32 v120, 0
    v_mov_b32 v121, 0
    v_mov_b32 v122, 0
    v_mov_b32 v123, 0
    v_mov_b32 v124, 0
    v_mov_b32 v125, 0
    v_mov_b32 v126, 0
    v_mov_b32 v127, 0
    v_mov_b32 v128, 0
    v_mov_b32 v129, 0
    v_mov_b32 v130, 0
    v_mov_b32 v131, 0
    v_mov_b32 v132, 0
    v_mov_b32 v133, 0
    v_mov_b32 v134, 0
    v_mov_b32 v135, 0
    v_mov_b32 v136, 0
    v_mov_b32 v137, 0
    v_mov_b32 v138, 0
    v_mov_b32 v139, 0
    v_mov_b32 v140, 0
    v_mov_b32 v141, 0
    v_mov_b32 v142, 0
    v_mov_b32 v143, 0
    v_mov_b32 v144, 0
    v_mov_b32 v145, 0
    v_mov_b32 v146, 0
    v_mov_b32 v147, 0
    v_mov_b32 v148, 0
    v_mov_b32 v149, 0
    v_mov_b32 v150, 0
    v_mov_b32 v151, 0
    v_mov_b32 v152, 0
    v_mov_b32 v153, 0
    v_mov_b32 v154, 0
    v_mov_b32 v155, 0
    v_mov_b32 v156, 0
    v_mov_b32 v157, 0
    v_mov_b32 v158, 0
    v_mov_b32 v159, 0
    v_mov_b32 v160, 0
    v_mov_b32 v161, 0
    v_mov_b32 v162, 0
    v_mov_b32 v163, 0
    v_mov_b32 v164, 0
    v_mov_b32 v165, 0
    v_mov_b32 v166, 0
    v_mov_b32 v167, 0
    s_mov_b32 s50, 0xffff0000
    s_waitcnt vmcnt(0)
    v_lshlrev_b32 v52, 16, v40
    v_and_b32 v53, s50, v40
    v_lshlrev_b32 v54, 16, v41
    v_and_b32 v55, s50, v41
    v_lshlrev_b32 v56, 16, v42
    v_and_b32 v57, s50, v42
    v_lshlrev_b32 v58, 16, v43
    v_and_b32 v59, s50, v43
    v_lshlrev_b32 v60, 16, v44
    v_and_b32 v61, s50, v44
    v_lshlrev_b32 v62, 16, v45
    v_and_b32 v63, s50, v45
    v_lshlrev_b32 v64, 16, v46
    v_and_b32 v65, s50, v46
    v_lshlrev_b32 v66, 16, v47
    v_and_b32 v67, s50, v47
    v_lshlrev_b32 v68, 16, v48
    v_and_b32 v69, s50, v48
    v_lshlrev_b32 v70, 16, v49
    v_and_b32 v71, s50, v49
    v_pk_add_f32 v[40:41], v[52:53], v[54:55]
    v_pk_add_f32 v[42:43], v[56:57], v[58:59]
    v_pk_add_f32 v[40:41], v[40:41], v[60:61]
    v_pk_add_f32 v[42:43], v[42:43], v[62:63]
    v_pk_add_f32 v[40:41], v[40:41], v[64:65]
    v_pk_add_f32 v[42:43], v[42:43], v[66:67]
    v_pk_add_f32 v[40:41], v[40:41], v[68:69]
    v_pk_add_f32 v[42:43], v[42:43], v[70:71]
    v_pk_add_f32 v[40:41], v[40:41], v[42:43]
    v_add_f32 v40, v40, v41
    s_nop 1
    v_add_f32_dpp v40, v40, v40 quad_perm:[1,0,3,2] row_mask:0xf bank_mask:0xf
    s_nop 1
    v_add_f32_dpp v40, v40, v40 quad_perm:[2,3,0,1] row_mask:0xf bank_mask:0xf
    s_nop 1
    v_add_f32_dpp v40, v40, v40 row_half_mirror row_mask:0xf bank_mask:0xf
    s_nop 1
    v_add_f32_dpp v40, v40, v40 row_mirror row_mask:0xf bank_mask:0xf
    v_mov_b32 v46, v40
    s_nop 1
    v_permlane16_swap_b32 v40, v46
    s_nop 0
    v_add_f32 v40, v40, v46
    v_mul_f32 v40, 0x3acccccd, v40
    v_pk_add_f32 v[52:53], v[52:53], v[40:41] op_sel_hi:[1,0] neg_lo:[0,1] neg_hi:[0,1]
    v_pk_add_f32 v[54:55], v[54:55], v[40:41] op_sel_hi:[1,0] neg_lo:[0,1] neg_hi:[0,1]
    v_pk_add_f32 v[56:57], v[56:57], v[40:41] op_sel_hi:[1,0] neg_lo:[0,1] neg_hi:[0,1]
    v_pk_add_f32 v[58:59], v[58:59], v[40:41] op_sel_hi:[1,0] neg_lo:[0,1] neg_hi:[0,1]
    v_pk_add_f32 v[60:61], v[60:61], v[40:41] op_sel_hi:[1,0] neg_lo:[0,1] neg_hi:[0,1]
    v_pk_add_f32 v[62:63], v[62:63], v[40:41] op_sel_hi:[1,0] neg_lo:[0,1] neg_hi:[0,1]
    v_pk_add_f32 v[64:65], v[64:65], v[40:41] op_sel_hi:[1,0] neg_lo:[0,1] neg_hi:[0,1]
    v_pk_add_f32 v[66:67], v[66:67], v[40:41] op_sel_hi:[1,0] neg_lo:[0,1] neg_hi:[0,1]
    v_pk_add_f32 v[68:69], v[68:69], v[40:41] op_sel_hi:[1,0] neg_lo:[0,1] neg_hi:[0,1]
    v_pk_add_f32 v[70:71], v[70:71], v[40:41] op_sel_hi:[1,0] neg_lo:[0,1] neg_hi:[0,1]
    v_pk_mul_f32 v[42:43], v[52:53], v[52:53]
    v_pk_mul_f32 v[44:45], v[54:55], v[54:55]
    v_pk_fma_f32 v[42:43], v[56:57], v[56:57], v[42:43]
    v_pk_fma_f32 v[44:45], v[58:59], v[58:59], v[44:45]
    v_pk_fma_f32 v[42:43], v[60:61], v[60:61], v[42:43]
    v_pk_fma_f32 v[44:45], v[62:63], v[62:63], v[44:45]
    v_pk_fma_f32 v[42:43], v[64:65], v[64:65], v[42:43]
    v_pk_fma_f32 v[44:45], v[66:67], v[66:67], v[44:45]
    v_pk_fma_f32 v[42:43], v[68:69], v[68:69], v[42:43]
    v_pk_fma_f32 v[44:45], v[70:71], v[70:71], v[44:45]
    v_pk_add_f32 v[42:43], v[42:43], v[44:45]
    v_add_f32 v41, v42, v43
    s_nop 1
    v_add_f32_dpp v41, v41, v41 quad_perm:[1,0,3,2] row_mask:0xf bank_mask:0xf
    s_nop 1
    v_add_f32_dpp v41, v41, v41 quad_perm:[2,3,0,1] row_mask:0xf bank_mask:0xf
    s_nop 1
    v_add_f32_dpp v41, v41, v41 row_half_mirror row_mask:0xf bank_mask:0xf
    s_nop 1
    v_add_f32_dpp v41, v41, v41 row_mirror row_mask:0xf bank_mask:0xf
    v_mov_b32 v46, v41
    s_nop 1
    v_permlane16_swap_b32 v41, v46
    s_nop 0
    v_add_f32 v41, v41, v46
    v_mul_f32 v41, 0x3acccccd, v41
    v_cvt_pk_bf16_f32 v40, v40, v40
    v_lshlrev_b32 v40, 16, v40
    v_cvt_pk_bf16_f32 v41, v41, v41
    v_lshlrev_b32 v41, 16, v41
    v_add_f32 v41, 0x3727c5ac, v41
    v_cvt_pk_bf16_f32 v41, v41, v41
    v_lshlrev_b32 v41, 16, v41
    v_sqrt_f32 v41, v41
    s_lshl_b32 s50, s40, 4
    v_cvt_pk_bf16_f32 v41, v41, v41
    v_lshlrev_b32 v41, 16, v41
    v_rcp_f32 v41, v41
    s_add_u32 s50, s50, 155648
    v_lshlrev_b32 v36, 3, v36
    v_add_u32 v36, s50, v36
    ds_write_b64 v36, v[40:41]
    s_waitcnt lgkmcnt(0)
    s_cmp_ge_u32 s58, 8
    s_cbranch_scc1 K1_cp_14
    s_mov_b32 exec_lo, 0x003f003f
    s_mov_b32 exec_hi, 0x003f003f
    buffer_store_dwordx4 v[20:23], v11, s[32:35], s57 offen sc1
    s_mov_b64 exec, -1
K1_cp_14:
    s_lshr_b32 s50, s45, 1
    s_lshl_b32 s50, s50, 5
    s_and_b32 s51, s45, 1
    s_lshl3_add_u32 s50, s51, s50
    s_add_u32 s50, s50, s46
    s_lshl_b32 s63, s50, 7
    s_add_u32 s63, s63, 11534336
    s_cmp_lg_u32 s40, 6
    s_cbranch_scc1 K1_dn_15
    v_mov_b32 v16, 0
    v_mov_b32 v17, 0
    s_mov_b64 exec, 1
    buffer_store_dword v16, v17, s[32:35], s63 offen sc1
    s_mov_b64 exec, 0xffff
    v_lshlrev_b32 v16, 2, v1
    v_add_u32 v16, 163776, v16
    ds_write_b32 v16, v17
    s_mov_b64 exec, -1
K1_dn_15:
    s_barrier
    s_cmp_lg_u32 s40, 7
    s_cbranch_scc1 K1_sp_16
    v_lshlrev_b32 v16, 4, v1
    v_add_u32 v12, 155648, v16
    s_mov_b64 exec, 0xff
    ds_read_b128 v[12:15], v12
    s_sub_u32 s50, s59, 14
    s_lshl_b32 s50, s50, 3
    s_add_u32 s50, s50, 9437184
    s_waitcnt lgkmcnt(0)
    buffer_store_dwordx4 v[12:15], v16, s[32:35], s50 offen sc1
    s_mov_b64 exec, -1
K1_sp_16:
    ds_read_b128 v[40:43], v8 offset:0
    ds_read_b64_tr_b16 v[24:25], v2 offset:0
    ds_read_b64_tr_b16 v[26:27], v2 offset:512
    ds_read_b128 v[44:47], v8 offset:2048
    ds_read_b128 v[48:51], v8 offset:4096
    ds_read_b128 v[52:55], v8 offset:6144
    ds_read_b64_tr_b16 v[28:29], v2 offset:12288
    ds_read_b64_tr_b16 v[30:31], v2 offset:12800
    ds_read_b64_tr_b16 v[32:33], v3 offset:0
    ds_read_b64_tr_b16 v[34:35], v3 offset:512
    s_waitcnt lgkmcnt(4)
    v_mfma_f32_16x16x32_bf16 v[72:75], v[24:27], v[40:43], v[72:75]
    ds_read_b64_tr_b16 v[36:37], v3 offset:12288
    v_mfma_f32_16x16x32_bf16 v[76:79], v[24:27], v[44:47], v[76:79]
    ds_read_b64_tr_b16 v[38:39], v3 offset:12800
    v_mfma_f32_16x16x32_bf16 v[80:83], v[24:27], v[48:51], v[80:83]
    v_mfma_f32_16x16x32_bf16 v[84:87], v[24:27], v[52:55], v[84:87]
    s_waitcnt lgkmcnt(4)
    v_mfma_f32_16x16x32_bf16 v[88:91], v[28:31], v[40:43], v[88:91]
    ds_read_b64_tr_b16 v[24:25], v4 offset:0
    v_mfma_f32_16x16x32_bf16 v[92:95], v[28:31], v[44:47], v[92:95]
    ds_read_b64_tr_b16 v[26:27], v4 offset:512
    v_mfma_f32_16x16x32_bf16 v[96:99], v[28:31], v[48:51], v[96:99]
    v_mfma_f32_16x16x32_bf16 v[100:103], v[28:31], v[52:55], v[100:103]
    s_waitcnt lgkmcnt(4)
    v_mfma_f32_16x16x32_bf16 v[104:107], v[32:35], v[40:43], v[104:107]
    ds_read_b64_tr_b16 v[28:29], v4 offset:12288
    v_mfma_f32_16x16x32_bf16 v[108:111], v[32:35], v[44:47], v[108:111]
    ds_read_b64_tr_b16 v[30:31], v4 offset:12800
    v_mfma_f32_16x16x32_bf16 v[112:115], v[32:35], v[48:51], v[112:115]
    v_mfma_f32_16x16x32_bf16 v[116:119], v[32:35], v[52:55], v[116:119]
    s_waitcnt lgkmcnt(4)
    v_mfma_f32_16x16x32_bf16 v[120:123], v[36:39], v[40:43], v[120:123]
    v_mfma_f32_16x16x32_bf16 v[124:127], v[36:39], v[44:47], v[124:127]
    v_mfma_f32_16x16x32_bf16 v[128:131], v[36:39], v[48:51], v[128:131]
    v_mfma_f32_16x16x32_bf16 v[132:135], v[36:39], v[52:55], v[132:135]
    s_waitcnt lgkmcnt(0)
    s_barrier
    v_mfma_f32_16x16x32_bf16 v[136:139], v[24:27], v[40:43], v[136:139]
    ds_read_b128 v[56:59], v9 offset:0
    ds_read_b64_tr_b16 v[32:33], v2 offset:24576
    v_mfma_f32_16x16x32_bf16 v[140:143], v[24:27], v[44:47], v[140:143]
    ds_read_b64_tr_b16 v[34:35], v2 offset:25088
    ds_read_b128 v[60:63], v9 offset:2048
    v_mfma_f32_16x16x32_bf16 v[144:147], v[24:27], v[48:51], v[144:147]
    ds_read_b64_tr_b16 v[36:37], v2 offset:36864
    v_mfma_f32_16x16x32_bf16 v[148:151], v[24:27], v[52:55], v[148:151]
    ds_read_b64_tr_b16 v[38:39], v2 offset:37376
    v_mfma_f32_16x16x32_bf16 v[152:155], v[28:31], v[40:43], v[152:155]
    ds_read_b128 v[64:67], v9 offset:4096
    v_mfma_f32_16x16x32_bf16 v[156:159], v[28:31], v[44:47], v[156:159]
    ds_read_b128 v[68:71], v9 offset:6144
    v_mfma_f32_16x16x32_bf16 v[160:163], v[28:31], v[48:51], v[160:163]
    ds_read_b64_tr_b16 v[24:25], v3 offset:24576
    v_mfma_f32_16x16x32_bf16 v[164:167], v[28:31], v[52:55], v[164:167]
    ds_read_b64_tr_b16 v[26:27], v3 offset:25088
    s_waitcnt lgkmcnt(2)
    v_mfma_f32_16x16x32_bf16 v[72:75], v[32:35], v[56:59], v[72:75]
    ds_read_b64_tr_b16 v[28:29], v3 offset:36864
    v_mfma_f32_16x16x32_bf16 v[76:79], v[32:35], v[60:63], v[76:79]
    ds_read_b64_tr_b16 v[30:31], v3 offset:37376
    v_mfma_f32_16x16x32_bf16 v[80:83], v[32:35], v[64:67], v[80:83]
    v_mfma_f32_16x16x32_bf16 v[84:87], v[32:35], v[68:71], v[84:87]
    v_mfma_f32_16x16x32_bf16 v[88:91], v[36:39], v[56:59], v[88:91]
    ds_read_b64_tr_b16 v[32:33], v4 offset:24576
    v_mfma_f32_16x16x32_bf16 v[92:95], v[36:39], v[60:63], v[92:95]
    ds_read_b64_tr_b16 v[34:35], v4 offset:25088
    v_mfma_f32_16x16x32_bf16 v[96:99], v[36:39], v[64:67], v[96:99]
    v_mfma_f32_16x16x32_bf16 v[100:103], v[36:39], v[68:71], v[100:103]
    s_waitcnt lgkmcnt(4)
    v_mfma_f32_16x16x32_bf16 v[104:107], v[24:27], v[56:59], v[104:107]
    ds_read_b64_tr_b16 v[36:37], v4 offset:36864
    v_mfma_f32_16x16x32_bf16 v[108:111], v[24:27], v[60:63], v[108:111]
    ds_read_b64_tr_b16 v[38:39], v4 offset:37376
    v_mfma_f32_16x16x32_bf16 v[112:115], v[24:27], v[64:67], v[112:115]
    v_mfma_f32_16x16x32_bf16 v[116:119], v[24:27], v[68:71], v[116:119]
    s_waitcnt lgkmcnt(4)
    v_mfma_f32_16x16x32_bf16 v[120:123], v[28:31], v[56:59], v[120:123]
    v_mfma_f32_16x16x32_bf16 v[124:127], v[28:31], v[60:63], v[124:127]
    v_mfma_f32_16x16x32_bf16 v[128:131], v[28:31], v[64:67], v[128:131]
    v_mfma_f32_16x16x32_bf16 v[132:135], v[28:31], v[68:71], v[132:135]
    s_waitcnt lgkmcnt(0)
    s_barrier
    v_mfma_f32_16x16x32_bf16 v[136:139], v[32:35], v[56:59], v[136:139]
    ds_read_b128 v[40:43], v8 offset:16384
    ds_read_b64_tr_b16 v[24:25], v5 offset:0
    v_mfma_f32_16x16x32_bf16 v[140:143], v[32:35], v[60:63], v[140:143]
    ds_read_b64_tr_b16 v[26:27], v5 offset:512
    ds_read_b128 v[44:47], v8 offset:18432
    v_mfma_f32_16x16x32_bf16 v[144:147], v[32:35], v[64:67], v[144:147]
    ds_read_b64_tr_b16 v[28:29], v5 offset:12288
    v_mfma_f32_16x16x32_bf16 v[148:151], v[32:35], v[68:71], v[148:151]
    ds_read_b64_tr_b16 v[30:31], v5 offset:12800
    v_mfma_f32_16x16x32_bf16 v[152:155], v[36:39], v[56:59], v[152:155]
    ds_read_b128 v[48:51], v8 offset:20480
    v_mfma_f32_16x16x32_bf16 v[156:159], v[36:39], v[60:63], v[156:159]
    ds_read_b128 v[52:55], v8 offset:22528
    v_mfma_f32_16x16x32_bf16 v[160:163], v[36:39], v[64:67], v[160:163]
    ds_read_b64_tr_b16 v[32:33], v6 offset:0
    v_mfma_f32_16x16x32_bf16 v[164:167], v[36:39], v[68:71], v[164:167]
    ds_read_b64_tr_b16 v[34:35], v6 offset:512
    s_waitcnt lgkmcnt(2)
    v_mfma_f32_16x16x32_bf16 v[72:75], v[24:27], v[40:43], v[72:75]
    ds_read_b64_tr_b16 v[36:37], v6 offset:12288
    v_mfma_f32_16x16x32_bf16 v[76:79], v[24:27], v[44:47], v[76:79]
    ds_read_b64_tr_b16 v[38:39], v6 offset:12800
    v_mfma_f32_16x16x32_bf16 v[80:83], v[24:27], v[48:51], v[80:83]
    v_mfma_f32_16x16x32_bf16 v[84:87], v[24:27], v[52:55], v[84:87]
    v_mfma_f32_16x16x32_bf16 v[88:91], v[28:31], v[40:43], v[88:91]
    ds_read_b64_tr_b16 v[24:25], v7 offset:0
    v_mfma_f32_16x16x32_bf16 v[92:95], v[28:31], v[44:47], v[92:95]
    ds_read_b64_tr_b16 v[26:27], v7 offset:512
    v_mfma_f32_16x16x32_bf16 v[96:99], v[28:31], v[48:51], v[96:99]
    v_mfma_f32_16x16x32_bf16 v[100:103], v[28:31], v[52:55], v[100:103]
    s_waitcnt lgkmcnt(4)
    v_mfma_f32_16x16x32_bf16 v[104:107], v[32:35], v[40:43], v[104:107]
    ds_read_b64_tr_b16 v[28:29], v7 offset:12288
    v_mfma_f32_16x16x32_bf16 v[108:111], v[32:35], v[44:47], v[108:111]
    ds_read_b64_tr_b16 v[30:31], v7 offset:12800
    v_mfma_f32_16x16x32_bf16 v[112:115], v[32:35], v[48:51], v[112:115]
    v_mfma_f32_16x16x32_bf16 v[116:119], v[32:35], v[52:55], v[116:119]
    s_waitcnt lgkmcnt(4)
    v_mfma_f32_16x16x32_bf16 v[120:123], v[36:39], v[40:43], v[120:123]
    v_mfma_f32_16x16x32_bf16 v[124:127], v[36:39], v[44:47], v[124:127]
    v_mfma_f32_16x16x32_bf16 v[128:131], v[36:39], v[48:51], v[128:131]
    v_mfma_f32_16x16x32_bf16 v[132:135], v[36:39], v[52:55], v[132:135]
    s_waitcnt vmcnt(0)
    s_waitcnt lgkmcnt(0)
    s_barrier
    s_cmp_lg_u32 s40, 7
    s_cbranch_scc1 K1_fs_17
    v_mov_b32 v16, 1
    v_mov_b32 v17, 0
    s_mov_b64 exec, 1
    buffer_store_byte v16, v17, s[36:39], s41 offen sc1
    s_mov_b64 exec, -1
K1_fs_17:
    v_mfma_f32_16x16x32_bf16 v[136:139], v[24:27], v[40:43], v[136:139]
    ds_read_b128 v[56:59], v9 offset:16384
    ds_read_b64_tr_b16 v[32:33], v5 offset:24576
    v_mfma_f32_16x16x32_bf16 v[140:143], v[24:27], v[44:47], v[140:143]
    ds_read_b64_tr_b16 v[34:35], v5 offset:25088
    ds_read_b128 v[60:63], v9 offset:18432
    v_mfma_f32_16x16x32_bf16 v[144:147], v[24:27], v[48:51], v[144:147]
    ds_read_b64_tr_b16 v[36:37], v5 offset:36864
    v_mfma_f32_16x16x32_bf16 v[148:151], v[24:27], v[52:55], v[148:151]
    ds_read_b64_tr_b16 v[38:39], v5 offset:37376
    v_mfma_f32_16x16x32_bf16 v[152:155], v[28:31], v[40:43], v[152:155]
    ds_read_b128 v[64:67], v9 offset:20480
    v_mfma_f32_16x16x32_bf16 v[156:159], v[28:31], v[44:47], v[156:159]
    ds_read_b128 v[68:71], v9 offset:22528
    v_mfma_f32_16x16x32_bf16 v[160:163], v[28:31], v[48:51], v[160:163]
    ds_read_b64_tr_b16 v[24:25], v6 offset:24576
    v_mfma_f32_16x16x32_bf16 v[164:167], v[28:31], v[52:55], v[164:167]
    ds_read_b64_tr_b16 v[26:27], v6 offset:25088
    s_waitcnt lgkmcnt(2)
    v_mfma_f32_16x16x32_bf16 v[72:75], v[32:35], v[56:59], v[72:75]
    ds_read_b64_tr_b16 v[28:29], v6 offset:36864
    v_mfma_f32_16x16x32_bf16 v[76:79], v[32:35], v[60:63], v[76:79]
    ds_read_b64_tr_b16 v[30:31], v6 offset:37376
    v_mfma_f32_16x16x32_bf16 v[80:83], v[32:35], v[64:67], v[80:83]
    v_mfma_f32_16x16x32_bf16 v[84:87], v[32:35], v[68:71], v[84:87]
    v_mfma_f32_16x16x32_bf16 v[88:91], v[36:39], v[56:59], v[88:91]
    ds_read_b64_tr_b16 v[32:33], v7 offset:24576
    v_mfma_f32_16x16x32_bf16 v[92:95], v[36:39], v[60:63], v[92:95]
    ds_read_b64_tr_b16 v[34:35], v7 offset:25088
    v_mfma_f32_16x16x32_bf16 v[96:99], v[36:39], v[64:67], v[96:99]
    v_mfma_f32_16x16x32_bf16 v[100:103], v[36:39], v[68:71], v[100:103]
    s_waitcnt lgkmcnt(4)
    v_mfma_f32_16x16x32_bf16 v[104:107], v[24:27], v[56:59], v[104:107]
    ds_read_b64_tr_b16 v[36:37], v7 offset:36864
    v_mfma_f32_16x16x32_bf16 v[108:111], v[24:27], v[60:63], v[108:111]
    ds_read_b64_tr_b16 v[38:39], v7 offset:37376
    v_mfma_f32_16x16x32_bf16 v[112:115], v[24:27], v[64:67], v[112:115]
    v_mfma_f32_16x16x32_bf16 v[116:119], v[24:27], v[68:71], v[116:119]
    s_waitcnt lgkmcnt(4)
    v_mfma_f32_16x16x32_bf16 v[120:123], v[28:31], v[56:59], v[120:123]
    v_mfma_f32_16x16x32_bf16 v[124:127], v[28:31], v[60:63], v[124:127]
    v_mfma_f32_16x16x32_bf16 v[128:131], v[28:31], v[64:67], v[128:131]
    v_mfma_f32_16x16x32_bf16 v[132:135], v[28:31], v[68:71], v[132:135]
    s_waitcnt lgkmcnt(0)
    s_barrier
    v_mfma_f32_16x16x32_bf16 v[136:139], v[32:35], v[56:59], v[136:139]
    ds_read_b128 v[40:43], v8 offset:32768
    ds_read_b64_tr_b16 v[24:25], v2 offset:0
    v_mfma_f32_16x16x32_bf16 v[140:143], v[32:35], v[60:63], v[140:143]
    ds_read_b64_tr_b16 v[26:27], v2 offset:512
    ds_read_b128 v[44:47], v8 offset:34816
    v_mfma_f32_16x16x32_bf16 v[144:147], v[32:35], v[64:67], v[144:147]
    ds_read_b64_tr_b16 v[28:29], v2 offset:12288
    v_mfma_f32_16x16x32_bf16 v[148:151], v[32:35], v[68:71], v[148:151]
    ds_read_b64_tr_b16 v[30:31], v2 offset:12800
    v_mfma_f32_16x16x32_bf16 v[152:155], v[36:39], v[56:59], v[152:155]
    ds_read_b128 v[48:51], v8 offset:36864
    v_mfma_f32_16x16x32_bf16 v[156:159], v[36:39], v[60:63], v[156:159]
    ds_read_b128 v[52:55], v8 offset:38912
    v_mfma_f32_16x16x32_bf16 v[160:163], v[36:39], v[64:67], v[160:163]
    ds_read_b64_tr_b16 v[32:33], v3 offset:0
    v_mfma_f32_16x16x32_bf16 v[164:167], v[36:39], v[68:71], v[164:167]
    ds_read_b64_tr_b16 v[34:35], v3 offset:512
    s_waitcnt lgkmcnt(2)
    v_mfma_f32_16x16x32_bf16 v[72:75], v[24:27], v[40:43], v[72:75]
    ds_read_b64_tr_b16 v[36:37], v3 offset:12288
    v_mfma_f32_16x16x32_bf16 v[76:79], v[24:27], v[44:47], v[76:79]
    ds_read_b64_tr_b16 v[38:39], v3 offset:12800
    v_mfma_f32_16x16x32_bf16 v[80:83], v[24:27], v[48:51], v[80:83]
    v_mfma_f32_16x16x32_bf16 v[84:87], v[24:27], v[52:55], v[84:87]
    v_mfma_f32_16x16x32_bf16 v[88:91], v[28:31], v[40:43], v[88:91]
    ds_read_b64_tr_b16 v[24:25], v4 offset:0
    v_mfma_f32_16x16x32_bf16 v[92:95], v[28:31], v[44:47], v[92:95]
    ds_read_b64_tr_b16 v[26:27], v4 offset:512
    v_mfma_f32_16x16x32_bf16 v[96:99], v[28:31], v[48:51], v[96:99]
    v_mfma_f32_16x16x32_bf16 v[100:103], v[28:31], v[52:55], v[100:103]
    s_waitcnt lgkmcnt(4)
    v_mfma_f32_16x16x32_bf16 v[104:107], v[32:35], v[40:43], v[104:107]
    ds_read_b64_tr_b16 v[28:29], v4 offset:12288
    v_mfma_f32_16x16x32_bf16 v[108:111], v[32:35], v[44:47], v[108:111]
    ds_read_b64_tr_b16 v[30:31], v4 offset:12800
    v_mfma_f32_16x16x32_bf16 v[112:115], v[32:35], v[48:51], v[112:115]
    v_mfma_f32_16x16x32_bf16 v[116:119], v[32:35], v[52:55], v[116:119]
    s_waitcnt lgkmcnt(4)
    v_mfma_f32_16x16x32_bf16 v[120:123], v[36:39], v[40:43], v[120:123]
    v_mfma_f32_16x16x32_bf16 v[124:127], v[36:39], v[44:47], v[124:127]
    v_mfma_f32_16x16x32_bf16 v[128:131], v[36:39], v[48:51], v[128:131]
    v_mfma_f32_16x16x32_bf16 v[132:135], v[36:39], v[52:55], v[132:135]
    s_waitcnt lgkmcnt(0)
    s_barrier
    v_mfma_f32_16x16x32_bf16 v[136:139], v[24:27], v[40:43], v[136:139]
    ds_read_b128 v[56:59], v9 offset:32768
    ds_read_b64_tr_b16 v[32:33], v2 offset:24576
    v_mfma_f32_16x16x32_bf16 v[140:143], v[24:27], v[44:47], v[140:143]
    ds_read_b64_tr_b16 v[34:35], v2 offset:25088
    ds_read_b128 v[60:63], v9 offset:34816
    v_mfma_f32_16x16x32_bf16 v[144:147], v[24:27], v[48:51], v[144:147]
    ds_read_b64_tr_b16 v[36:37], v2 offset:36864
    v_mfma_f32_16x16x32_bf16 v[148:151], v[24:27], v[52:55], v[148:151]
    ds_read_b64_tr_b16 v[38:39], v2 offset:37376
    v_mfma_f32_16x16x32_bf16 v[152:155], v[28:31], v[40:43], v[152:155]
    ds_read_b128 v[64:67], v9 offset:36864
    v_mfma_f32_16x16x32_bf16 v[156:159], v[28:31], v[44:47], v[156:159]
    ds_read_b128 v[68:71], v9 offset:38912
    v_mfma_f32_16x16x32_bf16 v[160:163], v[28:31], v[48:51], v[160:163]
    ds_read_b64_tr_b16 v[24:25], v3 offset:24576
    v_mfma_f32_16x16x32_bf16 v[164:167], v[28:31], v[52:55], v[164:167]
    ds_read_b64_tr_b16 v[26:27], v3 offset:25088
    s_waitcnt lgkmcnt(2)
    v_mfma_f32_16x16x32_bf16 v[72:75], v[32:35], v[56:59], v[72:75]
    ds_read_b64_tr_b16 v[28:29], v3 offset:36864
    v_mfma_f32_16x16x32_bf16 v[76:79], v[32:35], v[60:63], v[76:79]
    ds_read_b64_tr_b16 v[30:31], v3 offset:37376
    v_mfma_f32_16x16x32_bf16 v[80:83], v[32:35], v[64:67], v[80:83]
    v_mfma_f32_16x16x32_bf16 v[84:87], v[32:35], v[68:71], v[84:87]
    v_mfma_f32_16x16x32_bf16 v[88:91], v[36:39], v[56:59], v[88:91]
    ds_read_b64_tr_b16 v[32:33], v4 offset:24576
    v_mfma_f32_16x16x32_bf16 v[92:95], v[36:39], v[60:63], v[92:95]
    ds_read_b64_tr_b16 v[34:35], v4 offset:25088
    v_mfma_f32_16x16x32_bf16 v[96:99], v[36:39], v[64:67], v[96:99]
    v_mfma_f32_16x16x32_bf16 v[100:103], v[36:39], v[68:71], v[100:103]
    s_waitcnt lgkmcnt(4)
    v_mfma_f32_16x16x32_bf16 v[104:107], v[24:27], v[56:59], v[104:107]
    ds_read_b64_tr_b16 v[36:37], v4 offset:36864
    v_mfma_f32_16x16x32_bf16 v[108:111], v[24:27], v[60:63], v[108:111]
    ds_read_b64_tr_b16 v[38:39], v4 offset:37376
    v_mfma_f32_16x16x32_bf16 v[112:115], v[24:27], v[64:67], v[112:115]
    v_mfma_f32_16x16x32_bf16 v[116:119], v[24:27], v[68:71], v[116:119]
    s_waitcnt lgkmcnt(4)
    v_mfma_f32_16x16x32_bf16 v[120:123], v[28:31], v[56:59], v[120:123]
    v_mfma_f32_16x16x32_bf16 v[124:127], v[28:31], v[60:63], v[124:127]
    v_mfma_f32_16x16x32_bf16 v[128:131], v[28:31], v[64:67], v[128:131]
    v_mfma_f32_16x16x32_bf16 v[132:135], v[28:31], v[68:71], v[132:135]
    s_waitcnt lgkmcnt(0)
    s_barrier
    v_mfma_f32_16x16x32_bf16 v[136:139], v[32:35], v[56:59], v[136:139]
    ds_read_b128 v[40:43], v8 offset:0
    ds_read_b64_tr_b16 v[24:25], v5 offset:0
    v_mfma_f32_16x16x32_bf16 v[140:143], v[32:35], v[60:63], v[140:143]
    ds_read_b64_tr_b16 v[26:27], v5 offset:512
    ds_read_b128 v[44:47], v8 offset:2048
    v_mfma_f32_16x16x32_bf16 v[144:147], v[32:35], v[64:67], v[144:147]
    ds_read_b64_tr_b16 v[28:29], v5 offset:12288
    v_mfma_f32_16x16x32_bf16 v[148:151], v[32:35], v[68:71], v[148:151]
    ds_read_b64_tr_b16 v[30:31], v5 offset:12800
    v_mfma_f32_16x16x32_bf16 v[152:155], v[36:39], v[56:59], v[152:155]
    ds_read_b128 v[48:51], v8 offset:4096
    v_mfma_f32_16x16x32_bf16 v[156:159], v[36:39], v[60:63], v[156:159]
    ds_read_b128 v[52:55], v8 offset:6144
    v_mfma_f32_16x16x32_bf16 v[160:163], v[36:39], v[64:67], v[160:163]
    ds_read_b64_tr_b16 v[32:33], v6 offset:0
    v_mfma_f32_16x16x32_bf16 v[164:167], v[36:39], v[68:71], v[164:167]
    ds_read_b64_tr_b16 v[34:35], v6 offset:512
    s_waitcnt lgkmcnt(2)
    v_mfma_f32_16x16x32_bf16 v[72:75], v[24:27], v[40:43], v[72:75]
    ds_read_b64_tr_b16 v[36:37], v6 offset:12288
    v_mfma_f32_16x16x32_bf16 v[76:79], v[24:27], v[44:47], v[76:79]
    ds_read_b64_tr_b16 v[38:39], v6 offset:12800
    v_mfma_f32_16x16x32_bf16 v[80:83], v[24:27], v[48:51], v[80:83]
    v_mfma_f32_16x16x32_bf16 v[84:87], v[24:27], v[52:55], v[84:87]
    v_mfma_f32_16x16x32_bf16 v[88:91], v[28:31], v[40:43], v[88:91]
    ds_read_b64_tr_b16 v[24:25], v7 offset:0
    v_mfma_f32_16x16x32_bf16 v[92:95], v[28:31], v[44:47], v[92:95]
    ds_read_b64_tr_b16 v[26:27], v7 offset:512
    v_mfma_f32_16x16x32_bf16 v[96:99], v[28:31], v[48:51], v[96:99]
    v_mfma_f32_16x16x32_bf16 v[100:103], v[28:31], v[52:55], v[100:103]
    s_waitcnt lgkmcnt(4)
    v_mfma_f32_16x16x32_bf16 v[104:107], v[32:35], v[40:43], v[104:107]
    ds_read_b64_tr_b16 v[28:29], v7 offset:12288
    v_mfma_f32_16x16x32_bf16 v[108:111], v[32:35], v[44:47], v[108:111]
    ds_read_b64_tr_b16 v[30:31], v7 offset:12800
    v_mfma_f32_16x16x32_bf16 v[112:115], v[32:35], v[48:51], v[112:115]
    v_mfma_f32_16x16x32_bf16 v[116:119], v[32:35], v[52:55], v[116:119]
    s_waitcnt lgkmcnt(4)
    v_mfma_f32_16x16x32_bf16 v[120:123], v[36:39], v[40:43], v[120:123]
    v_mfma_f32_16x16x32_bf16 v[124:127], v[36:39], v[44:47], v[124:127]
    v_mfma_f32_16x16x32_bf16 v[128:131], v[36:39], v[48:51], v[128:131]
    v_mfma_f32_16x16x32_bf16 v[132:135], v[36:39], v[52:55], v[132:135]
    s_waitcnt lgkmcnt(0)
    s_barrier
    v_mfma_f32_16x16x32_bf16 v[136:139], v[24:27], v[40:43], v[136:139]
    ds_read_b128 v[56:59], v9 offset:0
    ds_read_b64_tr_b16 v[32:33], v5 offset:24576
    v_mfma_f32_16x16x32_bf16 v[140:143], v[24:27], v[44:47], v[140:143]
    ds_read_b64_tr_b16 v[34:35], v5 offset:25088
    ds_read_b128 v[60:63], v9 offset:2048
    v_mfma_f32_16x16x32_bf16 v[144:147], v[24:27], v[48:51], v[144:147]
    ds_read_b64_tr_b16 v[36:37], v5 offset:36864
    v_mfma_f32_16x16x32_bf16 v[148:151], v[24:27], v[52:55], v[148:151]
    ds_read_b64_tr_b16 v[38:39], v5 offset:37376
    v_mfma_f32_16x16x32_bf16 v[152:155], v[28:31], v[40:43], v[152:155]
    ds_read_b128 v[64:67], v9 offset:4096
    v_mfma_f32_16x16x32_bf16 v[156:159], v[28:31], v[44:47], v[156:159]
    ds_read_b128 v[68:71], v9 offset:6144
    v_mfma_f32_16x16x32_bf16 v[160:163], v[28:31], v[48:51], v[160:163]
    ds_read_b64_tr_b16 v[24:25], v6 offset:24576
    v_mfma_f32_16x16x32_bf16 v[164:167], v[28:31], v[52:55], v[164:167]
    ds_read_b64_tr_b16 v[26:27], v6 offset:25088
    s_waitcnt lgkmcnt(2)
    v_mfma_f32_16x16x32_bf16 v[72:75], v[32:35], v[56:59], v[72:75]
    ds_read_b64_tr_b16 v[28:29], v6 offset:36864
    v_mfma_f32_16x16x32_bf16 v[76:79], v[32:35], v[60:63], v[76:79]
    ds_read_b64_tr_b16 v[30:31], v6 offset:37376
    v_mfma_f32_16x16x32_bf16 v[80:83], v[32:35], v[64:67], v[80:83]
    v_mfma_f32_16x16x32_bf16 v[84:87], v[32:35], v[68:71], v[84:87]
    v_mfma_f32_16x16x32_bf16 v[88:91], v[36:39], v[56:59], v[88:91]
    ds_read_b64_tr_b16 v[32:33], v7 offset:24576
    v_mfma_f32_16x16x32_bf16 v[92:95], v[36:39], v[60:63], v[92:95]
    ds_read_b64_tr_b16 v[34:35], v7 offset:25088
    v_mfma_f32_16x16x32_bf16 v[96:99], v[36:39], v[64:67], v[96:99]
    v_mfma_f32_16x16x32_bf16 v[100:103], v[36:39], v[68:71], v[100:103]
    s_waitcnt lgkmcnt(4)
    v_mfma_f32_16x16x32_bf16 v[104:107], v[24:27], v[56:59], v[104:107]
    ds_read_b64_tr_b16 v[36:37], v7 offset:36864
    v_mfma_f32_16x16x32_bf16 v[108:111], v[24:27], v[60:63], v[108:111]
    ds_read_b64_tr_b16 v[38:39], v7 offset:37376
    v_mfma_f32_16x16x32_bf16 v[112:115], v[24:27], v[64:67], v[112:115]
    v_mfma_f32_16x16x32_bf16 v[116:119], v[24:27], v[68:71], v[116:119]
    s_waitcnt lgkmcnt(4)
    v_mfma_f32_16x16x32_bf16 v[120:123], v[28:31], v[56:59], v[120:123]
    v_mfma_f32_16x16x32_bf16 v[124:127], v[28:31], v[60:63], v[124:127]
    v_mfma_f32_16x16x32_bf16 v[128:131], v[28:31], v[64:67], v[128:131]
    v_mfma_f32_16x16x32_bf16 v[132:135], v[28:31], v[68:71], v[132:135]
    s_waitcnt lgkmcnt(0)
    s_barrier
    v_mfma_f32_16x16x32_bf16 v[136:139], v[32:35], v[56:59], v[136:139]
    ds_read_b128 v[40:43], v8 offset:16384
    ds_read_b64_tr_b16 v[24:25], v2 offset:0
    v_mfma_f32_16x16x32_bf16 v[140:143], v[32:35], v[60:63], v[140:143]
    ds_read_b64_tr_b16 v[26:27], v2 offset:512
    ds_read_b128 v[44:47], v8 offset:18432
    v_mfma_f32_16x16x32_bf16 v[144:147], v[32:35], v[64:67], v[144:147]
    ds_read_b64_tr_b16 v[28:29], v2 offset:12288
    v_mfma_f32_16x16x32_bf16 v[148:151], v[32:35], v[68:71], v[148:151]
    ds_read_b64_tr_b16 v[30:31], v2 offset:12800
    v_mfma_f32_16x16x32_bf16 v[152:155], v[36:39], v[56:59], v[152:155]
    ds_read_b128 v[48:51], v8 offset:20480
    v_mfma_f32_16x16x32_bf16 v[156:159], v[36:39], v[60:63], v[156:159]
    ds_read_b128 v[52:55], v8 offset:22528
    v_mfma_f32_16x16x32_bf16 v[160:163], v[36:39], v[64:67], v[160:163]
    ds_read_b64_tr_b16 v[32:33], v3 offset:0
    v_mfma_f32_16x16x32_bf16 v[164:167], v[36:39], v[68:71], v[164:167]
    ds_read_b64_tr_b16 v[34:35], v3 offset:512
    s_waitcnt lgkmcnt(2)
    v_mfma_f32_16x16x32_bf16 v[72:75], v[24:27], v[40:43], v[72:75]
    ds_read_b64_tr_b16 v[36:37], v3 offset:12288
    v_mfma_f32_16x16x32_bf16 v[76:79], v[24:27], v[44:47], v[76:79]
    ds_read_b64_tr_b16 v[38:39], v3 offset:12800
    v_mfma_f32_16x16x32_bf16 v[80:83], v[24:27], v[48:51], v[80:83]
    v_mfma_f32_16x16x32_bf16 v[84:87], v[24:27], v[52:55], v[84:87]
    v_mfma_f32_16x16x32_bf16 v[88:91], v[28:31], v[40:43], v[88:91]
    ds_read_b64_tr_b16 v[24:25], v4 offset:0
    v_mfma_f32_16x16x32_bf16 v[92:95], v[28:31], v[44:47], v[92:95]
    ds_read_b64_tr_b16 v[26:27], v4 offset:512
    v_mfma_f32_16x16x32_bf16 v[96:99], v[28:31], v[48:51], v[96:99]
    v_mfma_f32_16x16x32_bf16 v[100:103], v[28:31], v[52:55], v[100:103]
    s_waitcnt lgkmcnt(4)
    v_mfma_f32_16x16x32_bf16 v[104:107], v[32:35], v[40:43], v[104:107]
    ds_read_b64_tr_b16 v[28:29], v4 offset:12288
    v_mfma_f32_16x16x32_bf16 v[108:111], v[32:35], v[44:47], v[108:111]
    ds_read_b64_tr_b16 v[30:31], v4 offset:12800
    v_mfma_f32_16x16x32_bf16 v[112:115], v[32:35], v[48:51], v[112:115]
    v_mfma_f32_16x16x32_bf16 v[116:119], v[32:35], v[52:55], v[116:119]
    s_waitcnt lgkmcnt(4)
    v_mfma_f32_16x16x32_bf16 v[120:123], v[36:39], v[40:43], v[120:123]
    v_mfma_f32_16x16x32_bf16 v[124:127], v[36:39], v[44:47], v[124:127]
    v_mfma_f32_16x16x32_bf16 v[128:131], v[36:39], v[48:51], v[128:131]
    v_mfma_f32_16x16x32_bf16 v[132:135], v[36:39], v[52:55], v[132:135]
    s_waitcnt lgkmcnt(0)
    s_barrier
    v_mfma_f32_16x16x32_bf16 v[136:139], v[24:27], v[40:43], v[136:139]
    ds_read_b128 v[56:59], v9 offset:16384
    ds_read_b64_tr_b16 v[32:33], v2 offset:24576
    v_mfma_f32_16x16x32_bf16 v[140:143], v[24:27], v[44:47], v[140:143]
    ds_read_b64_tr_b16 v[34:35], v2 offset:25088
    ds_read_b128 v[60:63], v9 offset:18432
    v_mfma_f32_16x16x32_bf16 v[144:147], v[24:27], v[48:51], v[144:147]
    ds_read_b64_tr_b16 v[36:37], v2 offset:36864
    v_mfma_f32_16x16x32_bf16 v[148:151], v[24:27], v[52:55], v[148:151]
    ds_read_b64_tr_b16 v[38:39], v2 offset:37376
    v_mfma_f32_16x16x32_bf16 v[152:155], v[28:31], v[40:43], v[152:155]
    ds_read_b128 v[64:67], v9 offset:20480
    v_mfma_f32_16x16x32_bf16 v[156:159], v[28:31], v[44:47], v[156:159]
    ds_read_b128 v[68:71], v9 offset:22528
    v_mfma_f32_16x16x32_bf16 v[160:163], v[28:31], v[48:51], v[160:163]
    ds_read_b64_tr_b16 v[24:25], v3 offset:24576
    v_mfma_f32_16x16x32_bf16 v[164:167], v[28:31], v[52:55], v[164:167]
    ds_read_b64_tr_b16 v[26:27], v3 offset:25088
    s_waitcnt lgkmcnt(2)
    v_mfma_f32_16x16x32_bf16 v[72:75], v[32:35], v[56:59], v[72:75]
    ds_read_b64_tr_b16 v[28:29], v3 offset:36864
    v_mfma_f32_16x16x32_bf16 v[76:79], v[32:35], v[60:63], v[76:79]
    ds_read_b64_tr_b16 v[30:31], v3 offset:37376
    v_mfma_f32_16x16x32_bf16 v[80:83], v[32:35], v[64:67], v[80:83]
    v_mfma_f32_16x16x32_bf16 v[84:87], v[32:35], v[68:71], v[84:87]
    v_mfma_f32_16x16x32_bf16 v[88:91], v[36:39], v[56:59], v[88:91]
    ds_read_b64_tr_b16 v[32:33], v4 offset:24576
    v_mfma_f32_16x16x32_bf16 v[92:95], v[36:39], v[60:63], v[92:95]
    ds_read_b64_tr_b16 v[34:35], v4 offset:25088
    v_mfma_f32_16x16x32_bf16 v[96:99], v[36:39], v[64:67], v[96:99]
    v_mfma_f32_16x16x32_bf16 v[100:103], v[36:39], v[68:71], v[100:103]
    s_waitcnt lgkmcnt(4)
    v_mfma_f32_16x16x32_bf16 v[104:107], v[24:27], v[56:59], v[104:107]
    ds_read_b64_tr_b16 v[36:37], v4 offset:36864
    v_mfma_f32_16x16x32_bf16 v[108:111], v[24:27], v[60:63], v[108:111]
    ds_read_b64_tr_b16 v[38:39], v4 offset:37376
    v_mfma_f32_16x16x32_bf16 v[112:115], v[24:27], v[64:67], v[112:115]
    v_mfma_f32_16x16x32_bf16 v[116:119], v[24:27], v[68:71], v[116:119]
    s_waitcnt lgkmcnt(4)
    v_mfma_f32_16x16x32_bf16 v[120:123], v[28:31], v[56:59], v[120:123]
    v_mfma_f32_16x16x32_bf16 v[124:127], v[28:31], v[60:63], v[124:127]
    v_mfma_f32_16x16x32_bf16 v[128:131], v[28:31], v[64:67], v[128:131]
    v_mfma_f32_16x16x32_bf16 v[132:135], v[28:31], v[68:71], v[132:135]
    s_waitcnt lgkmcnt(0)
    s_barrier
    v_mfma_f32_16x16x32_bf16 v[136:139], v[32:35], v[56:59], v[136:139]
    ds_read_b128 v[40:43], v8 offset:32768
    ds_read_b64_tr_b16 v[24:25], v5 offset:0
    v_mfma_f32_16x16x32_bf16 v[140:143], v[32:35], v[60:63], v[140:143]
    ds_read_b64_tr_b16 v[26:27], v5 offset:512
    ds_read_b128 v[44:47], v8 offset:34816
    v_mfma_f32_16x16x32_bf16 v[144:147], v[32:35], v[64:67], v[144:147]
    ds_read_b64_tr_b16 v[28:29], v5 offset:12288
    v_mfma_f32_16x16x32_bf16 v[148:151], v[32:35], v[68:71], v[148:151]
    ds_read_b64_tr_b16 v[30:31], v5 offset:12800
    v_mfma_f32_16x16x32_bf16 v[152:155], v[36:39], v[56:59], v[152:155]
    ds_read_b128 v[48:51], v8 offset:36864
    v_mfma_f32_16x16x32_bf16 v[156:159], v[36:39], v[60:63], v[156:159]
    ds_read_b128 v[52:55], v8 offset:38912
    v_mfma_f32_16x16x32_bf16 v[160:163], v[36:39], v[64:67], v[160:163]
    ds_read_b64_tr_b16 v[32:33], v6 offset:0
    v_mfma_f32_16x16x32_bf16 v[164:167], v[36:39], v[68:71], v[164:167]
    ds_read_b64_tr_b16 v[34:35], v6 offset:512
    s_waitcnt lgkmcnt(2)
    v_mfma_f32_16x16x32_bf16 v[72:75], v[24:27], v[40:43], v[72:75]
    ds_read_b64_tr_b16 v[36:37], v6 offset:12288
    v_mfma_f32_16x16x32_bf16 v[76:79], v[24:27], v[44:47], v[76:79]
    ds_read_b64_tr_b16 v[38:39], v6 offset:12800
    v_mfma_f32_16x16x32_bf16 v[80:83], v[24:27], v[48:51], v[80:83]
    v_mfma_f32_16x16x32_bf16 v[84:87], v[24:27], v[52:55], v[84:87]
    v_mfma_f32_16x16x32_bf16 v[88:91], v[28:31], v[40:43], v[88:91]
    ds_read_b64_tr_b16 v[24:25], v7 offset:0
    v_mfma_f32_16x16x32_bf16 v[92:95], v[28:31], v[44:47], v[92:95]
    ds_read_b64_tr_b16 v[26:27], v7 offset:512
    v_mfma_f32_16x16x32_bf16 v[96:99], v[28:31], v[48:51], v[96:99]
    v_mfma_f32_16x16x32_bf16 v[100:103], v[28:31], v[52:55], v[100:103]
    s_waitcnt lgkmcnt(4)
    v_mfma_f32_16x16x32_bf16 v[104:107], v[32:35], v[40:43], v[104:107]
    ds_read_b64_tr_b16 v[28:29], v7 offset:12288
    v_mfma_f32_16x16x32_bf16 v[108:111], v[32:35], v[44:47], v[108:111]
    ds_read_b64_tr_b16 v[30:31], v7 offset:12800
    v_mfma_f32_16x16x32_bf16 v[112:115], v[32:35], v[48:51], v[112:115]
    v_mfma_f32_16x16x32_bf16 v[116:119], v[32:35], v[52:55], v[116:119]
    s_waitcnt lgkmcnt(4)
    v_mfma_f32_16x16x32_bf16 v[120:123], v[36:39], v[40:43], v[120:123]
    v_mfma_f32_16x16x32_bf16 v[124:127], v[36:39], v[44:47], v[124:127]
    v_mfma_f32_16x16x32_bf16 v[128:131], v[36:39], v[48:51], v[128:131]
    v_mfma_f32_16x16x32_bf16 v[132:135], v[36:39], v[52:55], v[132:135]
    s_waitcnt lgkmcnt(0)
    s_barrier
    v_mfma_f32_16x16x32_bf16 v[136:139], v[24:27], v[40:43], v[136:139]
    ds_read_b128 v[56:59], v9 offset:32768
    ds_read_b64_tr_b16 v[32:33], v5 offset:24576
    v_mfma_f32_16x16x32_bf16 v[140:143], v[24:27], v[44:47], v[140:143]
    ds_read_b64_tr_b16 v[34:35], v5 offset:25088
    ds_read_b128 v[60:63], v9 offset:34816
    v_mfma_f32_16x16x32_bf16 v[144:147], v[24:27], v[48:51], v[144:147]
    ds_read_b64_tr_b16 v[36:37], v5 offset:36864
    v_mfma_f32_16x16x32_bf16 v[148:151], v[24:27], v[52:55], v[148:151]
    ds_read_b64_tr_b16 v[38:39], v5 offset:37376
    v_mfma_f32_16x16x32_bf16 v[152:155], v[28:31], v[40:43], v[152:155]
    ds_read_b128 v[64:67], v9 offset:36864
    v_mfma_f32_16x16x32_bf16 v[156:159], v[28:31], v[44:47], v[156:159]
    ds_read_b128 v[68:71], v9 offset:38912
    v_mfma_f32_16x16x32_bf16 v[160:163], v[28:31], v[48:51], v[160:163]
    ds_read_b64_tr_b16 v[24:25], v6 offset:24576
    v_mfma_f32_16x16x32_bf16 v[164:167], v[28:31], v[52:55], v[164:167]
    ds_read_b64_tr_b16 v[26:27], v6 offset:25088
    s_waitcnt lgkmcnt(2)
    v_mfma_f32_16x16x32_bf16 v[72:75], v[32:35], v[56:59], v[72:75]
    ds_read_b64_tr_b16 v[28:29], v6 offset:36864
    v_mfma_f32_16x16x32_bf16 v[76:79], v[32:35], v[60:63], v[76:79]
    ds_read_b64_tr_b16 v[30:31], v6 offset:37376
    v_mfma_f32_16x16x32_bf16 v[80:83], v[32:35], v[64:67], v[80:83]
    v_mfma_f32_16x16x32_bf16 v[84:87], v[32:35], v[68:71], v[84:87]
    v_mfma_f32_16x16x32_bf16 v[88:91], v[36:39], v[56:59], v[88:91]
    ds_read_b64_tr_b16 v[32:33], v7 offset:24576
    v_mfma_f32_16x16x32_bf16 v[92:95], v[36:39], v[60:63], v[92:95]
    ds_read_b64_tr_b16 v[34:35], v7 offset:25088
    v_mfma_f32_16x16x32_bf16 v[96:99], v[36:39], v[64:67], v[96:99]
    v_mfma_f32_16x16x32_bf16 v[100:103], v[36:39], v[68:71], v[100:103]
    s_waitcnt lgkmcnt(4)
    v_mfma_f32_16x16x32_bf16 v[104:107], v[24:27], v[56:59], v[104:107]
    ds_read_b64_tr_b16 v[36:37], v7 offset:36864
    v_mfma_f32_16x16x32_bf16 v[108:111], v[24:27], v[60:63], v[108:111]
    ds_read_b64_tr_b16 v[38:39], v7 offset:37376
    v_mfma_f32_16x16x32_bf16 v[112:115], v[24:27], v[64:67], v[112:115]
    v_mfma_f32_16x16x32_bf16 v[116:119], v[24:27], v[68:71], v[116:119]
    s_waitcnt lgkmcnt(4)
    v_mfma_f32_16x16x32_bf16 v[120:123], v[28:31], v[56:59], v[120:123]
    v_mfma_f32_16x16x32_bf16 v[124:127], v[28:31], v[60:63], v[124:127]
    v_mfma_f32_16x16x32_bf16 v[128:131], v[28:31], v[64:67], v[128:131]
    v_mfma_f32_16x16x32_bf16 v[132:135], v[28:31], v[68:71], v[132:135]
    s_waitcnt lgkmcnt(0)
    s_barrier
    v_mfma_f32_16x16x32_bf16 v[136:139], v[32:35], v[56:59], v[136:139]
    ds_read_b128 v[40:43], v8 offset:0
    ds_read_b64_tr_b16 v[24:25], v2 offset:0
    v_mfma_f32_16x16x32_bf16 v[140:143], v[32:35], v[60:63], v[140:143]
    ds_read_b64_tr_b16 v[26:27], v2 offset:512
    ds_read_b128 v[44:47], v8 offset:2048
    v_mfma_f32_16x16x32_bf16 v[144:147], v[32:35], v[64:67], v[144:147]
    ds_read_b64_tr_b16 v[28:29], v2 offset:12288
    v_mfma_f32_16x16x32_bf16 v[148:151], v[32:35], v[68:71], v[148:151]
    ds_read_b64_tr_b16 v[30:31], v2 offset:12800
    v_mfma_f32_16x16x32_bf16 v[152:155], v[36:39], v[56:59], v[152:155]
    ds_read_b128 v[48:51], v8 offset:4096
    v_mfma_f32_16x16x32_bf16 v[156:159], v[36:39], v[60:63], v[156:159]
    ds_read_b128 v[52:55], v8 offset:6144
    v_mfma_f32_16x16x32_bf16 v[160:163], v[36:39], v[64:67], v[160:163]
    ds_read_b64_tr_b16 v[32:33], v3 offset:0
    v_mfma_f32_16x16x32_bf16 v[164:167], v[36:39], v[68:71], v[164:167]
    ds_read_b64_tr_b16 v[34:35], v3 offset:512
    s_waitcnt lgkmcnt(2)
    v_mfma_f32_16x16x32_bf16 v[72:75], v[24:27], v[40:43], v[72:75]
    ds_read_b64_tr_b16 v[36:37], v3 offset:12288
    v_mfma_f32_16x16x32_bf16 v[76:79], v[24:27], v[44:47], v[76:79]
    ds_read_b64_tr_b16 v[38:39], v3 offset:12800
    v_mfma_f32_16x16x32_bf16 v[80:83], v[24:27], v[48:51], v[80:83]
    v_mfma_f32_16x16x32_bf16 v[84:87], v[24:27], v[52:55], v[84:87]
    v_mfma_f32_16x16x32_bf16 v[88:91], v[28:31], v[40:43], v[88:91]
    ds_read_b64_tr_b16 v[24:25], v4 offset:0
    v_mfma_f32_16x16x32_bf16 v[92:95], v[28:31], v[44:47], v[92:95]
    ds_read_b64_tr_b16 v[26:27], v4 offset:512
    v_mfma_f32_16x16x32_bf16 v[96:99], v[28:31], v[48:51], v[96:99]
    v_mfma_f32_16x16x32_bf16 v[100:103], v[28:31], v[52:55], v[100:103]
    s_waitcnt lgkmcnt(4)
    v_mfma_f32_16x16x32_bf16 v[104:107], v[32:35], v[40:43], v[104:107]
    ds_read_b64_tr_b16 v[28:29], v4 offset:12288
    v_mfma_f32_16x16x32_bf16 v[108:111], v[32:35], v[44:47], v[108:111]
    ds_read_b64_tr_b16 v[30:31], v4 offset:12800
    v_mfma_f32_16x16x32_bf16 v[112:115], v[32:35], v[48:51], v[112:115]
    v_mfma_f32_16x16x32_bf16 v[116:119], v[32:35], v[52:55], v[116:119]
    s_waitcnt lgkmcnt(4)
    v_mfma_f32_16x16x32_bf16 v[120:123], v[36:39], v[40:43], v[120:123]
    v_mfma_f32_16x16x32_bf16 v[124:127], v[36:39], v[44:47], v[124:127]
    v_mfma_f32_16x16x32_bf16 v[128:131], v[36:39], v[48:51], v[128:131]
    v_mfma_f32_16x16x32_bf16 v[132:135], v[36:39], v[52:55], v[132:135]
    s_waitcnt lgkmcnt(0)
    s_barrier
    v_mfma_f32_16x16x32_bf16 v[136:139], v[24:27], v[40:43], v[136:139]
    ds_read_b128 v[56:59], v9 offset:0
    ds_read_b64_tr_b16 v[32:33], v2 offset:24576
    v_mfma_f32_16x16x32_bf16 v[140:143], v[24:27], v[44:47], v[140:143]
    ds_read_b64_tr_b16 v[34:35], v2 offset:25088
    ds_read_b128 v[60:63], v9 offset:2048
    v_mfma_f32_16x16x32_bf16 v[144:147], v[24:27], v[48:51], v[144:147]
    ds_read_b64_tr_b16 v[36:37], v2 offset:36864
    v_mfma_f32_16x16x32_bf16 v[148:151], v[24:27], v[52:55], v[148:151]
    ds_read_b64_tr_b16 v[38:39], v2 offset:37376
    v_mfma_f32_16x16x32_bf16 v[152:155], v[28:31], v[40:43], v[152:155]
    ds_read_b128 v[64:67], v9 offset:4096
    v_mfma_f32_16x16x32_bf16 v[156:159], v[28:31], v[44:47], v[156:159]
    ds_read_b128 v[68:71], v9 offset:6144
    v_mfma_f32_16x16x32_bf16 v[160:163], v[28:31], v[48:51], v[160:163]
    ds_read_b64_tr_b16 v[24:25], v3 offset:24576
    v_mfma_f32_16x16x32_bf16 v[164:167], v[28:31], v[52:55], v[164:167]
    ds_read_b64_tr_b16 v[26:27], v3 offset:25088
    s_waitcnt lgkmcnt(2)
    v_mfma_f32_16x16x32_bf16 v[72:75], v[32:35], v[56:59], v[72:75]
    ds_read_b64_tr_b16 v[28:29], v3 offset:36864
    v_mfma_f32_16x16x32_bf16 v[76:79], v[32:35], v[60:63], v[76:79]
    ds_read_b64_tr_b16 v[30:31], v3 offset:37376
    v_mfma_f32_16x16x32_bf16 v[80:83], v[32:35], v[64:67], v[80:83]
    v_mfma_f32_16x16x32_bf16 v[84:87], v[32:35], v[68:71], v[84:87]
    v_mfma_f32_16x16x32_bf16 v[88:91], v[36:39], v[56:59], v[88:91]
    ds_read_b64_tr_b16 v[32:33], v4 offset:24576
    v_mfma_f32_16x16x32_bf16 v[92:95], v[36:39], v[60:63], v[92:95]
    ds_read_b64_tr_b16 v[34:35], v4 offset:25088
    v_mfma_f32_16x16x32_bf16 v[96:99], v[36:39], v[64:67], v[96:99]
    v_mfma_f32_16x16x32_bf16 v[100:103], v[36:39], v[68:71], v[100:103]
    s_waitcnt lgkmcnt(4)
    v_mfma_f32_16x16x32_bf16 v[104:107], v[24:27], v[56:59], v[104:107]
    ds_read_b64_tr_b16 v[36:37], v4 offset:36864
    v_mfma_f32_16x16x32_bf16 v[108:111], v[24:27], v[60:63], v[108:111]
    ds_read_b64_tr_b16 v[38:39], v4 offset:37376
    v_mfma_f32_16x16x32_bf16 v[112:115], v[24:27], v[64:67], v[112:115]
    v_mfma_f32_16x16x32_bf16 v[116:119], v[24:27], v[68:71], v[116:119]
    s_waitcnt lgkmcnt(4)
    v_mfma_f32_16x16x32_bf16 v[120:123], v[28:31], v[56:59], v[120:123]
    v_mfma_f32_16x16x32_bf16 v[124:127], v[28:31], v[60:63], v[124:127]
    v_mfma_f32_16x16x32_bf16 v[128:131], v[28:31], v[64:67], v[128:131]
    v_mfma_f32_16x16x32_bf16 v[132:135], v[28:31], v[68:71], v[132:135]
    s_waitcnt lgkmcnt(0)
    s_barrier
    v_mfma_f32_16x16x32_bf16 v[136:139], v[32:35], v[56:59], v[136:139]
    ds_read_b128 v[40:43], v8 offset:16384
    ds_read_b64_tr_b16 v[24:25], v5 offset:0
    v_mfma_f32_16x16x32_bf16 v[140:143], v[32:35], v[60:63], v[140:143]
    ds_read_b64_tr_b16 v[26:27], v5 offset:512
    ds_read_b128 v[44:47], v8 offset:18432
    v_mfma_f32_16x16x32_bf16 v[144:147], v[32:35], v[64:67], v[144:147]
    ds_read_b64_tr_b16 v[28:29], v5 offset:12288
    v_mfma_f32_16x16x32_bf16 v[148:151], v[32:35], v[68:71], v[148:151]
    ds_read_b64_tr_b16 v[30:31], v5 offset:12800
    v_mfma_f32_16x16x32_bf16 v[152:155], v[36:39], v[56:59], v[152:155]
    ds_read_b128 v[48:51], v8 offset:20480
    v_mfma_f32_16x16x32_bf16 v[156:159], v[36:39], v[60:63], v[156:159]
    ds_read_b128 v[52:55], v8 offset:22528
    v_mfma_f32_16x16x32_bf16 v[160:163], v[36:39], v[64:67], v[160:163]
    ds_read_b64_tr_b16 v[32:33], v6 offset:0
    v_mfma_f32_16x16x32_bf16 v[164:167], v[36:39], v[68:71], v[164:167]
    ds_read_b64_tr_b16 v[34:35], v6 offset:512
    s_waitcnt lgkmcnt(2)
    v_mfma_f32_16x16x32_bf16 v[72:75], v[24:27], v[40:43], v[72:75]
    ds_read_b64_tr_b16 v[36:37], v6 offset:12288
    v_mfma_f32_16x16x32_bf16 v[76:79], v[24:27], v[44:47], v[76:79]
    ds_read_b64_tr_b16 v[38:39], v6 offset:12800
    v_mfma_f32_16x16x32_bf16 v[80:83], v[24:27], v[48:51], v[80:83]
    v_mfma_f32_16x16x32_bf16 v[84:87], v[24:27], v[52:55], v[84:87]
    v_mfma_f32_16x16x32_bf16 v[88:91], v[28:31], v[40:43], v[88:91]
    ds_read_b64_tr_b16 v[24:25], v7 offset:0
    v_mfma_f32_16x16x32_bf16 v[92:95], v[28:31], v[44:47], v[92:95]
    ds_read_b64_tr_b16 v[26:27], v7 offset:512
    v_mfma_f32_16x16x32_bf16 v[96:99], v[28:31], v[48:51], v[96:99]
    v_mfma_f32_16x16x32_bf16 v[100:103], v[28:31], v[52:55], v[100:103]
    s_waitcnt lgkmcnt(4)
    v_mfma_f32_16x16x32_bf16 v[104:107], v[32:35], v[40:43], v[104:107]
    ds_read_b64_tr_b16 v[28:29], v7 offset:12288
    v_mfma_f32_16x16x32_bf16 v[108:111], v[32:35], v[44:47], v[108:111]
    ds_read_b64_tr_b16 v[30:31], v7 offset:12800
    v_mfma_f32_16x16x32_bf16 v[112:115], v[32:35], v[48:51], v[112:115]
    v_mfma_f32_16x16x32_bf16 v[116:119], v[32:35], v[52:55], v[116:119]
    s_waitcnt lgkmcnt(4)
    v_mfma_f32_16x16x32_bf16 v[120:123], v[36:39], v[40:43], v[120:123]
    v_mfma_f32_16x16x32_bf16 v[124:127], v[36:39], v[44:47], v[124:127]
    v_mfma_f32_16x16x32_bf16 v[128:131], v[36:39], v[48:51], v[128:131]
    v_mfma_f32_16x16x32_bf16 v[132:135], v[36:39], v[52:55], v[132:135]
    s_waitcnt lgkmcnt(0)
    s_barrier
    v_mfma_f32_16x16x32_bf16 v[136:139], v[24:27], v[40:43], v[136:139]
    ds_read_b128 v[56:59], v9 offset:16384
    ds_read_b64_tr_b16 v[32:33], v5 offset:24576
    v_mfma_f32_16x16x32_bf16 v[140:143], v[24:27], v[44:47], v[140:143]
    ds_read_b64_tr_b16 v[34:35], v5 offset:25088
    ds_read_b128 v[60:63], v9 offset:18432
    v_mfma_f32_16x16x32_bf16 v[144:147], v[24:27], v[48:51], v[144:147]
    ds_read_b64_tr_b16 v[36:37], v5 offset:36864
    v_mfma_f32_16x16x32_bf16 v[148:151], v[24:27], v[52:55], v[148:151]
    ds_read_b64_tr_b16 v[38:39], v5 offset:37376
    v_mfma_f32_16x16x32_bf16 v[152:155], v[28:31], v[40:43], v[152:155]
    ds_read_b128 v[64:67], v9 offset:20480
    v_mfma_f32_16x16x32_bf16 v[156:159], v[28:31], v[44:47], v[156:159]
    ds_read_b128 v[68:71], v9 offset:22528
    v_mfma_f32_16x16x32_bf16 v[160:163], v[28:31], v[48:51], v[160:163]
    ds_read_b64_tr_b16 v[24:25], v6 offset:24576
    v_mfma_f32_16x16x32_bf16 v[164:167], v[28:31], v[52:55], v[164:167]
    ds_read_b64_tr_b16 v[26:27], v6 offset:25088
    s_waitcnt lgkmcnt(2)
    v_mfma_f32_16x16x32_bf16 v[72:75], v[32:35], v[56:59], v[72:75]
    ds_read_b64_tr_b16 v[28:29], v6 offset:36864
    v_mfma_f32_16x16x32_bf16 v[76:79], v[32:35], v[60:63], v[76:79]
    ds_read_b64_tr_b16 v[30:31], v6 offset:37376
    v_mfma_f32_16x16x32_bf16 v[80:83], v[32:35], v[64:67], v[80:83]
    v_mfma_f32_16x16x32_bf16 v[84:87], v[32:35], v[68:71], v[84:87]
    v_mfma_f32_16x16x32_bf16 v[88:91], v[36:39], v[56:59], v[88:91]
    ds_read_b64_tr_b16 v[32:33], v7 offset:24576
    v_mfma_f32_16x16x32_bf16 v[92:95], v[36:39], v[60:63], v[92:95]
    ds_read_b64_tr_b16 v[34:35], v7 offset:25088
    v_mfma_f32_16x16x32_bf16 v[96:99], v[36:39], v[64:67], v[96:99]
    v_mfma_f32_16x16x32_bf16 v[100:103], v[36:39], v[68:71], v[100:103]
    s_waitcnt lgkmcnt(4)
    v_mfma_f32_16x16x32_bf16 v[104:107], v[24:27], v[56:59], v[104:107]
    ds_read_b64_tr_b16 v[36:37], v7 offset:36864
    v_mfma_f32_16x16x32_bf16 v[108:111], v[24:27], v[60:63], v[108:111]
    ds_read_b64_tr_b16 v[38:39], v7 offset:37376
    v_mfma_f32_16x16x32_bf16 v[112:115], v[24:27], v[64:67], v[112:115]
    v_mfma_f32_16x16x32_bf16 v[116:119], v[24:27], v[68:71], v[116:119]
    s_waitcnt lgkmcnt(4)
    v_mfma_f32_16x16x32_bf16 v[120:123], v[28:31], v[56:59], v[120:123]
    v_mfma_f32_16x16x32_bf16 v[124:127], v[28:31], v[60:63], v[124:127]
    v_mfma_f32_16x16x32_bf16 v[128:131], v[28:31], v[64:67], v[128:131]
    v_mfma_f32_16x16x32_bf16 v[132:135], v[28:31], v[68:71], v[132:135]
    s_waitcnt lgkmcnt(0)
    s_barrier
    v_mfma_f32_16x16x32_bf16 v[136:139], v[32:35], v[56:59], v[136:139]
    ds_read_b128 v[40:43], v8 offset:32768
    ds_read_b64_tr_b16 v[24:25], v2 offset:0
    v_mfma_f32_16x16x32_bf16 v[140:143], v[32:35], v[60:63], v[140:143]
    ds_read_b64_tr_b16 v[26:27], v2 offset:512
    ds_read_b128 v[44:47], v8 offset:34816
    v_mfma_f32_16x16x32_bf16 v[144:147], v[32:35], v[64:67], v[144:147]
    ds_read_b64_tr_b16 v[28:29], v2 offset:12288
    v_mfma_f32_16x16x32_bf16 v[148:151], v[32:35], v[68:71], v[148:151]
    ds_read_b64_tr_b16 v[30:31], v2 offset:12800
    v_mfma_f32_16x16x32_bf16 v[152:155], v[36:39], v[56:59], v[152:155]
    ds_read_b128 v[48:51], v8 offset:36864
    v_mfma_f32_16x16x32_bf16 v[156:159], v[36:39], v[60:63], v[156:159]
    ds_read_b128 v[52:55], v8 offset:38912
    v_mfma_f32_16x16x32_bf16 v[160:163], v[36:39], v[64:67], v[160:163]
    ds_read_b64_tr_b16 v[32:33], v3 offset:0
    v_mfma_f32_16x16x32_bf16 v[164:167], v[36:39], v[68:71], v[164:167]
    ds_read_b64_tr_b16 v[34:35], v3 offset:512
    s_waitcnt lgkmcnt(2)
    v_mfma_f32_16x16x32_bf16 v[72:75], v[24:27], v[40:43], v[72:75]
    ds_read_b64_tr_b16 v[36:37], v3 offset:12288
    v_mfma_f32_16x16x32_bf16 v[76:79], v[24:27], v[44:47], v[76:79]
    ds_read_b64_tr_b16 v[38:39], v3 offset:12800
    v_mfma_f32_16x16x32_bf16 v[80:83], v[24:27], v[48:51], v[80:83]
    v_mfma_f32_16x16x32_bf16 v[84:87], v[24:27], v[52:55], v[84:87]
    v_mfma_f32_16x16x32_bf16 v[88:91], v[28:31], v[40:43], v[88:91]
    ds_read_b64_tr_b16 v[24:25], v4 offset:0
    v_mfma_f32_16x16x32_bf16 v[92:95], v[28:31], v[44:47], v[92:95]
    ds_read_b64_tr_b16 v[26:27], v4 offset:512
    v_mfma_f32_16x16x32_bf16 v[96:99], v[28:31], v[48:51], v[96:99]
    v_mfma_f32_16x16x32_bf16 v[100:103], v[28:31], v[52:55], v[100:103]
    s_waitcnt lgkmcnt(4)
    v_mfma_f32_16x16x32_bf16 v[104:107], v[32:35], v[40:43], v[104:107]
    ds_read_b64_tr_b16 v[28:29], v4 offset:12288
    v_mfma_f32_16x16x32_bf16 v[108:111], v[32:35], v[44:47], v[108:111]
    ds_read_b64_tr_b16 v[30:31], v4 offset:12800
    v_mfma_f32_16x16x32_bf16 v[112:115], v[32:35], v[48:51], v[112:115]
    v_mfma_f32_16x16x32_bf16 v[116:119], v[32:35], v[52:55], v[116:119]
    s_waitcnt lgkmcnt(4)
    v_mfma_f32_16x16x32_bf16 v[120:123], v[36:39], v[40:43], v[120:123]
    v_mfma_f32_16x16x32_bf16 v[124:127], v[36:39], v[44:47], v[124:127]
    v_mfma_f32_16x16x32_bf16 v[128:131], v[36:39], v[48:51], v[128:131]
    v_mfma_f32_16x16x32_bf16 v[132:135], v[36:39], v[52:55], v[132:135]
    s_waitcnt lgkmcnt(0)
    s_barrier
    v_mfma_f32_16x16x32_bf16 v[136:139], v[24:27], v[40:43], v[136:139]
    ds_read_b128 v[56:59], v9 offset:32768
    ds_read_b64_tr_b16 v[32:33], v2 offset:24576
    v_mfma_f32_16x16x32_bf16 v[140:143], v[24:27], v[44:47], v[140:143]
    ds_read_b64_tr_b16 v[34:35], v2 offset:25088
    ds_read_b128 v[60:63], v9 offset:34816
    v_mfma_f32_16x16x32_bf16 v[144:147], v[24:27], v[48:51], v[144:147]
    ds_read_b64_tr_b16 v[36:37], v2 offset:36864
    v_mfma_f32_16x16x32_bf16 v[148:151], v[24:27], v[52:55], v[148:151]
    ds_read_b64_tr_b16 v[38:39], v2 offset:37376
    v_mfma_f32_16x16x32_bf16 v[152:155], v[28:31], v[40:43], v[152:155]
    ds_read_b128 v[64:67], v9 offset:36864
    v_mfma_f32_16x16x32_bf16 v[156:159], v[28:31], v[44:47], v[156:159]
    ds_read_b128 v[68:71], v9 offset:38912
    v_mfma_f32_16x16x32_bf16 v[160:163], v[28:31], v[48:51], v[160:163]
    ds_read_b64_tr_b16 v[24:25], v3 offset:24576
    v_mfma_f32_16x16x32_bf16 v[164:167], v[28:31], v[52:55], v[164:167]
    ds_read_b64_tr_b16 v[26:27], v3 offset:25088
    s_waitcnt lgkmcnt(2)
    v_mfma_f32_16x16x32_bf16 v[72:75], v[32:35], v[56:59], v[72:75]
    ds_read_b64_tr_b16 v[28:29], v3 offset:36864
    v_mfma_f32_16x16x32_bf16 v[76:79], v[32:35], v[60:63], v[76:79]
    ds_read_b64_tr_b16 v[30:31], v3 offset:37376
    v_mfma_f32_16x16x32_bf16 v[80:83], v[32:35], v[64:67], v[80:83]
    v_mfma_f32_16x16x32_bf16 v[84:87], v[32:35], v[68:71], v[84:87]
    v_mfma_f32_16x16x32_bf16 v[88:91], v[36:39], v[56:59], v[88:91]
    ds_read_b64_tr_b16 v[32:33], v4 offset:24576
    v_mfma_f32_16x16x32_bf16 v[92:95], v[36:39], v[60:63], v[92:95]
    ds_read_b64_tr_b16 v[34:35], v4 offset:25088
    v_mfma_f32_16x16x32_bf16 v[96:99], v[36:39], v[64:67], v[96:99]
    v_mfma_f32_16x16x32_bf16 v[100:103], v[36:39], v[68:71], v[100:103]
    s_waitcnt lgkmcnt(4)
    v_mfma_f32_16x16x32_bf16 v[104:107], v[24:27], v[56:59], v[104:107]
    ds_read_b64_tr_b16 v[36:37], v4 offset:36864
    v_mfma_f32_16x16x32_bf16 v[108:111], v[24:27], v[60:63], v[108:111]
    ds_read_b64_tr_b16 v[38:39], v4 offset:37376
    v_mfma_f32_16x16x32_bf16 v[112:115], v[24:27], v[64:67], v[112:115]
    v_mfma_f32_16x16x32_bf16 v[116:119], v[24:27], v[68:71], v[116:119]
    s_waitcnt lgkmcnt(4)
    v_mfma_f32_16x16x32_bf16 v[120:123], v[28:31], v[56:59], v[120:123]
    v_mfma_f32_16x16x32_bf16 v[124:127], v[28:31], v[60:63], v[124:127]
    v_mfma_f32_16x16x32_bf16 v[128:131], v[28:31], v[64:67], v[128:131]
    v_mfma_f32_16x16x32_bf16 v[132:135], v[28:31], v[68:71], v[132:135]
    s_waitcnt lgkmcnt(0)
    s_barrier
    v_mfma_f32_16x16x32_bf16 v[136:139], v[32:35], v[56:59], v[136:139]
    ds_read_b128 v[40:43], v8 offset:0
    ds_read_b64_tr_b16 v[24:25], v5 offset:0
    v_mfma_f32_16x16x32_bf16 v[140:143], v[32:35], v[60:63], v[140:143]
    ds_read_b64_tr_b16 v[26:27], v5 offset:512
    ds_read_b128 v[44:47], v8 offset:2048
    v_mfma_f32_16x16x32_bf16 v[144:147], v[32:35], v[64:67], v[144:147]
    ds_read_b64_tr_b16 v[28:29], v5 offset:12288
    v_mfma_f32_16x16x32_bf16 v[148:151], v[32:35], v[68:71], v[148:151]
    ds_read_b64_tr_b16 v[30:31], v5 offset:12800
    v_mfma_f32_16x16x32_bf16 v[152:155], v[36:39], v[56:59], v[152:155]
    ds_read_b128 v[48:51], v8 offset:4096
    v_mfma_f32_16x16x32_bf16 v[156:159], v[36:39], v[60:63], v[156:159]
    ds_read_b128 v[52:55], v8 offset:6144
    v_mfma_f32_16x16x32_bf16 v[160:163], v[36:39], v[64:67], v[160:163]
    ds_read_b64_tr_b16 v[32:33], v6 offset:0
    v_mfma_f32_16x16x32_bf16 v[164:167], v[36:39], v[68:71], v[164:167]
    ds_read_b64_tr_b16 v[34:35], v6 offset:512
    s_waitcnt lgkmcnt(2)
    v_mfma_f32_16x16x32_bf16 v[72:75], v[24:27], v[40:43], v[72:75]
    ds_read_b64_tr_b16 v[36:37], v6 offset:12288
    v_mfma_f32_16x16x32_bf16 v[76:79], v[24:27], v[44:47], v[76:79]
    ds_read_b64_tr_b16 v[38:39], v6 offset:12800
    v_mfma_f32_16x16x32_bf16 v[80:83], v[24:27], v[48:51], v[80:83]
    v_mfma_f32_16x16x32_bf16 v[84:87], v[24:27], v[52:55], v[84:87]
    v_mfma_f32_16x16x32_bf16 v[88:91], v[28:31], v[40:43], v[88:91]
    ds_read_b64_tr_b16 v[24:25], v7 offset:0
    v_mfma_f32_16x16x32_bf16 v[92:95], v[28:31], v[44:47], v[92:95]
    ds_read_b64_tr_b16 v[26:27], v7 offset:512
    v_mfma_f32_16x16x32_bf16 v[96:99], v[28:31], v[48:51], v[96:99]
    v_mfma_f32_16x16x32_bf16 v[100:103], v[28:31], v[52:55], v[100:103]
    s_waitcnt lgkmcnt(4)
    v_mfma_f32_16x16x32_bf16 v[104:107], v[32:35], v[40:43], v[104:107]
    ds_read_b64_tr_b16 v[28:29], v7 offset:12288
    v_mfma_f32_16x16x32_bf16 v[108:111], v[32:35], v[44:47], v[108:111]
    ds_read_b64_tr_b16 v[30:31], v7 offset:12800
    v_mfma_f32_16x16x32_bf16 v[112:115], v[32:35], v[48:51], v[112:115]
    v_mfma_f32_16x16x32_bf16 v[116:119], v[32:35], v[52:55], v[116:119]
    s_waitcnt lgkmcnt(4)
    v_mfma_f32_16x16x32_bf16 v[120:123], v[36:39], v[40:43], v[120:123]
    v_mfma_f32_16x16x32_bf16 v[124:127], v[36:39], v[44:47], v[124:127]
    v_mfma_f32_16x16x32_bf16 v[128:131], v[36:39], v[48:51], v[128:131]
    v_mfma_f32_16x16x32_bf16 v[132:135], v[36:39], v[52:55], v[132:135]
    s_waitcnt lgkmcnt(0)
    s_barrier
    v_mfma_f32_16x16x32_bf16 v[136:139], v[24:27], v[40:43], v[136:139]
    ds_read_b128 v[56:59], v9 offset:0
    ds_read_b64_tr_b16 v[32:33], v5 offset:24576
    v_mfma_f32_16x16x32_bf16 v[140:143], v[24:27], v[44:47], v[140:143]
    ds_read_b64_tr_b16 v[34:35], v5 offset:25088
    ds_read_b128 v[60:63], v9 offset:2048
    v_mfma_f32_16x16x32_bf16 v[144:147], v[24:27], v[48:51], v[144:147]
    ds_read_b64_tr_b16 v[36:37], v5 offset:36864
    v_mfma_f32_16x16x32_bf16 v[148:151], v[24:27], v[52:55], v[148:151]
    ds_read_b64_tr_b16 v[38:39], v5 offset:37376
    v_mfma_f32_16x16x32_bf16 v[152:155], v[28:31], v[40:43], v[152:155]
    ds_read_b128 v[64:67], v9 offset:4096
    v_mfma_f32_16x16x32_bf16 v[156:159], v[28:31], v[44:47], v[156:159]
    ds_read_b128 v[68:71], v9 offset:6144
    v_mfma_f32_16x16x32_bf16 v[160:163], v[28:31], v[48:51], v[160:163]
    ds_read_b64_tr_b16 v[24:25], v6 offset:24576
    v_mfma_f32_16x16x32_bf16 v[164:167], v[28:31], v[52:55], v[164:167]
    ds_read_b64_tr_b16 v[26:27], v6 offset:25088
    s_waitcnt lgkmcnt(2)
    v_mfma_f32_16x16x32_bf16 v[72:75], v[32:35], v[56:59], v[72:75]
    ds_read_b64_tr_b16 v[28:29], v6 offset:36864
    v_mfma_f32_16x16x32_bf16 v[76:79], v[32:35], v[60:63], v[76:79]
    ds_read_b64_tr_b16 v[30:31], v6 offset:37376
    v_mfma_f32_16x16x32_bf16 v[80:83], v[32:35], v[64:67], v[80:83]
    v_mfma_f32_16x16x32_bf16 v[84:87], v[32:35], v[68:71], v[84:87]
    v_mfma_f32_16x16x32_bf16 v[88:91], v[36:39], v[56:59], v[88:91]
    ds_read_b64_tr_b16 v[32:33], v7 offset:24576
    v_mfma_f32_16x16x32_bf16 v[92:95], v[36:39], v[60:63], v[92:95]
    ds_read_b64_tr_b16 v[34:35], v7 offset:25088
    v_mfma_f32_16x16x32_bf16 v[96:99], v[36:39], v[64:67], v[96:99]
    v_mfma_f32_16x16x32_bf16 v[100:103], v[36:39], v[68:71], v[100:103]
    s_waitcnt lgkmcnt(4)
    v_mfma_f32_16x16x32_bf16 v[104:107], v[24:27], v[56:59], v[104:107]
    ds_read_b64_tr_b16 v[36:37], v7 offset:36864
    v_mfma_f32_16x16x32_bf16 v[108:111], v[24:27], v[60:63], v[108:111]
    ds_read_b64_tr_b16 v[38:39], v7 offset:37376
    v_mfma_f32_16x16x32_bf16 v[112:115], v[24:27], v[64:67], v[112:115]
    v_mfma_f32_16x16x32_bf16 v[116:119], v[24:27], v[68:71], v[116:119]
    s_waitcnt lgkmcnt(4)
    v_mfma_f32_16x16x32_bf16 v[120:123], v[28:31], v[56:59], v[120:123]
    v_mfma_f32_16x16x32_bf16 v[124:127], v[28:31], v[60:63], v[124:127]
    v_mfma_f32_16x16x32_bf16 v[128:131], v[28:31], v[64:67], v[128:131]
    v_mfma_f32_16x16x32_bf16 v[132:135], v[28:31], v[68:71], v[132:135]
    s_waitcnt lgkmcnt(2)
    v_mfma_f32_16x16x32_bf16 v[136:139], v[32:35], v[56:59], v[136:139]
    v_mfma_f32_16x16x32_bf16 v[140:143], v[32:35], v[60:63], v[140:143]
    v_mfma_f32_16x16x32_bf16 v[144:147], v[32:35], v[64:67], v[144:147]
    v_mfma_f32_16x16x32_bf16 v[148:151], v[32:35], v[68:71], v[148:151]
    s_waitcnt lgkmcnt(0)
    v_mfma_f32_16x16x32_bf16 v[152:155], v[36:39], v[56:59], v[152:155]
    v_mfma_f32_16x16x32_bf16 v[156:159], v[36:39], v[60:63], v[156:159]
    v_mfma_f32_16x16x32_bf16 v[160:163], v[36:39], v[64:67], v[160:163]
    v_mfma_f32_16x16x32_bf16 v[164:167], v[36:39], v[68:71], v[164:167]
    v_lshrrev_b32 v2, 4, v1
    s_mul_i32 s50, s49, 384
    s_add_u32 s50, s50, 147456
    v_lshlrev_b32 v3, 4, v2
    v_add_u32 v3, s50, v3
    s_lshl_b32 s50, s48, 9
    s_add_u32 s50, s50, 159744
    v_lshlrev_b32 v4, 3, v10
    v_add_u32 v4, s50, v4
    s_barrier
    ds_read_b64 v[12:13], v4 offset:0
    ds_read_b64 v[14:15], v4 offset:128
    ds_read_b64 v[16:17], v4 offset:256
    ds_read_b64 v[18:19], v4 offset:384
    ds_read_b128 v[40:43], v3 offset:0
    ds_read_b128 v[44:47], v3 offset:64
    ds_read_b128 v[48:51], v3 offset:128
    ds_read_b128 v[52:55], v3 offset:192
    ds_read_b128 v[56:59], v3 offset:256
    ds_read_b128 v[60:63], v3 offset:320
    v_and_b32 v6, 1, v2
    s_mov_b32 s50, 69632
    v_mul_u32_u24 v6, s50, v6
    v_lshl_add_u32 v6, v10, 4, v6
    v_lshrrev_b32 v7, 5, v1
    v_lshl_add_u32 v6, v7, 8, v6
    v_add_u32 v7, 139264, v6
    s_lshl_b32 s50, s45, 3
    s_lshl2_add_u32 s50, s48, s50
    s_mul_i32 s50, s50, 69632
    s_mul_i32 s51, s46, 12
    s_mul_i32 s52, s49, 3
    s_add_u32 s51, s51, s52
    s_lshl_b32 s51, s51, 9
    s_add_u32 s55, s50, s51
    s_waitcnt lgkmcnt(6)
    v_mul_f32 v24, 0xbfb8aa3b, v13
    v_rcp_f32 v25, v13
    v_mul_f32 v26, 0xbfb8aa3b, v15
    v_rcp_f32 v27, v15
    v_mul_f32 v28, 0xbfb8aa3b, v17
    v_rcp_f32 v29, v17
    v_mul_f32 v30, 0xbfb8aa3b, v19
    v_rcp_f32 v31, v19
    s_waitcnt lgkmcnt(0)
    v_pk_fma_f32 v[72:73], v[40:41], v[12:13], v[72:73] op_sel_hi:[1,0,1] neg_lo:[1,0,0] neg_hi:[1,0,0]
    v_pk_fma_f32 v[74:75], v[42:43], v[12:13], v[74:75] op_sel_hi:[1,0,1] neg_lo:[1,0,0] neg_hi:[1,0,0]
    v_pk_fma_f32 v[76:77], v[40:41], v[14:15], v[76:77] op_sel_hi:[1,0,1] neg_lo:[1,0,0] neg_hi:[1,0,0]
    v_pk_fma_f32 v[78:79], v[42:43], v[14:15], v[78:79] op_sel_hi:[1,0,1] neg_lo:[1,0,0] neg_hi:[1,0,0]
    v_pk_mul_f32 v[72:73], v[72:73], v[24:25] op_sel_hi:[1,0]
    v_pk_mul_f32 v[74:75], v[74:75], v[24:25] op_sel_hi:[1,0]
    v_pk_mul_f32 v[76:77], v[76:77], v[26:27] op_sel_hi:[1,0]
    v_pk_mul_f32 v[78:79], v[78:79], v[26:27] op_sel_hi:[1,0]
    v_exp_f32 v72, v72
    v_exp_f32 v73, v73
    v_exp_f32 v74, v74
    v_exp_f32 v75, v75
    v_exp_f32 v76, v76
    v_exp_f32 v77, v77
    v_exp_f32 v78, v78
    v_exp_f32 v79, v79
    v_pk_fma_f32 v[88:89], v[44:45], v[12:13], v[88:89] op_sel_hi:[1,0,1] neg_lo:[1,0,0] neg_hi:[1,0,0]
    v_pk_fma_f32 v[90:91], v[46:47], v[12:13], v[90:91] op_sel_hi:[1,0,1] neg_lo:[1,0,0] neg_hi:[1,0,0]
    v_pk_fma_f32 v[92:93], v[44:45], v[14:15], v[92:93] op_sel_hi:[1,0,1] neg_lo:[1,0,0] neg_hi:[1,0,0]
    v_pk_fma_f32 v[94:95], v[46:47], v[14:15], v[94:95] op_sel_hi:[1,0,1] neg_lo:[1,0,0] neg_hi:[1,0,0]
    v_pk_fma_f32 v[72:73], v[72:73], v[24:25], v[24:25] op_sel:[0,1,1] op_sel_hi:[1,1,1]
    v_pk_fma_f32 v[74:75], v[74:75], v[24:25], v[24:25] op_sel:[0,1,1] op_sel_hi:[1,1,1]
    v_pk_fma_f32 v[76:77], v[76:77], v[26:27], v[26:27] op_sel:[0,1,1] op_sel_hi:[1,1,1]
    v_pk_fma_f32 v[78:79], v[78:79], v[26:27], v[26:27] op_sel:[0,1,1] op_sel_hi:[1,1,1]
    v_rcp_f32 v72, v72
    v_rcp_f32 v73, v73
    v_rcp_f32 v74, v74
    v_rcp_f32 v75, v75
    v_rcp_f32 v76, v76
    v_rcp_f32 v77, v77
    v_rcp_f32 v78, v78
    v_rcp_f32 v79, v79
    s_nop 0
    v_pk_mul_f32 v[72:73], v[72:73], v[88:89]
    v_pk_mul_f32 v[74:75], v[74:75], v[90:91]
    v_pk_mul_f32 v[76:77], v[76:77], v[92:93]
    v_pk_mul_f32 v[78:79], v[78:79], v[94:95]
    v_cvt_pk_bf16_f32 v88, v72, v73
    v_cvt_pk_bf16_f32 v89, v74, v75
    v_cvt_pk_bf16_f32 v90, v76, v77
    v_cvt_pk_bf16_f32 v91, v78, v79
    s_nop 1
    v_permlane16_swap_b32 v88, v90
    v_permlane16_swap_b32 v89, v91
    buffer_store_dwordx4 v[88:91], v6, s[32:35], s55 offen offset:0 sc1
    v_pk_fma_f32 v[80:81], v[40:41], v[16:17], v[80:81] op_sel_hi:[1,0,1] neg_lo:[1,0,0] neg_hi:[1,0,0]
    v_pk_fma_f32 v[82:83], v[42:43], v[16:17], v[82:83] op_sel_hi:[1,0,1] neg_lo:[1,0,0] neg_hi:[1,0,0]
    v_pk_fma_f32 v[84:85], v[40:41], v[18:19], v[84:85] op_sel_hi:[1,0,1] neg_lo:[1,0,0] neg_hi:[1,0,0]
    v_pk_fma_f32 v[86:87], v[42:43], v[18:19], v[86:87] op_sel_hi:[1,0,1] neg_lo:[1,0,0] neg_hi:[1,0,0]
    v_pk_mul_f32 v[80:81], v[80:81], v[28:29] op_sel_hi:[1,0]
    v_pk_mul_f32 v[82:83], v[82:83], v[28:29] op_sel_hi:[1,0]
    v_pk_mul_f32 v[84:85], v[84:85], v[30:31] op_sel_hi:[1,0]
    v_pk_mul_f32 v[86:87], v[86:87], v[30:31] op_sel_hi:[1,0]
    v_exp_f32 v80, v80
    v_exp_f32 v81, v81
    v_exp_f32 v82, v82
    v_exp_f32 v83, v83
    v_exp_f32 v84, v84
    v_exp_f32 v85, v85
    v_exp_f32 v86, v86
    v_exp_f32 v87, v87
    v_pk_fma_f32 v[96:97], v[44:45], v[16:17], v[96:97] op_sel_hi:[1,0,1] neg_lo:[1,0,0] neg_hi:[1,0,0]
    v_pk_fma_f32 v[98:99], v[46:47], v[16:17], v[98:99] op_sel_hi:[1,0,1] neg_lo:[1,0,0] neg_hi:[1,0,0]
    v_pk_fma_f32 v[100:101], v[44:45], v[18:19], v[100:101] op_sel_hi:[1,0,1] neg_lo:[1,0,0] neg_hi:[1,0,0]
    v_pk_fma_f32 v[102:103], v[46:47], v[18:19], v[102:103] op_sel_hi:[1,0,1] neg_lo:[1,0,0] neg_hi:[1,0,0]
    v_pk_fma_f32 v[80:81], v[80:81], v[28:29], v[28:29] op_sel:[0,1,1] op_sel_hi:[1,1,1]
    v_pk_fma_f32 v[82:83], v[82:83], v[28:29], v[28:29] op_sel:[0,1,1] op_sel_hi:[1,1,1]
    v_pk_fma_f32 v[84:85], v[84:85], v[30:31], v[30:31] op_sel:[0,1,1] op_sel_hi:[1,1,1]
    v_pk_fma_f32 v[86:87], v[86:87], v[30:31], v[30:31] op_sel:[0,1,1] op_sel_hi:[1,1,1]
    v_rcp_f32 v80, v80
    v_rcp_f32 v81, v81
    v_rcp_f32 v82, v82
    v_rcp_f32 v83, v83
    v_rcp_f32 v84, v84
    v_rcp_f32 v85, v85
    v_rcp_f32 v86, v86
    v_rcp_f32 v87, v87
    s_nop 0
    v_pk_mul_f32 v[80:81], v[80:81], v[96:97]
    v_pk_mul_f32 v[82:83], v[82:83], v[98:99]
    v_pk_mul_f32 v[84:85], v[84:85], v[100:101]
    v_pk_mul_f32 v[86:87], v[86:87], v[102:103]
    v_cvt_pk_bf16_f32 v96, v80, v81
    v_cvt_pk_bf16_f32 v97, v82, v83
    v_cvt_pk_bf16_f32 v98, v84, v85
    v_cvt_pk_bf16_f32 v99, v86, v87
    s_nop 1
    v_permlane16_swap_b32 v96, v98
    v_permlane16_swap_b32 v97, v99
    buffer_store_dwordx4 v[96:99], v7, s[32:35], s55 offen offset:0 sc1
    v_pk_fma_f32 v[104:105], v[48:49], v[12:13], v[104:105] op_sel_hi:[1,0,1] neg_lo:[1,0,0] neg_hi:[1,0,0]
    v_pk_fma_f32 v[106:107], v[50:51], v[12:13], v[106:107] op_sel_hi:[1,0,1] neg_lo:[1,0,0] neg_hi:[1,0,0]
    v_pk_fma_f32 v[108:109], v[48:49], v[14:15], v[108:109] op_sel_hi:[1,0,1] neg_lo:[1,0,0] neg_hi:[1,0,0]
    v_pk_fma_f32 v[110:111], v[50:51], v[14:15], v[110:111] op_sel_hi:[1,0,1] neg_lo:[1,0,0] neg_hi:[1,0,0]
    v_pk_mul_f32 v[104:105], v[104:105], v[24:25] op_sel_hi:[1,0]
    v_pk_mul_f32 v[106:107], v[106:107], v[24:25] op_sel_hi:[1,0]
    v_pk_mul_f32 v[108:109], v[108:109], v[26:27] op_sel_hi:[1,0]
    v_pk_mul_f32 v[110:111], v[110:111], v[26:27] op_sel_hi:[1,0]
    v_exp_f32 v104, v104
    v_exp_f32 v105, v105
    v_exp_f32 v106, v106
    v_exp_f32 v107, v107
    v_exp_f32 v108, v108
    v_exp_f32 v109, v109
    v_exp_f32 v110, v110
    v_exp_f32 v111, v111
    v_pk_fma_f32 v[120:121], v[52:53], v[12:13], v[120:121] op_sel_hi:[1,0,1] neg_lo:[1,0,0] neg_hi:[1,0,0]
    v_pk_fma_f32 v[122:123], v[54:55], v[12:13], v[122:123] op_sel_hi:[1,0,1] neg_lo:[1,0,0] neg_hi:[1,0,0]
    v_pk_fma_f32 v[124:125], v[52:53], v[14:15], v[124:125] op_sel_hi:[1,0,1] neg_lo:[1,0,0] neg_hi:[1,0,0]
    v_pk_fma_f32 v[126:127], v[54:55], v[14:15], v[126:127] op_sel_hi:[1,0,1] neg_lo:[1,0,0] neg_hi:[1,0,0]
    v_pk_fma_f32 v[104:105], v[104:105], v[24:25], v[24:25] op_sel:[0,1,1] op_sel_hi:[1,1,1]
    v_pk_fma_f32 v[106:107], v[106:107], v[24:25], v[24:25] op_sel:[0,1,1] op_sel_hi:[1,1,1]
    v_pk_fma_f32 v[108:109], v[108:109], v[26:27], v[26:27] op_sel:[0,1,1] op_sel_hi:[1,1,1]
    v_pk_fma_f32 v[110:111], v[110:111], v[26:27], v[26:27] op_sel:[0,1,1] op_sel_hi:[1,1,1]
    v_rcp_f32 v104, v104
    v_rcp_f32 v105, v105
    v_rcp_f32 v106, v106
    v_rcp_f32 v107, v107
    v_rcp_f32 v108, v108
    v_rcp_f32 v109, v109
    v_rcp_f32 v110, v110
    v_rcp_f32 v111, v111
    s_nop 0
    v_pk_mul_f32 v[104:105], v[104:105], v[120:121]
    v_pk_mul_f32 v[106:107], v[106:107], v[122:123]
    v_pk_mul_f32 v[108:109], v[108:109], v[124:125]
    v_pk_mul_f32 v[110:111], v[110:111], v[126:127]
    v_cvt_pk_bf16_f32 v120, v104, v105
    v_cvt_pk_bf16_f32 v121, v106, v107
    v_cvt_pk_bf16_f32 v122, v108, v109
    v_cvt_pk_bf16_f32 v123, v110, v111
    s_nop 1
    v_permlane16_swap_b32 v120, v122
    v_permlane16_swap_b32 v121, v123
    buffer_store_dwordx4 v[120:123], v6, s[32:35], s55 offen offset:512 sc1
    v_pk_fma_f32 v[112:113], v[48:49], v[16:17], v[112:113] op_sel_hi:[1,0,1] neg_lo:[1,0,0] neg_hi:[1,0,0]
    v_pk_fma_f32 v[114:115], v[50:51], v[16:17], v[114:115] op_sel_hi:[1,0,1] neg_lo:[1,0,0] neg_hi:[1,0,0]
    v_pk_fma_f32 v[116:117], v[48:49], v[18:19], v[116:117] op_sel_hi:[1,0,1] neg_lo:[1,0,0] neg_hi:[1,0,0]
    v_pk_fma_f32 v[118:119], v[50:51], v[18:19], v[118:119] op_sel_hi:[1,0,1] neg_lo:[1,0,0] neg_hi:[1,0,0]
    v_pk_mul_f32 v[112:113], v[112:113], v[28:29] op_sel_hi:[1,0]
    v_pk_mul_f32 v[114:115], v[114:115], v[28:29] op_sel_hi:[1,0]
    v_pk_mul_f32 v[116:117], v[116:117], v[30:31] op_sel_hi:[1,0]
    v_pk_mul_f32 v[118:119], v[118:119], v[30:31] op_sel_hi:[1,0]
    v_exp_f32 v112, v112
    v_exp_f32 v113, v113
    v_exp_f32 v114, v114
    v_exp_f32 v115, v115
    v_exp_f32 v116, v116
    v_exp_f32 v117, v117
    v_exp_f32 v118, v118
    v_exp_f32 v119, v119
    v_pk_fma_f32 v[128:129], v[52:53], v[16:17], v[128:129] op_sel_hi:[1,0,1] neg_lo:[1,0,0] neg_hi:[1,0,0]
    v_pk_fma_f32 v[130:131], v[54:55], v[16:17], v[130:131] op_sel_hi:[1,0,1] neg_lo:[1,0,0] neg_hi:[1,0,0]
    v_pk_fma_f32 v[132:133], v[52:53], v[18:19], v[132:133] op_sel_hi:[1,0,1] neg_lo:[1,0,0] neg_hi:[1,0,0]
    v_pk_fma_f32 v[134:135], v[54:55], v[18:19], v[134:135] op_sel_hi:[1,0,1] neg_lo:[1,0,0] neg_hi:[1,0,0]
    v_pk_fma_f32 v[112:113], v[112:113], v[28:29], v[28:29] op_sel:[0,1,1] op_sel_hi:[1,1,1]
    v_pk_fma_f32 v[114:115], v[114:115], v[28:29], v[28:29] op_sel:[0,1,1] op_sel_hi:[1,1,1]
    v_pk_fma_f32 v[116:117], v[116:117], v[30:31], v[30:31] op_sel:[0,1,1] op_sel_hi:[1,1,1]
    v_pk_fma_f32 v[118:119], v[118:119], v[30:31], v[30:31] op_sel:[0,1,1] op_sel_hi:[1,1,1]
    v_rcp_f32 v112, v112
    v_rcp_f32 v113, v113
    v_rcp_f32 v114, v114
    v_rcp_f32 v115, v115
    v_rcp_f32 v116, v116
    v_rcp_f32 v117, v117
    v_rcp_f32 v118, v118
    v_rcp_f32 v119, v119
    s_nop 0
    v_pk_mul_f32 v[112:113], v[112:113], v[128:129]
    v_pk_mul_f32 v[114:115], v[114:115], v[130:131]
    v_pk_mul_f32 v[116:117], v[116:117], v[132:133]
    v_pk_mul_f32 v[118:119], v[118:119], v[134:135]
    v_cvt_pk_bf16_f32 v128, v112, v113
    v_cvt_pk_bf16_f32 v129, v114, v115
    v_cvt_pk_bf16_f32 v130, v116, v117
    v_cvt_pk_bf16_f32 v131, v118, v119
    s_nop 1
    v_permlane16_swap_b32 v128, v130
    v_permlane16_swap_b32 v129, v131
    buffer_store_dwordx4 v[128:131], v7, s[32:35], s55 offen offset:512 sc1
    v_pk_fma_f32 v[136:137], v[56:57], v[12:13], v[136:137] op_sel_hi:[1,0,1] neg_lo:[1,0,0] neg_hi:[1,0,0]
    v_pk_fma_f32 v[138:139], v[58:59], v[12:13], v[138:139] op_sel_hi:[1,0,1] neg_lo:[1,0,0] neg_hi:[1,0,0]
    v_pk_fma_f32 v[140:141], v[56:57], v[14:15], v[140:141] op_sel_hi:[1,0,1] neg_lo:[1,0,0] neg_hi:[1,0,0]
    v_pk_fma_f32 v[142:143], v[58:59], v[14:15], v[142:143] op_sel_hi:[1,0,1] neg_lo:[1,0,0] neg_hi:[1,0,0]
    v_pk_mul_f32 v[136:137], v[136:137], v[24:25] op_sel_hi:[1,0]
    v_pk_mul_f32 v[138:139], v[138:139], v[24:25] op_sel_hi:[1,0]
    v_pk_mul_f32 v[140:141], v[140:141], v[26:27] op_sel_hi:[1,0]
    v_pk_mul_f32 v[142:143], v[142:143], v[26:27] op_sel_hi:[1,0]
    v_exp_f32 v136, v136
    v_exp_f32 v137, v137
    v_exp_f32 v138, v138
    v_exp_f32 v139, v139
    v_exp_f32 v140, v140
    v_exp_f32 v141, v141
    v_exp_f32 v142, v142
    v_exp_f32 v143, v143
    v_pk_fma_f32 v[152:153], v[60:61], v[12:13], v[152:153] op_sel_hi:[1,0,1] neg_lo:[1,0,0] neg_hi:[1,0,0]
    v_pk_fma_f32 v[154:155], v[62:63], v[12:13], v[154:155] op_sel_hi:[1,0,1] neg_lo:[1,0,0] neg_hi:[1,0,0]
    v_pk_fma_f32 v[156:157], v[60:61], v[14:15], v[156:157] op_sel_hi:[1,0,1] neg_lo:[1,0,0] neg_hi:[1,0,0]
    v_pk_fma_f32 v[158:159], v[62:63], v[14:15], v[158:159] op_sel_hi:[1,0,1] neg_lo:[1,0,0] neg_hi:[1,0,0]
    v_pk_fma_f32 v[136:137], v[136:137], v[24:25], v[24:25] op_sel:[0,1,1] op_sel_hi:[1,1,1]
    v_pk_fma_f32 v[138:139], v[138:139], v[24:25], v[24:25] op_sel:[0,1,1] op_sel_hi:[1,1,1]
    v_pk_fma_f32 v[140:141], v[140:141], v[26:27], v[26:27] op_sel:[0,1,1] op_sel_hi:[1,1,1]
    v_pk_fma_f32 v[142:143], v[142:143], v[26:27], v[26:27] op_sel:[0,1,1] op_sel_hi:[1,1,1]
    v_rcp_f32 v136, v136
    v_rcp_f32 v137, v137
    v_rcp_f32 v138, v138
    v_rcp_f32 v139, v139
    v_rcp_f32 v140, v140
    v_rcp_f32 v141, v141
    v_rcp_f32 v142, v142
    v_rcp_f32 v143, v143
    s_nop 0
    v_pk_mul_f32 v[136:137], v[136:137], v[152:153]
    v_pk_mul_f32 v[138:139], v[138:139], v[154:155]
    v_pk_mul_f32 v[140:141], v[140:141], v[156:157]
    v_pk_mul_f32 v[142:143], v[142:143], v[158:159]
    v_cvt_pk_bf16_f32 v152, v136, v137
    v_cvt_pk_bf16_f32 v153, v138, v139
    v_cvt_pk_bf16_f32 v154, v140, v141
    v_cvt_pk_bf16_f32 v155, v142, v143
    s_nop 1
    v_permlane16_swap_b32 v152, v154
    v_permlane16_swap_b32 v153, v155
    buffer_store_dwordx4 v[152:155], v6, s[32:35], s55 offen offset:1024 sc1
    v_pk_fma_f32 v[144:145], v[56:57], v[16:17], v[144:145] op_sel_hi:[1,0,1] neg_lo:[1,0,0] neg_hi:[1,0,0]
    v_pk_fma_f32 v[146:147], v[58:59], v[16:17], v[146:147] op_sel_hi:[1,0,1] neg_lo:[1,0,0] neg_hi:[1,0,0]
    v_pk_fma_f32 v[148:149], v[56:57], v[18:19], v[148:149] op_sel_hi:[1,0,1] neg_lo:[1,0,0] neg_hi:[1,0,0]
    v_pk_fma_f32 v[150:151], v[58:59], v[18:19], v[150:151] op_sel_hi:[1,0,1] neg_lo:[1,0,0] neg_hi:[1,0,0]
    v_pk_mul_f32 v[144:145], v[144:145], v[28:29] op_sel_hi:[1,0]
    v_pk_mul_f32 v[146:147], v[146:147], v[28:29] op_sel_hi:[1,0]
    v_pk_mul_f32 v[148:149], v[148:149], v[30:31] op_sel_hi:[1,0]
    v_pk_mul_f32 v[150:151], v[150:151], v[30:31] op_sel_hi:[1,0]
    v_exp_f32 v144, v144
    v_exp_f32 v145, v145
    v_exp_f32 v146, v146
    v_exp_f32 v147, v147
    v_exp_f32 v148, v148
    v_exp_f32 v149, v149
    v_exp_f32 v150, v150
    v_exp_f32 v151, v151
    v_pk_fma_f32 v[160:161], v[60:61], v[16:17], v[160:161] op_sel_hi:[1,0,1] neg_lo:[1,0,0] neg_hi:[1,0,0]
    v_pk_fma_f32 v[162:163], v[62:63], v[16:17], v[162:163] op_sel_hi:[1,0,1] neg_lo:[1,0,0] neg_hi:[1,0,0]
    v_pk_fma_f32 v[164:165], v[60:61], v[18:19], v[164:165] op_sel_hi:[1,0,1] neg_lo:[1,0,0] neg_hi:[1,0,0]
    v_pk_fma_f32 v[166:167], v[62:63], v[18:19], v[166:167] op_sel_hi:[1,0,1] neg_lo:[1,0,0] neg_hi:[1,0,0]
    v_pk_fma_f32 v[144:145], v[144:145], v[28:29], v[28:29] op_sel:[0,1,1] op_sel_hi:[1,1,1]
    v_pk_fma_f32 v[146:147], v[146:147], v[28:29], v[28:29] op_sel:[0,1,1] op_sel_hi:[1,1,1]
    v_pk_fma_f32 v[148:149], v[148:149], v[30:31], v[30:31] op_sel:[0,1,1] op_sel_hi:[1,1,1]
    v_pk_fma_f32 v[150:151], v[150:151], v[30:31], v[30:31] op_sel:[0,1,1] op_sel_hi:[1,1,1]
    v_rcp_f32 v144, v144
    v_rcp_f32 v145, v145
    v_rcp_f32 v146, v146
    v_rcp_f32 v147, v147
    v_rcp_f32 v148, v148
    v_rcp_f32 v149, v149
    v_rcp_f32 v150, v150
    v_rcp_f32 v151, v151
    s_nop 0
    v_pk_mul_f32 v[144:145], v[144:145], v[160:161]
    v_pk_mul_f32 v[146:147], v[146:147], v[162:163]
    v_pk_mul_f32 v[148:149], v[148:149], v[164:165]
    v_pk_mul_f32 v[150:151], v[150:151], v[166:167]
    v_cvt_pk_bf16_f32 v160, v144, v145
    v_cvt_pk_bf16_f32 v161, v146, v147
    v_cvt_pk_bf16_f32 v162, v148, v149
    v_cvt_pk_bf16_f32 v163, v150, v151
    s_nop 1
    v_permlane16_swap_b32 v160, v162
    v_permlane16_swap_b32 v161, v163
    buffer_store_dwordx4 v[160:163], v7, s[32:35], s55 offen offset:1024 sc1
    s_barrier
    v_mov_b32 v2, 163836
    v_mov_b32 v3, 1
    v_mov_b32 v4, 0
    s_mov_b64 exec, 1
    s_waitcnt vmcnt(0)
    ds_add_rtn_u32 v5, v2, v3
    s_waitcnt lgkmcnt(0)
    v_readfirstlane_b32 s50, v5
    s_cmp_lg_u32 s50, 7
    s_cbranch_scc1 K1_dn_18
    buffer_store_dword v3, v4, s[32:35], s63 offen sc1
K1_dn_18:
    s_mov_b64 exec, -1
    s_branch P2_exit
K1_attn_comp:
    s_and_b32 s48, s40, 3
    s_lshr_b32 s49, s40, 2
    v_cmp_le_u32 vcc, 100, v0
    v_mov_b32 v13, 20
    v_subrev_u32 v12, 100, v0
    v_cndmask_b32 v12, v0, v12, vcc
    v_cndmask_b32 v13, 0, v13, vcc
    v_add_u32 v14, v12, v13
    v_cmp_le_u32 vcc, 100, v14
    v_subrev_u32 v15, 100, v14
    v_mul_u32_u24 v13, 5, v13
    v_cndmask_b32 v14, v14, v15, vcc
    v_add_lshl_u32 v14, v14, v13, 3
    s_mul_i32 s53, s46, 1600
    v_mov_b32 v16, 0
    v_mov_b32 v17, 0
    v_mov_b32 v40, -1
    v_mov_b32 v41, -1
    v_mov_b32 v42, -1
    v_mov_b32 v43, -1
    v_lshlrev_b32 v44, 4, v0
    s_lshl3_add_u32 s58, s46, s45
    s_mul_i32 s58, s58, 7168
    s_add_u32 s58, s58, 9764864
    s_movk_i32 s52, 200
    v_cmp_gt_u32 vcc, s52, v0
    s_movk_i32 s52, 448
    v_cmp_gt_u32 s[56:57], s52, v0
    s_waitcnt lgkmcnt(0)
    s_mov_b32 s24, s4
    s_mov_b32 s25, s5
    s_mov_b32 s32, s22
    s_mov_b32 s33, s23
    s_mov_b32 s36, s20
    s_mov_b32 s37, s21
    s_mov_b32 s34, 0x1000000
    s_mov_b32 s35, 0x20000
    s_mov_b32 s38, 256
    s_mov_b32 s39, 0x20000
    s_mov_b32 s28, s8
    s_mov_b32 s29, s9
    s_mov_b32 s30, 25600
    s_and_saveexec_b64 s[54:55], vcc
    s_cbranch_execz K1_ph_19
    buffer_load_dwordx2 v[16:17], v14, s[28:31], s53 offen
K1_ph_19:
    s_mov_b64 exec, s[54:55]
    s_lshl_b32 s50, s45, 5
    s_add_u32 s50, s50, s46
    s_lshl_b32 s63, s50, 7
    s_add_u32 s63, s63, 11536384
    s_cmp_lg_u32 s40, 7
    s_cbranch_scc1 K1_dn_20
    v_mov_b32 v12, 0
    v_mov_b32 v13, 0
    s_mov_b64 exec, 1
    buffer_store_dword v12, v13, s[32:35], s63 offen sc1
    s_mov_b64 exec, 0xffff
    v_lshlrev_b32 v12, 2, v1
    v_add_u32 v12, 163776, v12
    ds_write_b32 v12, v13
    s_mov_b64 exec, -1
K1_dn_20:
    v_lshrrev_b32 v9, 4, v1
    v_and_b32 v8, 15, v1
    v_bfe_u32 v13, v1, 2, 2
    v_and_b32 v14, 3, v1
    v_lshlrev_b32 v15, 11, v9
    v_lshl_add_u32 v15, v13, 8, v15
    v_add_u32 v15, 98304, v15
    v_and_b32 v18, 1, v9
    v_lshl_add_u32 v18, v18, 2, v13
    v_lshlrev_b32 v18, 5, v18
    v_lshl_add_u32 v19, v14, 3, v18
    s_mul_i32 s50, s49, 48
    s_movk_i32 s51, 0xff
    s_add_u32 s52, s50, 80
    v_add_u32 v12, s52, v19
    v_and_or_b32 v2, v12, s51, v15
    s_add_u32 s52, s50, 160
    v_add_u32 v12, s52, v19
    v_and_or_b32 v3, v12, s51, v15
    s_add_u32 s52, s50, 0
    v_add_u32 v12, s52, v19
    v_and_or_b32 v90, v12, s51, v15
    v_lshlrev_b32 v12, 3, v14
    s_mov_b32 s52, 0x2020c070
    v_lshrrev_b32 v12, v12, s52
    s_lshl_b32 s52, s49, 3
    v_add3_u32 v12, v12, s52, v18
    v_and_or_b32 v91, v12, s51, v15
    v_mov_b32 v4, v2
    s_cmp_eq_u32 s48, 1
    s_cselect_b64 vcc, -1, 0
    v_cndmask_b32 v4, v4, v3, vcc
    s_cmp_eq_u32 s48, 2
    s_cselect_b64 vcc, -1, 0
    v_cndmask_b32 v4, v4, v90, vcc
    s_cmp_eq_u32 s48, 3
    s_cselect_b64 vcc, -1, 0
    v_cndmask_b32 v4, v4, v91, vcc
    v_lshrrev_b32 v19, 5, v1
    v_bfe_u32 v15, v1, 1, 1
    v_bfe_u32 v18, v1, 4, 1
    v_lshl_add_u32 v15, v18, 1, v15
    s_mul_i32 s50, s49, 800
    s_add_u32 s50, s50, 148480
    v_mul_u32_u24 v5, 40, v13
    v_lshl_add_u32 v5, v15, 3, v5
    v_add_u32 v5, s50, v5
    v_and_b32 v18, 1, v1
    v_cmp_eq_u32 vcc, v18, v19
    v_mov_b32 v6, 150528
    v_bfe_u32 v15, v1, 1, 3
    v_cndmask_b32 v5, v6, v5, vcc
    v_xor_b32 v15, v15, v9
    s_mul_i32 s50, s48, 24576
    v_lshlrev_b32 v14, 7, v8
    v_add_u32 v14, s50, v14
    v_lshl_add_u32 v6, v15, 4, v14
    v_xor_b32 v7, 64, v6
    v_mov_b32 v24, 0x3f803f80
    v_mov_b32 v25, 0x3f803f80
    v_mov_b32 v26, 0x3f803f80
    v_mov_b32 v27, 0x3f803f80
    v_mov_b32 v20, 0
    v_mov_b32 v21, 0
    v_mov_b32 v22, 0
    v_mov_b32 v23, 0
    v_mov_b32 v104, 0
    v_mov_b32 v105, 0
    v_mov_b32 v106, 0
    v_mov_b32 v107, 0
    v_mov_b32 v108, 0
    v_mov_b32 v109, 0
    v_mov_b32 v110, 0
    v_mov_b32 v111, 0
    v_mov_b32 v112, 0
    v_mov_b32 v113, 0
    v_mov_b32 v114, 0
    v_mov_b32 v115, 0
    v_mov_b32 v116, 0
    v_mov_b32 v117, 0
    v_mov_b32 v118, 0
    v_mov_b32 v119, 0
    v_mov_b32 v120, 0
    v_mov_b32 v121, 0
    v_mov_b32 v122, 0
    v_mov_b32 v123, 0
    v_mov_b32 v124, 0
    v_mov_b32 v125, 0
    v_mov_b32 v126, 0
    v_mov_b32 v127, 0
    v_mov_b32 v128, 0
    v_mov_b32 v129, 0
    v_mov_b32 v130, 0
    v_mov_b32 v131, 0
    v_mov_b32 v132, 0
    v_mov_b32 v133, 0
    v_mov_b32 v134, 0
    v_mov_b32 v135, 0
    v_mov_b32 v136, 0
    v_mov_b32 v137, 0
    v_mov_b32 v138, 0
    v_mov_b32 v139, 0
    v_mov_b32 v140, 0
    v_mov_b32 v141, 0
    v_mov_b32 v142, 0
    v_mov_b32 v143, 0
    v_mov_b32 v144, 0
    v_mov_b32 v145, 0
    v_mov_b32 v146, 0
    v_mov_b32 v147, 0
    v_mov_b32 v148, 0
    v_mov_b32 v149, 0
    v_mov_b32 v150, 0
    v_mov_b32 v151, 0
    v_mov_b32 v152, 0
    v_mov_b32 v153, 0
    v_mov_b32 v154, 0
    v_mov_b32 v155, 0
    v_mov_b32 v156, 0
    v_mov_b32 v157, 0
    v_mov_b32 v158, 0
    v_mov_b32 v159, 0
    v_mov_b32 v160, 0
    v_mov_b32 v161, 0
    v_mov_b32 v162, 0
    v_mov_b32 v163, 0
    v_mov_b32 v164, 0
    v_mov_b32 v165, 0
    v_mov_b32 v166, 0
    v_mov_b32 v167, 0
    v_lshlrev_b32 v18, 3, v0
    v_add_u32 v18, 148480, v18
    ds_write_b64 v18, v[20:21] offset:4096
    s_and_saveexec_b64 s[54:55], s[56:57]
    s_cbranch_execz K1_se_21
    buffer_store_dwordx4 v[40:43], v44, s[32:35], s58 offen sc1
K1_se_21:
    s_mov_b64 exec, s[54:55]
    s_barrier
    ds_read_b128 v[48:51], v6 offset:0
    ds_read_b64_tr_b16 v[32:33], v2 offset:0
    ds_read_b64_tr_b16 v[34:35], v2 offset:1024
    ds_read_b128 v[52:55], v6 offset:2048
    ds_read_b128 v[56:59], v6 offset:4096
    ds_read_b128 v[60:63], v6 offset:6144
    ds_read_b64_tr_b16 v[36:37], v3 offset:0
    ds_read_b64_tr_b16 v[38:39], v3 offset:1024
    ds_read_b64_tr_b16 v[40:41], v90 offset:0
    ds_read_b64_tr_b16 v[42:43], v90 offset:1024
    s_waitcnt lgkmcnt(4)
    v_mfma_f32_16x16x32_bf16 v[104:107], v[32:35], v[48:51], v[104:107]
    ds_read_b64_tr_b16 v[28:29], v4 offset:0
    v_mfma_f32_16x16x32_bf16 v[108:111], v[32:35], v[52:55], v[108:111]
    ds_read_b64_tr_b16 v[30:31], v4 offset:1024
    v_mfma_f32_16x16x32_bf16 v[112:115], v[32:35], v[56:59], v[112:115]
    ds_read_b64_tr_b16 v[44:45], v91 offset:0
    v_mfma_f32_16x16x32_bf16 v[116:119], v[32:35], v[60:63], v[116:119]
    ds_read_b64_tr_b16 v[46:47], v91 offset:1024
    s_waitcnt lgkmcnt(6)
    v_mfma_f32_16x16x32_bf16 v[120:123], v[36:39], v[48:51], v[120:123]
    ds_read_b64_tr_b16 v[32:33], v2 offset:8192
    v_mfma_f32_16x16x32_bf16 v[124:127], v[36:39], v[52:55], v[124:127]
    ds_read_b64_tr_b16 v[34:35], v2 offset:9216
    v_mfma_f32_16x16x32_bf16 v[128:131], v[36:39], v[56:59], v[128:131]
    ds_read_b128 v[64:67], v7 offset:0
    v_mfma_f32_16x16x32_bf16 v[132:135], v[36:39], v[60:63], v[132:135]
    ds_read_b128 v[68:71], v7 offset:2048
    s_waitcnt lgkmcnt(8)
    v_mfma_f32_16x16x32_bf16 v[136:139], v[40:43], v[48:51], v[136:139]
    ds_read_b64_tr_b16 v[36:37], v3 offset:8192
    v_mfma_f32_16x16x32_bf16 v[140:143], v[40:43], v[52:55], v[140:143]
    ds_read_b64_tr_b16 v[38:39], v3 offset:9216
    v_mfma_f32_16x16x32_bf16 v[144:147], v[40:43], v[56:59], v[144:147]
    ds_read_b128 v[72:75], v7 offset:4096
    v_mfma_f32_16x16x32_bf16 v[148:151], v[40:43], v[60:63], v[148:151]
    ds_read_b128 v[76:79], v7 offset:6144
    s_waitcnt lgkmcnt(8)
    v_mfma_f32_16x16x32_bf16 v[152:155], v[44:47], v[48:51], v[152:155]
    ds_read_b64_tr_b16 v[40:41], v90 offset:8192
    v_mfma_f32_16x16x32_bf16 v[156:159], v[44:47], v[52:55], v[156:159]
    ds_read_b64_tr_b16 v[42:43], v90 offset:9216
    v_mfma_f32_16x16x32_bf16 v[160:163], v[44:47], v[56:59], v[160:163]
    v_mfma_f32_16x16x32_bf16 v[164:167], v[44:47], v[60:63], v[164:167]
    v_mfma_f32_16x16x32_bf16 v[20:23], v[28:31], v[24:27], v[20:23]
    s_waitcnt lgkmcnt(2)
    v_mfma_f32_16x16x32_bf16 v[104:107], v[32:35], v[64:67], v[104:107]
    ds_read_b64_tr_b16 v[28:29], v4 offset:8192
    v_mfma_f32_16x16x32_bf16 v[108:111], v[32:35], v[68:71], v[108:111]
    ds_read_b64_tr_b16 v[30:31], v4 offset:9216
    v_mfma_f32_16x16x32_bf16 v[112:115], v[32:35], v[72:75], v[112:115]
    ds_read_b64_tr_b16 v[44:45], v91 offset:8192
    v_mfma_f32_16x16x32_bf16 v[116:119], v[32:35], v[76:79], v[116:119]
    ds_read_b64_tr_b16 v[46:47], v91 offset:9216
    v_mfma_f32_16x16x32_bf16 v[120:123], v[36:39], v[64:67], v[120:123]
    v_mfma_f32_16x16x32_bf16 v[124:127], v[36:39], v[68:71], v[124:127]
    v_mfma_f32_16x16x32_bf16 v[128:131], v[36:39], v[72:75], v[128:131]
    v_mfma_f32_16x16x32_bf16 v[132:135], v[36:39], v[76:79], v[132:135]
    s_waitcnt lgkmcnt(0)
    s_barrier
    v_mfma_f32_16x16x32_bf16 v[136:139], v[40:43], v[64:67], v[136:139]
    ds_read_b128 v[48:51], v6 offset:8192
    ds_read_b128 v[52:55], v6 offset:10240
    v_mfma_f32_16x16x32_bf16 v[140:143], v[40:43], v[68:71], v[140:143]
    ds_read_b64_tr_b16 v[32:33], v2 offset:16384
    ds_read_b64_tr_b16 v[34:35], v2 offset:17408
    v_mfma_f32_16x16x32_bf16 v[144:147], v[40:43], v[72:75], v[144:147]
    ds_read_b64_tr_b16 v[36:37], v3 offset:16384
    v_mfma_f32_16x16x32_bf16 v[148:151], v[40:43], v[76:79], v[148:151]
    ds_read_b64_tr_b16 v[38:39], v3 offset:17408
    v_mfma_f32_16x16x32_bf16 v[152:155], v[44:47], v[64:67], v[152:155]
    ds_read_b128 v[56:59], v6 offset:12288
    v_mfma_f32_16x16x32_bf16 v[156:159], v[44:47], v[68:71], v[156:159]
    ds_read_b128 v[60:63], v6 offset:14336
    v_mfma_f32_16x16x32_bf16 v[160:163], v[44:47], v[72:75], v[160:163]
    ds_read_b64_tr_b16 v[40:41], v90 offset:16384
    v_mfma_f32_16x16x32_bf16 v[164:167], v[44:47], v[76:79], v[164:167]
    ds_read_b64_tr_b16 v[42:43], v90 offset:17408
    v_mfma_f32_16x16x32_bf16 v[20:23], v[28:31], v[24:27], v[20:23]
    s_waitcnt lgkmcnt(2)
    v_mfma_f32_16x16x32_bf16 v[104:107], v[32:35], v[48:51], v[104:107]
    ds_read_b64_tr_b16 v[28:29], v4 offset:16384
    v_mfma_f32_16x16x32_bf16 v[108:111], v[32:35], v[52:55], v[108:111]
    ds_read_b64_tr_b16 v[30:31], v4 offset:17408
    v_mfma_f32_16x16x32_bf16 v[112:115], v[32:35], v[56:59], v[112:115]
    ds_read_b64_tr_b16 v[44:45], v91 offset:16384
    v_mfma_f32_16x16x32_bf16 v[116:119], v[32:35], v[60:63], v[116:119]
    ds_read_b64_tr_b16 v[46:47], v91 offset:17408
    v_mfma_f32_16x16x32_bf16 v[120:123], v[36:39], v[48:51], v[120:123]
    ds_read_b64_tr_b16 v[32:33], v2 offset:24576
    v_mfma_f32_16x16x32_bf16 v[124:127], v[36:39], v[52:55], v[124:127]
    ds_read_b64_tr_b16 v[34:35], v2 offset:25600
    v_mfma_f32_16x16x32_bf16 v[128:131], v[36:39], v[56:59], v[128:131]
    ds_read_b128 v[64:67], v7 offset:8192
    v_mfma_f32_16x16x32_bf16 v[132:135], v[36:39], v[60:63], v[132:135]
    ds_read_b128 v[68:71], v7 offset:10240
    s_waitcnt lgkmcnt(8)
    v_mfma_f32_16x16x32_bf16 v[136:139], v[40:43], v[48:51], v[136:139]
    ds_read_b64_tr_b16 v[36:37], v3 offset:24576
    v_mfma_f32_16x16x32_bf16 v[140:143], v[40:43], v[52:55], v[140:143]
    ds_read_b64_tr_b16 v[38:39], v3 offset:25600
    v_mfma_f32_16x16x32_bf16 v[144:147], v[40:43], v[56:59], v[144:147]
    ds_read_b128 v[72:75], v7 offset:12288
    v_mfma_f32_16x16x32_bf16 v[148:151], v[40:43], v[60:63], v[148:151]
    ds_read_b128 v[76:79], v7 offset:14336
    s_waitcnt lgkmcnt(8)
    v_mfma_f32_16x16x32_bf16 v[152:155], v[44:47], v[48:51], v[152:155]
    ds_read_b64_tr_b16 v[40:41], v90 offset:24576
    v_mfma_f32_16x16x32_bf16 v[156:159], v[44:47], v[52:55], v[156:159]
    ds_read_b64_tr_b16 v[42:43], v90 offset:25600
    v_mfma_f32_16x16x32_bf16 v[160:163], v[44:47], v[56:59], v[160:163]
    v_mfma_f32_16x16x32_bf16 v[164:167], v[44:47], v[60:63], v[164:167]
    v_mfma_f32_16x16x32_bf16 v[20:23], v[28:31], v[24:27], v[20:23]
    s_waitcnt lgkmcnt(2)
    v_mfma_f32_16x16x32_bf16 v[104:107], v[32:35], v[64:67], v[104:107]
    ds_read_b64_tr_b16 v[28:29], v4 offset:24576
    v_mfma_f32_16x16x32_bf16 v[108:111], v[32:35], v[68:71], v[108:111]
    ds_read_b64_tr_b16 v[30:31], v4 offset:25600
    v_mfma_f32_16x16x32_bf16 v[112:115], v[32:35], v[72:75], v[112:115]
    ds_read_b64_tr_b16 v[44:45], v91 offset:24576
    v_mfma_f32_16x16x32_bf16 v[116:119], v[32:35], v[76:79], v[116:119]
    ds_read_b64_tr_b16 v[46:47], v91 offset:25600
    v_mfma_f32_16x16x32_bf16 v[120:123], v[36:39], v[64:67], v[120:123]
    v_mfma_f32_16x16x32_bf16 v[124:127], v[36:39], v[68:71], v[124:127]
    v_mfma_f32_16x16x32_bf16 v[128:131], v[36:39], v[72:75], v[128:131]
    v_mfma_f32_16x16x32_bf16 v[132:135], v[36:39], v[76:79], v[132:135]
    s_waitcnt vmcnt(0)
    ds_write_b64 v18, v[16:17]
    s_waitcnt lgkmcnt(0)
    s_barrier
    s_cmp_lg_u32 s40, 7
    s_cbranch_scc1 K1_fs_22
    v_mov_b32 v10, 1
    v_mov_b32 v11, 0
    s_mov_b64 exec, 1
    buffer_store_byte v10, v11, s[36:39], s41 offen sc1
    s_mov_b64 exec, -1
K1_fs_22:
    v_mfma_f32_16x16x32_bf16 v[136:139], v[40:43], v[64:67], v[136:139]
    ds_read_b128 v[48:51], v6 offset:16384
    ds_read_b128 v[52:55], v6 offset:18432
    v_mfma_f32_16x16x32_bf16 v[140:143], v[40:43], v[68:71], v[140:143]
    ds_read_b64_tr_b16 v[32:33], v2 offset:32768
    ds_read_b64_tr_b16 v[34:35], v2 offset:33792
    v_mfma_f32_16x16x32_bf16 v[144:147], v[40:43], v[72:75], v[144:147]
    ds_read_b64_tr_b16 v[36:37], v3 offset:32768
    v_mfma_f32_16x16x32_bf16 v[148:151], v[40:43], v[76:79], v[148:151]
    ds_read_b64_tr_b16 v[38:39], v3 offset:33792
    v_mfma_f32_16x16x32_bf16 v[152:155], v[44:47], v[64:67], v[152:155]
    ds_read_b128 v[56:59], v6 offset:20480
    v_mfma_f32_16x16x32_bf16 v[156:159], v[44:47], v[68:71], v[156:159]
    ds_read_b128 v[60:63], v6 offset:22528
    v_mfma_f32_16x16x32_bf16 v[160:163], v[44:47], v[72:75], v[160:163]
    ds_read_b64_tr_b16 v[40:41], v90 offset:32768
    v_mfma_f32_16x16x32_bf16 v[164:167], v[44:47], v[76:79], v[164:167]
    ds_read_b64_tr_b16 v[42:43], v90 offset:33792
    v_mfma_f32_16x16x32_bf16 v[20:23], v[28:31], v[24:27], v[20:23]
    s_waitcnt lgkmcnt(2)
    v_mfma_f32_16x16x32_bf16 v[104:107], v[32:35], v[48:51], v[104:107]
    ds_read_b64_tr_b16 v[28:29], v4 offset:32768
    v_mfma_f32_16x16x32_bf16 v[108:111], v[32:35], v[52:55], v[108:111]
    ds_read_b64_tr_b16 v[30:31], v4 offset:33792
    v_mfma_f32_16x16x32_bf16 v[112:115], v[32:35], v[56:59], v[112:115]
    ds_read_b64_tr_b16 v[44:45], v91 offset:32768
    v_mfma_f32_16x16x32_bf16 v[116:119], v[32:35], v[60:63], v[116:119]
    ds_read_b64_tr_b16 v[46:47], v91 offset:33792
    v_mfma_f32_16x16x32_bf16 v[120:123], v[36:39], v[48:51], v[120:123]
    ds_read_b64_tr_b16 v[32:33], v2 offset:40960
    v_mfma_f32_16x16x32_bf16 v[124:127], v[36:39], v[52:55], v[124:127]
    ds_read_b64_tr_b16 v[34:35], v2 offset:41984
    v_mfma_f32_16x16x32_bf16 v[128:131], v[36:39], v[56:59], v[128:131]
    ds_read_b128 v[64:67], v7 offset:16384
    v_mfma_f32_16x16x32_bf16 v[132:135], v[36:39], v[60:63], v[132:135]
    ds_read_b128 v[68:71], v7 offset:18432
    s_waitcnt lgkmcnt(8)
    v_mfma_f32_16x16x32_bf16 v[136:139], v[40:43], v[48:51], v[136:139]
    ds_read_b64_tr_b16 v[36:37], v3 offset:40960
    v_mfma_f32_16x16x32_bf16 v[140:143], v[40:43], v[52:55], v[140:143]
    ds_read_b64_tr_b16 v[38:39], v3 offset:41984
    v_mfma_f32_16x16x32_bf16 v[144:147], v[40:43], v[56:59], v[144:147]
    ds_read_b128 v[72:75], v7 offset:20480
    v_mfma_f32_16x16x32_bf16 v[148:151], v[40:43], v[60:63], v[148:151]
    ds_read_b128 v[76:79], v7 offset:22528
    s_waitcnt lgkmcnt(8)
    v_mfma_f32_16x16x32_bf16 v[152:155], v[44:47], v[48:51], v[152:155]
    ds_read_b64_tr_b16 v[40:41], v90 offset:40960
    v_mfma_f32_16x16x32_bf16 v[156:159], v[44:47], v[52:55], v[156:159]
    ds_read_b64_tr_b16 v[42:43], v90 offset:41984
    v_mfma_f32_16x16x32_bf16 v[160:163], v[44:47], v[56:59], v[160:163]
    ds_read_b64_tr_b16 v[80:81], v5 offset:0
    v_mfma_f32_16x16x32_bf16 v[164:167], v[44:47], v[60:63], v[164:167]
    ds_read_b64_tr_b16 v[92:93], v5 offset:32
    v_mfma_f32_16x16x32_bf16 v[20:23], v[28:31], v[24:27], v[20:23]
    s_waitcnt lgkmcnt(4)
    v_mfma_f32_16x16x32_bf16 v[104:107], v[32:35], v[64:67], v[104:107]
    ds_read_b64_tr_b16 v[28:29], v4 offset:40960
    v_mfma_f32_16x16x32_bf16 v[108:111], v[32:35], v[68:71], v[108:111]
    ds_read_b64_tr_b16 v[30:31], v4 offset:41984
    v_mfma_f32_16x16x32_bf16 v[112:115], v[32:35], v[72:75], v[112:115]
    ds_read_b64_tr_b16 v[44:45], v91 offset:40960
    v_mfma_f32_16x16x32_bf16 v[116:119], v[32:35], v[76:79], v[116:119]
    ds_read_b64_tr_b16 v[46:47], v91 offset:41984
    v_mfma_f32_16x16x32_bf16 v[120:123], v[36:39], v[64:67], v[120:123]
    v_mfma_f32_16x16x32_bf16 v[124:127], v[36:39], v[68:71], v[124:127]
    v_mfma_f32_16x16x32_bf16 v[128:131], v[36:39], v[72:75], v[128:131]
    v_mfma_f32_16x16x32_bf16 v[132:135], v[36:39], v[76:79], v[132:135]
    s_waitcnt lgkmcnt(0)
    s_barrier
    v_mfma_f32_16x16x32_bf16 v[136:139], v[40:43], v[64:67], v[136:139]
    ds_read_b128 v[48:51], v6 offset:0
    ds_read_b128 v[52:55], v6 offset:2048
    v_mfma_f32_16x16x32_bf16 v[140:143], v[40:43], v[68:71], v[140:143]
    ds_read_b64_tr_b16 v[32:33], v2 offset:0
    ds_read_b64_tr_b16 v[34:35], v2 offset:1024
    v_mfma_f32_16x16x32_bf16 v[144:147], v[40:43], v[72:75], v[144:147]
    ds_read_b64_tr_b16 v[36:37], v3 offset:0
    v_mfma_f32_16x16x32_bf16 v[148:151], v[40:43], v[76:79], v[148:151]
    ds_read_b64_tr_b16 v[38:39], v3 offset:1024
    v_mfma_f32_16x16x32_bf16 v[152:155], v[44:47], v[64:67], v[152:155]
    ds_read_b128 v[56:59], v6 offset:4096
    v_mfma_f32_16x16x32_bf16 v[156:159], v[44:47], v[68:71], v[156:159]
    ds_read_b128 v[60:63], v6 offset:6144
    v_mfma_f32_16x16x32_bf16 v[160:163], v[44:47], v[72:75], v[160:163]
    ds_read_b64_tr_b16 v[40:41], v90 offset:0
    v_mfma_f32_16x16x32_bf16 v[164:167], v[44:47], v[76:79], v[164:167]
    ds_read_b64_tr_b16 v[42:43], v90 offset:1024
    v_mfma_f32_16x16x32_bf16 v[20:23], v[28:31], v[24:27], v[20:23]
    s_waitcnt lgkmcnt(2)
    v_mfma_f32_16x16x32_bf16 v[104:107], v[32:35], v[48:51], v[104:107]
    ds_read_b64_tr_b16 v[28:29], v4 offset:0
    v_mfma_f32_16x16x32_bf16 v[108:111], v[32:35], v[52:55], v[108:111]
    ds_read_b64_tr_b16 v[30:31], v4 offset:1024
    v_mfma_f32_16x16x32_bf16 v[112:115], v[32:35], v[56:59], v[112:115]
    ds_read_b64_tr_b16 v[44:45], v91 offset:0
    v_mfma_f32_16x16x32_bf16 v[116:119], v[32:35], v[60:63], v[116:119]
    ds_read_b64_tr_b16 v[46:47], v91 offset:1024
    v_mfma_f32_16x16x32_bf16 v[120:123], v[36:39], v[48:51], v[120:123]
    ds_read_b64_tr_b16 v[32:33], v2 offset:8192
    v_mfma_f32_16x16x32_bf16 v[124:127], v[36:39], v[52:55], v[124:127]
    ds_read_b64_tr_b16 v[34:35], v2 offset:9216
    v_mfma_f32_16x16x32_bf16 v[128:131], v[36:39], v[56:59], v[128:131]
    ds_read_b128 v[64:67], v7 offset:0
    v_mfma_f32_16x16x32_bf16 v[132:135], v[36:39], v[60:63], v[132:135]
    ds_read_b128 v[68:71], v7 offset:2048
    s_waitcnt lgkmcnt(8)
    v_mfma_f32_16x16x32_bf16 v[136:139], v[40:43], v[48:51], v[136:139]
    ds_read_b64_tr_b16 v[36:37], v3 offset:8192
    v_mfma_f32_16x16x32_bf16 v[140:143], v[40:43], v[52:55], v[140:143]
    ds_read_b64_tr_b16 v[38:39], v3 offset:9216
    v_mfma_f32_16x16x32_bf16 v[144:147], v[40:43], v[56:59], v[144:147]
    ds_read_b128 v[72:75], v7 offset:4096
    v_mfma_f32_16x16x32_bf16 v[148:151], v[40:43], v[60:63], v[148:151]
    ds_read_b128 v[76:79], v7 offset:6144
    s_waitcnt lgkmcnt(8)
    v_mfma_f32_16x16x32_bf16 v[152:155], v[44:47], v[48:51], v[152:155]
    ds_read_b64_tr_b16 v[40:41], v90 offset:8192
    v_mfma_f32_16x16x32_bf16 v[156:159], v[44:47], v[52:55], v[156:159]
    ds_read_b64_tr_b16 v[42:43], v90 offset:9216
    v_mfma_f32_16x16x32_bf16 v[160:163], v[44:47], v[56:59], v[160:163]
    ds_read_b64_tr_b16 v[82:83], v5 offset:160
    v_mfma_f32_16x16x32_bf16 v[164:167], v[44:47], v[60:63], v[164:167]
    ds_read_b64_tr_b16 v[94:95], v5 offset:192
    v_mfma_f32_16x16x32_bf16 v[20:23], v[28:31], v[24:27], v[20:23]
    s_waitcnt lgkmcnt(4)
    v_mfma_f32_16x16x32_bf16 v[104:107], v[32:35], v[64:67], v[104:107]
    ds_read_b64_tr_b16 v[28:29], v4 offset:8192
    v_mfma_f32_16x16x32_bf16 v[108:111], v[32:35], v[68:71], v[108:111]
    ds_read_b64_tr_b16 v[30:31], v4 offset:9216
    v_mfma_f32_16x16x32_bf16 v[112:115], v[32:35], v[72:75], v[112:115]
    ds_read_b64_tr_b16 v[44:45], v91 offset:8192
    v_mfma_f32_16x16x32_bf16 v[116:119], v[32:35], v[76:79], v[116:119]
    ds_read_b64_tr_b16 v[46:47], v91 offset:9216
    v_mfma_f32_16x16x32_bf16 v[120:123], v[36:39], v[64:67], v[120:123]
    v_mfma_f32_16x16x32_bf16 v[124:127], v[36:39], v[68:71], v[124:127]
    v_mfma_f32_16x16x32_bf16 v[128:131], v[36:39], v[72:75], v[128:131]
    v_mfma_f32_16x16x32_bf16 v[132:135], v[36:39], v[76:79], v[132:135]
    s_waitcnt lgkmcnt(0)
    s_barrier
    v_mfma_f32_16x16x32_bf16 v[136:139], v[40:43], v[64:67], v[136:139]
    ds_read_b128 v[48:51], v6 offset:8192
    ds_read_b128 v[52:55], v6 offset:10240
    v_mfma_f32_16x16x32_bf16 v[140:143], v[40:43], v[68:71], v[140:143]
    ds_read_b64_tr_b16 v[32:33], v2 offset:16384
    ds_read_b64_tr_b16 v[34:35], v2 offset:17408
    v_mfma_f32_16x16x32_bf16 v[144:147], v[40:43], v[72:75], v[144:147]
    ds_read_b64_tr_b16 v[36:37], v3 offset:16384
    v_mfma_f32_16x16x32_bf16 v[148:151], v[40:43], v[76:79], v[148:151]
    ds_read_b64_tr_b16 v[38:39], v3 offset:17408
    v_mfma_f32_16x16x32_bf16 v[152:155], v[44:47], v[64:67], v[152:155]
    ds_read_b128 v[56:59], v6 offset:12288
    v_mfma_f32_16x16x32_bf16 v[156:159], v[44:47], v[68:71], v[156:159]
    ds_read_b128 v[60:63], v6 offset:14336
    v_mfma_f32_16x16x32_bf16 v[160:163], v[44:47], v[72:75], v[160:163]
    ds_read_b64_tr_b16 v[40:41], v90 offset:16384
    v_mfma_f32_16x16x32_bf16 v[164:167], v[44:47], v[76:79], v[164:167]
    ds_read_b64_tr_b16 v[42:43], v90 offset:17408
    v_mfma_f32_16x16x32_bf16 v[20:23], v[28:31], v[24:27], v[20:23]
    s_waitcnt lgkmcnt(2)
    v_mfma_f32_16x16x32_bf16 v[104:107], v[32:35], v[48:51], v[104:107]
    ds_read_b64_tr_b16 v[28:29], v4 offset:16384
    v_mfma_f32_16x16x32_bf16 v[108:111], v[32:35], v[52:55], v[108:111]
    ds_read_b64_tr_b16 v[30:31], v4 offset:17408
    v_mfma_f32_16x16x32_bf16 v[112:115], v[32:35], v[56:59], v[112:115]
    ds_read_b64_tr_b16 v[44:45], v91 offset:16384
    v_mfma_f32_16x16x32_bf16 v[116:119], v[32:35], v[60:63], v[116:119]
    ds_read_b64_tr_b16 v[46:47], v91 offset:17408
    v_mfma_f32_16x16x32_bf16 v[120:123], v[36:39], v[48:51], v[120:123]
    ds_read_b64_tr_b16 v[32:33], v2 offset:24576
    v_mfma_f32_16x16x32_bf16 v[124:127], v[36:39], v[52:55], v[124:127]
    ds_read_b64_tr_b16 v[34:35], v2 offset:25600
    v_mfma_f32_16x16x32_bf16 v[128:131], v[36:39], v[56:59], v[128:131]
    ds_read_b128 v[64:67], v7 offset:8192
    v_mfma_f32_16x16x32_bf16 v[132:135], v[36:39], v[60:63], v[132:135]
    ds_read_b128 v[68:71], v7 offset:10240
    s_waitcnt lgkmcnt(8)
    v_mfma_f32_16x16x32_bf16 v[136:139], v[40:43], v[48:51], v[136:139]
    ds_read_b64_tr_b16 v[36:37], v3 offset:24576
    v_mfma_f32_16x16x32_bf16 v[140:143], v[40:43], v[52:55], v[140:143]
    ds_read_b64_tr_b16 v[38:39], v3 offset:25600
    v_mfma_f32_16x16x32_bf16 v[144:147], v[40:43], v[56:59], v[144:147]
    ds_read_b128 v[72:75], v7 offset:12288
    v_mfma_f32_16x16x32_bf16 v[148:151], v[40:43], v[60:63], v[148:151]
    ds_read_b128 v[76:79], v7 offset:14336
    s_waitcnt lgkmcnt(8)
    v_mfma_f32_16x16x32_bf16 v[152:155], v[44:47], v[48:51], v[152:155]
    ds_read_b64_tr_b16 v[40:41], v90 offset:24576
    v_mfma_f32_16x16x32_bf16 v[156:159], v[44:47], v[52:55], v[156:159]
    ds_read_b64_tr_b16 v[42:43], v90 offset:25600
    v_mfma_f32_16x16x32_bf16 v[160:163], v[44:47], v[56:59], v[160:163]
    ds_read_b64_tr_b16 v[84:85], v5 offset:320
    v_mfma_f32_16x16x32_bf16 v[164:167], v[44:47], v[60:63], v[164:167]
    ds_read_b64_tr_b16 v[96:97], v5 offset:352
    v_mfma_f32_16x16x32_bf16 v[20:23], v[28:31], v[24:27], v[20:23]
    s_waitcnt lgkmcnt(4)
    v_mfma_f32_16x16x32_bf16 v[104:107], v[32:35], v[64:67], v[104:107]
    ds_read_b64_tr_b16 v[28:29], v4 offset:24576
    v_mfma_f32_16x16x32_bf16 v[108:111], v[32:35], v[68:71], v[108:111]
    ds_read_b64_tr_b16 v[30:31], v4 offset:25600
    v_mfma_f32_16x16x32_bf16 v[112:115], v[32:35], v[72:75], v[112:115]
    ds_read_b64_tr_b16 v[44:45], v91 offset:24576
    v_mfma_f32_16x16x32_bf16 v[116:119], v[32:35], v[76:79], v[116:119]
    ds_read_b64_tr_b16 v[46:47], v91 offset:25600
    v_mfma_f32_16x16x32_bf16 v[120:123], v[36:39], v[64:67], v[120:123]
    v_mfma_f32_16x16x32_bf16 v[124:127], v[36:39], v[68:71], v[124:127]
    v_mfma_f32_16x16x32_bf16 v[128:131], v[36:39], v[72:75], v[128:131]
    v_mfma_f32_16x16x32_bf16 v[132:135], v[36:39], v[76:79], v[132:135]
    s_waitcnt lgkmcnt(0)
    s_barrier
    v_mfma_f32_16x16x32_bf16 v[136:139], v[40:43], v[64:67], v[136:139]
    ds_read_b128 v[48:51], v6 offset:16384
    ds_read_b128 v[52:55], v6 offset:18432
    v_mfma_f32_16x16x32_bf16 v[140:143], v[40:43], v[68:71], v[140:143]
    ds_read_b64_tr_b16 v[32:33], v2 offset:32768
    ds_read_b64_tr_b16 v[34:35], v2 offset:33792
    v_mfma_f32_16x16x32_bf16 v[144:147], v[40:43], v[72:75], v[144:147]
    ds_read_b64_tr_b16 v[36:37], v3 offset:32768
    v_mfma_f32_16x16x32_bf16 v[148:151], v[40:43], v[76:79], v[148:151]
    ds_read_b64_tr_b16 v[38:39], v3 offset:33792
    v_mfma_f32_16x16x32_bf16 v[152:155], v[44:47], v[64:67], v[152:155]
    ds_read_b128 v[56:59], v6 offset:20480
    v_mfma_f32_16x16x32_bf16 v[156:159], v[44:47], v[68:71], v[156:159]
    ds_read_b128 v[60:63], v6 offset:22528
    v_mfma_f32_16x16x32_bf16 v[160:163], v[44:47], v[72:75], v[160:163]
    ds_read_b64_tr_b16 v[40:41], v90 offset:32768
    v_mfma_f32_16x16x32_bf16 v[164:167], v[44:47], v[76:79], v[164:167]
    ds_read_b64_tr_b16 v[42:43], v90 offset:33792
    v_mfma_f32_16x16x32_bf16 v[20:23], v[28:31], v[24:27], v[20:23]
    s_waitcnt lgkmcnt(2)
    v_mfma_f32_16x16x32_bf16 v[104:107], v[32:35], v[48:51], v[104:107]
    ds_read_b64_tr_b16 v[28:29], v4 offset:32768
    v_mfma_f32_16x16x32_bf16 v[108:111], v[32:35], v[52:55], v[108:111]
    ds_read_b64_tr_b16 v[30:31], v4 offset:33792
    v_mfma_f32_16x16x32_bf16 v[112:115], v[32:35], v[56:59], v[112:115]
    ds_read_b64_tr_b16 v[44:45], v91 offset:32768
    v_mfma_f32_16x16x32_bf16 v[116:119], v[32:35], v[60:63], v[116:119]
    ds_read_b64_tr_b16 v[46:47], v91 offset:33792
    v_mfma_f32_16x16x32_bf16 v[120:123], v[36:39], v[48:51], v[120:123]
    ds_read_b64_tr_b16 v[32:33], v2 offset:40960
    v_mfma_f32_16x16x32_bf16 v[124:127], v[36:39], v[52:55], v[124:127]
    ds_read_b64_tr_b16 v[34:35], v2 offset:41984
    v_mfma_f32_16x16x32_bf16 v[128:131], v[36:39], v[56:59], v[128:131]
    ds_read_b128 v[64:67], v7 offset:16384
    v_mfma_f32_16x16x32_bf16 v[132:135], v[36:39], v[60:63], v[132:135]
    ds_read_b128 v[68:71], v7 offset:18432
    s_waitcnt lgkmcnt(8)
    v_mfma_f32_16x16x32_bf16 v[136:139], v[40:43], v[48:51], v[136:139]
    ds_read_b64_tr_b16 v[36:37], v3 offset:40960
    v_mfma_f32_16x16x32_bf16 v[140:143], v[40:43], v[52:55], v[140:143]
    ds_read_b64_tr_b16 v[38:39], v3 offset:41984
    v_mfma_f32_16x16x32_bf16 v[144:147], v[40:43], v[56:59], v[144:147]
    ds_read_b128 v[72:75], v7 offset:20480
    v_mfma_f32_16x16x32_bf16 v[148:151], v[40:43], v[60:63], v[148:151]
    ds_read_b128 v[76:79], v7 offset:22528
    s_waitcnt lgkmcnt(8)
    v_mfma_f32_16x16x32_bf16 v[152:155], v[44:47], v[48:51], v[152:155]
    ds_read_b64_tr_b16 v[40:41], v90 offset:40960
    v_mfma_f32_16x16x32_bf16 v[156:159], v[44:47], v[52:55], v[156:159]
    ds_read_b64_tr_b16 v[42:43], v90 offset:41984
    v_mfma_f32_16x16x32_bf16 v[160:163], v[44:47], v[56:59], v[160:163]
    ds_read_b64_tr_b16 v[86:87], v5 offset:480
    v_mfma_f32_16x16x32_bf16 v[164:167], v[44:47], v[60:63], v[164:167]
    ds_read_b64_tr_b16 v[98:99], v5 offset:512
    v_mfma_f32_16x16x32_bf16 v[20:23], v[28:31], v[24:27], v[20:23]
    s_waitcnt lgkmcnt(4)
    v_mfma_f32_16x16x32_bf16 v[104:107], v[32:35], v[64:67], v[104:107]
    ds_read_b64_tr_b16 v[28:29], v4 offset:40960
    v_mfma_f32_16x16x32_bf16 v[108:111], v[32:35], v[68:71], v[108:111]
    ds_read_b64_tr_b16 v[30:31], v4 offset:41984
    v_mfma_f32_16x16x32_bf16 v[112:115], v[32:35], v[72:75], v[112:115]
    ds_read_b64_tr_b16 v[44:45], v91 offset:40960
    v_mfma_f32_16x16x32_bf16 v[116:119], v[32:35], v[76:79], v[116:119]
    ds_read_b64_tr_b16 v[46:47], v91 offset:41984
    v_mfma_f32_16x16x32_bf16 v[120:123], v[36:39], v[64:67], v[120:123]
    v_mfma_f32_16x16x32_bf16 v[124:127], v[36:39], v[68:71], v[124:127]
    v_mfma_f32_16x16x32_bf16 v[128:131], v[36:39], v[72:75], v[128:131]
    v_mfma_f32_16x16x32_bf16 v[132:135], v[36:39], v[76:79], v[132:135]
    s_waitcnt lgkmcnt(0)
    s_barrier
    v_mfma_f32_16x16x32_bf16 v[136:139], v[40:43], v[64:67], v[136:139]
    ds_read_b128 v[48:51], v6 offset:0
    ds_read_b128 v[52:55], v6 offset:2048
    v_mfma_f32_16x16x32_bf16 v[140:143], v[40:43], v[68:71], v[140:143]
    ds_read_b64_tr_b16 v[32:33], v2 offset:0
    ds_read_b64_tr_b16 v[34:35], v2 offset:1024
    v_mfma_f32_16x16x32_bf16 v[144:147], v[40:43], v[72:75], v[144:147]
    ds_read_b64_tr_b16 v[36:37], v3 offset:0
    v_mfma_f32_16x16x32_bf16 v[148:151], v[40:43], v[76:79], v[148:151]
    ds_read_b64_tr_b16 v[38:39], v3 offset:1024
    v_mfma_f32_16x16x32_bf16 v[152:155], v[44:47], v[64:67], v[152:155]
    ds_read_b128 v[56:59], v6 offset:4096
    v_mfma_f32_16x16x32_bf16 v[156:159], v[44:47], v[68:71], v[156:159]
    ds_read_b128 v[60:63], v6 offset:6144
    v_mfma_f32_16x16x32_bf16 v[160:163], v[44:47], v[72:75], v[160:163]
    ds_read_b64_tr_b16 v[40:41], v90 offset:0
    v_mfma_f32_16x16x32_bf16 v[164:167], v[44:47], v[76:79], v[164:167]
    ds_read_b64_tr_b16 v[42:43], v90 offset:1024
    v_mfma_f32_16x16x32_bf16 v[20:23], v[28:31], v[24:27], v[20:23]
    s_waitcnt lgkmcnt(2)
    v_mfma_f32_16x16x32_bf16 v[104:107], v[32:35], v[48:51], v[104:107]
    ds_read_b64_tr_b16 v[28:29], v4 offset:0
    v_mfma_f32_16x16x32_bf16 v[108:111], v[32:35], v[52:55], v[108:111]
    ds_read_b64_tr_b16 v[30:31], v4 offset:1024
    v_mfma_f32_16x16x32_bf16 v[112:115], v[32:35], v[56:59], v[112:115]
    ds_read_b64_tr_b16 v[44:45], v91 offset:0
    v_mfma_f32_16x16x32_bf16 v[116:119], v[32:35], v[60:63], v[116:119]
    ds_read_b64_tr_b16 v[46:47], v91 offset:1024
    v_mfma_f32_16x16x32_bf16 v[120:123], v[36:39], v[48:51], v[120:123]
    ds_read_b64_tr_b16 v[32:33], v2 offset:8192
    v_mfma_f32_16x16x32_bf16 v[124:127], v[36:39], v[52:55], v[124:127]
    ds_read_b64_tr_b16 v[34:35], v2 offset:9216
    v_mfma_f32_16x16x32_bf16 v[128:131], v[36:39], v[56:59], v[128:131]
    ds_read_b128 v[64:67], v7 offset:0
    v_mfma_f32_16x16x32_bf16 v[132:135], v[36:39], v[60:63], v[132:135]
    ds_read_b128 v[68:71], v7 offset:2048
    s_waitcnt lgkmcnt(8)
    v_mfma_f32_16x16x32_bf16 v[136:139], v[40:43], v[48:51], v[136:139]
    ds_read_b64_tr_b16 v[36:37], v3 offset:8192
    v_mfma_f32_16x16x32_bf16 v[140:143], v[40:43], v[52:55], v[140:143]
    ds_read_b64_tr_b16 v[38:39], v3 offset:9216
    v_mfma_f32_16x16x32_bf16 v[144:147], v[40:43], v[56:59], v[144:147]
    ds_read_b128 v[72:75], v7 offset:4096
    v_mfma_f32_16x16x32_bf16 v[148:151], v[40:43], v[60:63], v[148:151]
    ds_read_b128 v[76:79], v7 offset:6144
    s_waitcnt lgkmcnt(8)
    v_mfma_f32_16x16x32_bf16 v[152:155], v[44:47], v[48:51], v[152:155]
    ds_read_b64_tr_b16 v[40:41], v90 offset:8192
    v_mfma_f32_16x16x32_bf16 v[156:159], v[44:47], v[52:55], v[156:159]
    ds_read_b64_tr_b16 v[42:43], v90 offset:9216
    v_mfma_f32_16x16x32_bf16 v[160:163], v[44:47], v[56:59], v[160:163]
    ds_read_b64_tr_b16 v[88:89], v5 offset:640
    v_mfma_f32_16x16x32_bf16 v[164:167], v[44:47], v[60:63], v[164:167]
    ds_read_b64_tr_b16 v[100:101], v5 offset:672
    v_mfma_f32_16x16x32_bf16 v[20:23], v[28:31], v[24:27], v[20:23]
    s_waitcnt lgkmcnt(4)
    v_mfma_f32_16x16x32_bf16 v[104:107], v[32:35], v[64:67], v[104:107]
    ds_read_b64_tr_b16 v[28:29], v4 offset:8192
    v_mfma_f32_16x16x32_bf16 v[108:111], v[32:35], v[68:71], v[108:111]
    ds_read_b64_tr_b16 v[30:31], v4 offset:9216
    v_mfma_f32_16x16x32_bf16 v[112:115], v[32:35], v[72:75], v[112:115]
    ds_read_b64_tr_b16 v[44:45], v91 offset:8192
    v_mfma_f32_16x16x32_bf16 v[116:119], v[32:35], v[76:79], v[116:119]
    ds_read_b64_tr_b16 v[46:47], v91 offset:9216
    v_mfma_f32_16x16x32_bf16 v[120:123], v[36:39], v[64:67], v[120:123]
    v_mfma_f32_16x16x32_bf16 v[124:127], v[36:39], v[68:71], v[124:127]
    v_mfma_f32_16x16x32_bf16 v[128:131], v[36:39], v[72:75], v[128:131]
    v_mfma_f32_16x16x32_bf16 v[132:135], v[36:39], v[76:79], v[132:135]
    s_waitcnt lgkmcnt(0)
    s_barrier
    v_mfma_f32_16x16x32_bf16 v[136:139], v[40:43], v[64:67], v[136:139]
    ds_read_b128 v[48:51], v6 offset:8192
    ds_read_b128 v[52:55], v6 offset:10240
    v_mfma_f32_16x16x32_bf16 v[140:143], v[40:43], v[68:71], v[140:143]
    ds_read_b64_tr_b16 v[32:33], v2 offset:16384
    ds_read_b64_tr_b16 v[34:35], v2 offset:17408
    v_mfma_f32_16x16x32_bf16 v[144:147], v[40:43], v[72:75], v[144:147]
    ds_read_b64_tr_b16 v[36:37], v3 offset:16384
    v_mfma_f32_16x16x32_bf16 v[148:151], v[40:43], v[76:79], v[148:151]
    ds_read_b64_tr_b16 v[38:39], v3 offset:17408
    v_mfma_f32_16x16x32_bf16 v[152:155], v[44:47], v[64:67], v[152:155]
    ds_read_b128 v[56:59], v6 offset:12288
    v_mfma_f32_16x16x32_bf16 v[156:159], v[44:47], v[68:71], v[156:159]
    ds_read_b128 v[60:63], v6 offset:14336
    v_mfma_f32_16x16x32_bf16 v[160:163], v[44:47], v[72:75], v[160:163]
    ds_read_b64_tr_b16 v[40:41], v90 offset:16384
    v_mfma_f32_16x16x32_bf16 v[164:167], v[44:47], v[76:79], v[164:167]
    ds_read_b64_tr_b16 v[42:43], v90 offset:17408
    v_mfma_f32_16x16x32_bf16 v[20:23], v[28:31], v[24:27], v[20:23]
    s_waitcnt lgkmcnt(2)
    v_mfma_f32_16x16x32_bf16 v[104:107], v[32:35], v[48:51], v[104:107]
    ds_read_b64_tr_b16 v[28:29], v4 offset:16384
    v_mfma_f32_16x16x32_bf16 v[108:111], v[32:35], v[52:55], v[108:111]
    ds_read_b64_tr_b16 v[30:31], v4 offset:17408
    v_mfma_f32_16x16x32_bf16 v[112:115], v[32:35], v[56:59], v[112:115]
    ds_read_b64_tr_b16 v[44:45], v91 offset:16384
    v_mfma_f32_16x16x32_bf16 v[116:119], v[32:35], v[60:63], v[116:119]
    ds_read_b64_tr_b16 v[46:47], v91 offset:17408
    v_mfma_f32_16x16x32_bf16 v[120:123], v[36:39], v[48:51], v[120:123]
    ds_read_b64_tr_b16 v[32:33], v2 offset:24576
    v_mfma_f32_16x16x32_bf16 v[124:127], v[36:39], v[52:55], v[124:127]
    ds_read_b64_tr_b16 v[34:35], v2 offset:25600
    v_mfma_f32_16x16x32_bf16 v[128:131], v[36:39], v[56:59], v[128:131]
    ds_read_b128 v[64:67], v7 offset:8192
    v_mfma_f32_16x16x32_bf16 v[132:135], v[36:39], v[60:63], v[132:135]
    ds_read_b128 v[68:71], v7 offset:10240
    s_waitcnt lgkmcnt(8)
    v_mfma_f32_16x16x32_bf16 v[136:139], v[40:43], v[48:51], v[136:139]
    ds_read_b64_tr_b16 v[36:37], v3 offset:24576
    v_mfma_f32_16x16x32_bf16 v[140:143], v[40:43], v[52:55], v[140:143]
    ds_read_b64_tr_b16 v[38:39], v3 offset:25600
    v_mfma_f32_16x16x32_bf16 v[144:147], v[40:43], v[56:59], v[144:147]
    ds_read_b128 v[72:75], v7 offset:12288
    v_mfma_f32_16x16x32_bf16 v[148:151], v[40:43], v[60:63], v[148:151]
    ds_read_b128 v[76:79], v7 offset:14336
    s_waitcnt lgkmcnt(8)
    v_mfma_f32_16x16x32_bf16 v[152:155], v[44:47], v[48:51], v[152:155]
    ds_read_b64_tr_b16 v[40:41], v90 offset:24576
    v_mfma_f32_16x16x32_bf16 v[156:159], v[44:47], v[52:55], v[156:159]
    ds_read_b64_tr_b16 v[42:43], v90 offset:25600
    v_mfma_f32_16x16x32_bf16 v[160:163], v[44:47], v[56:59], v[160:163]
    v_mfma_f32_16x16x32_bf16 v[164:167], v[44:47], v[60:63], v[164:167]
    v_mfma_f32_16x16x32_bf16 v[20:23], v[28:31], v[24:27], v[20:23]
    s_waitcnt lgkmcnt(2)
    v_mfma_f32_16x16x32_bf16 v[104:107], v[32:35], v[64:67], v[104:107]
    ds_read_b64_tr_b16 v[28:29], v4 offset:24576
    v_mfma_f32_16x16x32_bf16 v[108:111], v[32:35], v[68:71], v[108:111]
    ds_read_b64_tr_b16 v[30:31], v4 offset:25600
    v_mfma_f32_16x16x32_bf16 v[112:115], v[32:35], v[72:75], v[112:115]
    ds_read_b64_tr_b16 v[44:45], v91 offset:24576
    v_mfma_f32_16x16x32_bf16 v[116:119], v[32:35], v[76:79], v[116:119]
    ds_read_b64_tr_b16 v[46:47], v91 offset:25600
    v_mfma_f32_16x16x32_bf16 v[120:123], v[36:39], v[64:67], v[120:123]
    v_mfma_f32_16x16x32_bf16 v[124:127], v[36:39], v[68:71], v[124:127]
    v_mfma_f32_16x16x32_bf16 v[128:131], v[36:39], v[72:75], v[128:131]
    v_mfma_f32_16x16x32_bf16 v[132:135], v[36:39], v[76:79], v[132:135]
    s_waitcnt lgkmcnt(0)
    s_barrier
    v_mfma_f32_16x16x32_bf16 v[136:139], v[40:43], v[64:67], v[136:139]
    ds_read_b128 v[48:51], v6 offset:16384
    ds_read_b128 v[52:55], v6 offset:18432
    v_mfma_f32_16x16x32_bf16 v[140:143], v[40:43], v[68:71], v[140:143]
    ds_read_b64_tr_b16 v[32:33], v2 offset:32768
    ds_read_b64_tr_b16 v[34:35], v2 offset:33792
    v_mfma_f32_16x16x32_bf16 v[144:147], v[40:43], v[72:75], v[144:147]
    ds_read_b64_tr_b16 v[36:37], v3 offset:32768
    v_mfma_f32_16x16x32_bf16 v[148:151], v[40:43], v[76:79], v[148:151]
    ds_read_b64_tr_b16 v[38:39], v3 offset:33792
    v_mfma_f32_16x16x32_bf16 v[152:155], v[44:47], v[64:67], v[152:155]
    ds_read_b128 v[56:59], v6 offset:20480
    v_mfma_f32_16x16x32_bf16 v[156:159], v[44:47], v[68:71], v[156:159]
    ds_read_b128 v[60:63], v6 offset:22528
    v_mfma_f32_16x16x32_bf16 v[160:163], v[44:47], v[72:75], v[160:163]
    ds_read_b64_tr_b16 v[40:41], v90 offset:32768
    v_mfma_f32_16x16x32_bf16 v[164:167], v[44:47], v[76:79], v[164:167]
    ds_read_b64_tr_b16 v[42:43], v90 offset:33792
    v_mfma_f32_16x16x32_bf16 v[20:23], v[28:31], v[24:27], v[20:23]
    s_waitcnt lgkmcnt(2)
    v_mfma_f32_16x16x32_bf16 v[104:107], v[32:35], v[48:51], v[104:107]
    ds_read_b64_tr_b16 v[28:29], v4 offset:32768
    v_mfma_f32_16x16x32_bf16 v[108:111], v[32:35], v[52:55], v[108:111]
    ds_read_b64_tr_b16 v[30:31], v4 offset:33792
    v_mfma_f32_16x16x32_bf16 v[112:115], v[32:35], v[56:59], v[112:115]
    ds_read_b64_tr_b16 v[44:45], v91 offset:32768
    v_mfma_f32_16x16x32_bf16 v[116:119], v[32:35], v[60:63], v[116:119]
    ds_read_b64_tr_b16 v[46:47], v91 offset:33792
    v_mfma_f32_16x16x32_bf16 v[120:123], v[36:39], v[48:51], v[120:123]
    ds_read_b64_tr_b16 v[32:33], v2 offset:40960
    v_mfma_f32_16x16x32_bf16 v[124:127], v[36:39], v[52:55], v[124:127]
    ds_read_b64_tr_b16 v[34:35], v2 offset:41984
    v_mfma_f32_16x16x32_bf16 v[128:131], v[36:39], v[56:59], v[128:131]
    ds_read_b128 v[64:67], v7 offset:16384
    v_mfma_f32_16x16x32_bf16 v[132:135], v[36:39], v[60:63], v[132:135]
    ds_read_b128 v[68:71], v7 offset:18432
    s_waitcnt lgkmcnt(8)
    v_mfma_f32_16x16x32_bf16 v[136:139], v[40:43], v[48:51], v[136:139]
    ds_read_b64_tr_b16 v[36:37], v3 offset:40960
    v_mfma_f32_16x16x32_bf16 v[140:143], v[40:43], v[52:55], v[140:143]
    ds_read_b64_tr_b16 v[38:39], v3 offset:41984
    v_mfma_f32_16x16x32_bf16 v[144:147], v[40:43], v[56:59], v[144:147]
    ds_read_b128 v[72:75], v7 offset:20480
    v_mfma_f32_16x16x32_bf16 v[148:151], v[40:43], v[60:63], v[148:151]
    ds_read_b128 v[76:79], v7 offset:22528
    s_waitcnt lgkmcnt(8)
    v_mfma_f32_16x16x32_bf16 v[152:155], v[44:47], v[48:51], v[152:155]
    ds_read_b64_tr_b16 v[40:41], v90 offset:40960
    v_mfma_f32_16x16x32_bf16 v[156:159], v[44:47], v[52:55], v[156:159]
    ds_read_b64_tr_b16 v[42:43], v90 offset:41984
    v_mfma_f32_16x16x32_bf16 v[160:163], v[44:47], v[56:59], v[160:163]
    v_mfma_f32_16x16x32_bf16 v[164:167], v[44:47], v[60:63], v[164:167]
    v_mfma_f32_16x16x32_bf16 v[20:23], v[28:31], v[24:27], v[20:23]
    s_waitcnt lgkmcnt(2)
    v_mfma_f32_16x16x32_bf16 v[104:107], v[32:35], v[64:67], v[104:107]
    ds_read_b64_tr_b16 v[28:29], v4 offset:40960
    v_mfma_f32_16x16x32_bf16 v[108:111], v[32:35], v[68:71], v[108:111]
    ds_read_b64_tr_b16 v[30:31], v4 offset:41984
    v_mfma_f32_16x16x32_bf16 v[112:115], v[32:35], v[72:75], v[112:115]
    ds_read_b64_tr_b16 v[44:45], v91 offset:40960
    v_mfma_f32_16x16x32_bf16 v[116:119], v[32:35], v[76:79], v[116:119]
    ds_read_b64_tr_b16 v[46:47], v91 offset:41984
    v_mfma_f32_16x16x32_bf16 v[120:123], v[36:39], v[64:67], v[120:123]
    v_mfma_f32_16x16x32_bf16 v[124:127], v[36:39], v[68:71], v[124:127]
    v_mfma_f32_16x16x32_bf16 v[128:131], v[36:39], v[72:75], v[128:131]
    v_mfma_f32_16x16x32_bf16 v[132:135], v[36:39], v[76:79], v[132:135]
    s_waitcnt lgkmcnt(0)
    s_barrier
    v_mfma_f32_16x16x32_bf16 v[136:139], v[40:43], v[64:67], v[136:139]
    ds_read_b128 v[48:51], v6 offset:0
    ds_read_b128 v[52:55], v6 offset:2048
    v_mfma_f32_16x16x32_bf16 v[140:143], v[40:43], v[68:71], v[140:143]
    ds_read_b64_tr_b16 v[32:33], v2 offset:0
    ds_read_b64_tr_b16 v[34:35], v2 offset:1024
    v_mfma_f32_16x16x32_bf16 v[144:147], v[40:43], v[72:75], v[144:147]
    ds_read_b64_tr_b16 v[36:37], v3 offset:0
    v_mfma_f32_16x16x32_bf16 v[148:151], v[40:43], v[76:79], v[148:151]
    ds_read_b64_tr_b16 v[38:39], v3 offset:1024
    v_mfma_f32_16x16x32_bf16 v[152:155], v[44:47], v[64:67], v[152:155]
    ds_read_b128 v[56:59], v6 offset:4096
    v_mfma_f32_16x16x32_bf16 v[156:159], v[44:47], v[68:71], v[156:159]
    ds_read_b128 v[60:63], v6 offset:6144
    v_mfma_f32_16x16x32_bf16 v[160:163], v[44:47], v[72:75], v[160:163]
    ds_read_b64_tr_b16 v[40:41], v90 offset:0
    v_mfma_f32_16x16x32_bf16 v[164:167], v[44:47], v[76:79], v[164:167]
    ds_read_b64_tr_b16 v[42:43], v90 offset:1024
    v_mfma_f32_16x16x32_bf16 v[20:23], v[28:31], v[24:27], v[20:23]
    s_waitcnt lgkmcnt(2)
    v_mfma_f32_16x16x32_bf16 v[104:107], v[32:35], v[48:51], v[104:107]
    ds_read_b64_tr_b16 v[28:29], v4 offset:0
    v_mfma_f32_16x16x32_bf16 v[108:111], v[32:35], v[52:55], v[108:111]
    ds_read_b64_tr_b16 v[30:31], v4 offset:1024
    v_mfma_f32_16x16x32_bf16 v[112:115], v[32:35], v[56:59], v[112:115]
    ds_read_b64_tr_b16 v[44:45], v91 offset:0
    v_mfma_f32_16x16x32_bf16 v[116:119], v[32:35], v[60:63], v[116:119]
    ds_read_b64_tr_b16 v[46:47], v91 offset:1024
    s_lshl_b32 s50, s48, 9
    s_add_u32 s50, s50, 159744
    v_lshlrev_b32 v10, 3, v8
    v_lshlrev_b32 v11, 3, v1
    v_add_u32 v10, s50, v10
    v_add_u32 v11, s50, v11
    ds_read_b32 v12, v10 offset:0
    ds_read_b32 v13, v10 offset:128
    ds_read_b32 v14, v10 offset:256
    ds_read_b32 v15, v10 offset:384
    ds_read_b32 v17, v11 offset:4
    v_mfma_f32_16x16x32_bf16 v[120:123], v[36:39], v[48:51], v[120:123]
    ds_read_b64_tr_b16 v[32:33], v2 offset:8192
    v_mfma_f32_16x16x32_bf16 v[124:127], v[36:39], v[52:55], v[124:127]
    ds_read_b64_tr_b16 v[34:35], v2 offset:9216
    v_mfma_f32_16x16x32_bf16 v[128:131], v[36:39], v[56:59], v[128:131]
    ds_read_b128 v[64:67], v7 offset:0
    v_mfma_f32_16x16x32_bf16 v[132:135], v[36:39], v[60:63], v[132:135]
    ds_read_b128 v[68:71], v7 offset:2048
    s_waitcnt lgkmcnt(13)
    v_mfma_f32_16x16x32_bf16 v[136:139], v[40:43], v[48:51], v[136:139]
    ds_read_b64_tr_b16 v[36:37], v3 offset:8192
    v_mfma_f32_16x16x32_bf16 v[140:143], v[40:43], v[52:55], v[140:143]
    ds_read_b64_tr_b16 v[38:39], v3 offset:9216
    v_mfma_f32_16x16x32_bf16 v[144:147], v[40:43], v[56:59], v[144:147]
    ds_read_b128 v[72:75], v7 offset:4096
    v_mfma_f32_16x16x32_bf16 v[148:151], v[40:43], v[60:63], v[148:151]
    ds_read_b128 v[76:79], v7 offset:6144
    s_waitcnt lgkmcnt(13)
    v_mfma_f32_16x16x32_bf16 v[152:155], v[44:47], v[48:51], v[152:155]
    ds_read_b64_tr_b16 v[40:41], v90 offset:8192
    v_mfma_f32_16x16x32_bf16 v[156:159], v[44:47], v[52:55], v[156:159]
    ds_read_b64_tr_b16 v[42:43], v90 offset:9216
    v_mfma_f32_16x16x32_bf16 v[160:163], v[44:47], v[56:59], v[160:163]
    v_mfma_f32_16x16x32_bf16 v[164:167], v[44:47], v[60:63], v[164:167]
    v_mfma_f32_16x16x32_bf16 v[20:23], v[28:31], v[24:27], v[20:23]
    s_waitcnt lgkmcnt(2)
    v_mfma_f32_16x16x32_bf16 v[104:107], v[32:35], v[64:67], v[104:107]
    ds_read_b64_tr_b16 v[28:29], v4 offset:8192
    v_mfma_f32_16x16x32_bf16 v[108:111], v[32:35], v[68:71], v[108:111]
    ds_read_b64_tr_b16 v[30:31], v4 offset:9216
    v_mfma_f32_16x16x32_bf16 v[112:115], v[32:35], v[72:75], v[112:115]
    ds_read_b64_tr_b16 v[44:45], v91 offset:8192
    v_mfma_f32_16x16x32_bf16 v[116:119], v[32:35], v[76:79], v[116:119]
    ds_read_b64_tr_b16 v[46:47], v91 offset:9216
    v_mfma_f32_16x16x32_bf16 v[120:123], v[36:39], v[64:67], v[120:123]
    v_mfma_f32_16x16x32_bf16 v[124:127], v[36:39], v[68:71], v[124:127]
    v_mfma_f32_16x16x32_bf16 v[128:131], v[36:39], v[72:75], v[128:131]
    v_mfma_f32_16x16x32_bf16 v[132:135], v[36:39], v[76:79], v[132:135]
    s_waitcnt lgkmcnt(4)
    v_mfma_f32_16x16x32_bf16 v[136:139], v[40:43], v[64:67], v[136:139]
    v_mfma_f32_16x16x32_bf16 v[140:143], v[40:43], v[68:71], v[140:143]
    v_mfma_f32_16x16x32_bf16 v[144:147], v[40:43], v[72:75], v[144:147]
    v_mfma_f32_16x16x32_bf16 v[148:151], v[40:43], v[76:79], v[148:151]
    s_waitcnt lgkmcnt(0)
    v_mfma_f32_16x16x32_bf16 v[152:155], v[44:47], v[64:67], v[152:155]
    v_mfma_f32_16x16x32_bf16 v[156:159], v[44:47], v[68:71], v[156:159]
    v_mfma_f32_16x16x32_bf16 v[160:163], v[44:47], v[72:75], v[160:163]
    v_mfma_f32_16x16x32_bf16 v[164:167], v[44:47], v[76:79], v[164:167]
    v_mfma_f32_16x16x32_bf16 v[20:23], v[28:31], v[24:27], v[20:23]
    v_mov_b32 v90, 0
    v_mov_b32 v91, 0
    v_mov_b32 v102, 0
    v_mov_b32 v103, 0
    s_lshl_b32 s50, s49, 8
    s_add_u32 s50, s50, 147456
    v_lshlrev_b32 v2, 4, v9
    v_add_u32 v2, s50, v2
    s_lshl_b32 s50, s48, 6
    v_add_u32 v3, s50, v2
    s_lshl_b32 s50, s49, 8
    s_lshl_b32 s51, s48, 6
    s_add_u32 s50, s50, s51
    s_mul_i32 s59, s50, 176
    s_mov_b32 exec_lo, 0x00010001
    s_mov_b32 exec_hi, 0x00010001
    ds_write_b128 v3, v[20:23]
    s_mov_b64 exec, -1
    s_movk_i32 s50, 176
    v_mul_u32_u24 v4, s50, v8
    v_add_u32 v4, s59, v4
    v_lshl_add_u32 v3, v9, 3, v4
    v_lshlrev_b32 v5, 3, v9
    s_mov_b32 s51, 0x90508020
    v_lshrrev_b32 v5, v5, s51
    v_and_b32 v5, 0xff, v5
    v_add_u32 v4, v5, v4
    v_mul_u32_u24 v5, s50, v1
    v_add_u32 v5, s59, v5
    s_waitcnt lgkmcnt(0)
    s_barrier
    ds_read_b128 v[32:35], v2 offset:0
    ds_read_b128 v[36:39], v2 offset:64
    ds_read_b128 v[40:43], v2 offset:128
    ds_read_b128 v[44:47], v2 offset:192
    s_mul_i32 s50, s48, 11264
    s_mul_i32 s51, s49, 80
    s_add_u32 s50, s50, s51
    s_add_u32 s50, s50, 90112
    s_sub_u32 s50, s50, s59
    v_add_u32 v6, s50, v5
    s_waitcnt lgkmcnt(0)
    v_pk_fma_f32 v[104:105], v[32:33], v[12:13], v[104:105] op_sel_hi:[1,0,1] neg_lo:[1,0,0] neg_hi:[1,0,0]
    v_pk_fma_f32 v[106:107], v[34:35], v[12:13], v[106:107] op_sel_hi:[1,0,1] neg_lo:[1,0,0] neg_hi:[1,0,0]
    v_pk_fma_f32 v[108:109], v[32:33], v[12:13], v[108:109] op_sel:[0,1,0] op_sel_hi:[1,1,1] neg_lo:[1,0,0] neg_hi:[1,0,0]
    v_pk_fma_f32 v[110:111], v[34:35], v[12:13], v[110:111] op_sel:[0,1,0] op_sel_hi:[1,1,1] neg_lo:[1,0,0] neg_hi:[1,0,0]
    v_pk_fma_f32 v[112:113], v[32:33], v[14:15], v[112:113] op_sel_hi:[1,0,1] neg_lo:[1,0,0] neg_hi:[1,0,0]
    v_pk_fma_f32 v[114:115], v[34:35], v[14:15], v[114:115] op_sel_hi:[1,0,1] neg_lo:[1,0,0] neg_hi:[1,0,0]
    v_pk_fma_f32 v[116:117], v[32:33], v[14:15], v[116:117] op_sel:[0,1,0] op_sel_hi:[1,1,1] neg_lo:[1,0,0] neg_hi:[1,0,0]
    v_pk_fma_f32 v[118:119], v[34:35], v[14:15], v[118:119] op_sel:[0,1,0] op_sel_hi:[1,1,1] neg_lo:[1,0,0] neg_hi:[1,0,0]
    v_cvt_pk_bf16_f32 v104, v104, v105
    v_cvt_pk_bf16_f32 v105, v106, v107
    ds_write_b64 v3, v[104:105] offset:0
    v_cvt_pk_bf16_f32 v108, v108, v109
    v_cvt_pk_bf16_f32 v109, v110, v111
    ds_write_b64 v3, v[108:109] offset:2816
    v_cvt_pk_bf16_f32 v112, v112, v113
    v_cvt_pk_bf16_f32 v113, v114, v115
    ds_write_b64 v3, v[112:113] offset:5632
    v_cvt_pk_bf16_f32 v116, v116, v117
    v_cvt_pk_bf16_f32 v117, v118, v119
    ds_write_b64 v3, v[116:117] offset:8448
    v_pk_fma_f32 v[152:153], v[44:45], v[12:13], v[152:153] op_sel_hi:[1,0,1] neg_lo:[1,0,0] neg_hi:[1,0,0]
    v_pk_fma_f32 v[154:155], v[46:47], v[12:13], v[154:155] op_sel_hi:[1,0,1] neg_lo:[1,0,0] neg_hi:[1,0,0]
    v_pk_fma_f32 v[156:157], v[44:45], v[12:13], v[156:157] op_sel:[0,1,0] op_sel_hi:[1,1,1] neg_lo:[1,0,0] neg_hi:[1,0,0]
    v_pk_fma_f32 v[158:159], v[46:47], v[12:13], v[158:159] op_sel:[0,1,0] op_sel_hi:[1,1,1] neg_lo:[1,0,0] neg_hi:[1,0,0]
    v_pk_fma_f32 v[160:161], v[44:45], v[14:15], v[160:161] op_sel_hi:[1,0,1] neg_lo:[1,0,0] neg_hi:[1,0,0]
    v_pk_fma_f32 v[162:163], v[46:47], v[14:15], v[162:163] op_sel_hi:[1,0,1] neg_lo:[1,0,0] neg_hi:[1,0,0]
    v_pk_fma_f32 v[164:165], v[44:45], v[14:15], v[164:165] op_sel:[0,1,0] op_sel_hi:[1,1,1] neg_lo:[1,0,0] neg_hi:[1,0,0]
    v_pk_fma_f32 v[166:167], v[46:47], v[14:15], v[166:167] op_sel:[0,1,0] op_sel_hi:[1,1,1] neg_lo:[1,0,0] neg_hi:[1,0,0]
    v_cvt_pk_bf16_f32 v152, v152, v153
    v_cvt_pk_bf16_f32 v153, v154, v155
    ds_write_b64 v4, v[152:153] offset:0
    v_cvt_pk_bf16_f32 v156, v156, v157
    v_cvt_pk_bf16_f32 v157, v158, v159
    ds_write_b64 v4, v[156:157] offset:2816
    v_cvt_pk_bf16_f32 v160, v160, v161
    v_cvt_pk_bf16_f32 v161, v162, v163
    ds_write_b64 v4, v[160:161] offset:5632
    v_cvt_pk_bf16_f32 v164, v164, v165
    v_cvt_pk_bf16_f32 v165, v166, v167
    ds_write_b64 v4, v[164:165] offset:8448
    v_mov_b32 v30, 0
    v_mov_b32 v31, 0
    ds_read_b128 v[20:23], v5 offset:0
    ds_read_b128 v[24:27], v5 offset:16
    ds_read_b64 v[28:29], v5 offset:32
    v_mul_f32 v16, 0x3fb8aa3b, v17
    v_rcp_f32 v18, v17
    v_mov_b32 v19, 0
    s_waitcnt lgkmcnt(0)
    v_mfma_f32_32x32x16_bf16 v[48:63], v[80:83], v[20:23], 0
    v_mfma_f32_32x32x16_bf16 v[64:79], v[92:95], v[20:23], 0
    v_mfma_f32_32x32x16_bf16 v[48:63], v[84:87], v[24:27], v[48:63]
    v_mfma_f32_32x32x16_bf16 v[64:79], v[96:99], v[24:27], v[64:79]
    v_mfma_f32_32x32x16_bf16 v[48:63], v[88:91], v[28:31], v[48:63]
    v_mfma_f32_32x32x16_bf16 v[64:79], v[100:103], v[28:31], v[64:79]
    v_cvt_pk_bf16_f32 v18, v18, v19
    v_pk_fma_f32 v[120:121], v[36:37], v[12:13], v[120:121] op_sel_hi:[1,0,1] neg_lo:[1,0,0] neg_hi:[1,0,0]
    v_pk_fma_f32 v[122:123], v[38:39], v[12:13], v[122:123] op_sel_hi:[1,0,1] neg_lo:[1,0,0] neg_hi:[1,0,0]
    v_pk_fma_f32 v[124:125], v[36:37], v[12:13], v[124:125] op_sel:[0,1,0] op_sel_hi:[1,1,1] neg_lo:[1,0,0] neg_hi:[1,0,0]
    v_pk_fma_f32 v[126:127], v[38:39], v[12:13], v[126:127] op_sel:[0,1,0] op_sel_hi:[1,1,1] neg_lo:[1,0,0] neg_hi:[1,0,0]
    v_pk_fma_f32 v[128:129], v[36:37], v[14:15], v[128:129] op_sel_hi:[1,0,1] neg_lo:[1,0,0] neg_hi:[1,0,0]
    v_pk_fma_f32 v[130:131], v[38:39], v[14:15], v[130:131] op_sel_hi:[1,0,1] neg_lo:[1,0,0] neg_hi:[1,0,0]
    v_pk_fma_f32 v[132:133], v[36:37], v[14:15], v[132:133] op_sel:[0,1,0] op_sel_hi:[1,1,1] neg_lo:[1,0,0] neg_hi:[1,0,0]
    v_pk_fma_f32 v[134:135], v[38:39], v[14:15], v[134:135] op_sel:[0,1,0] op_sel_hi:[1,1,1] neg_lo:[1,0,0] neg_hi:[1,0,0]
    v_cvt_pk_bf16_f32 v120, v120, v121
    v_cvt_pk_bf16_f32 v121, v122, v123
    ds_write_b64 v3, v[120:121] offset:96
    v_cvt_pk_bf16_f32 v124, v124, v125
    v_cvt_pk_bf16_f32 v125, v126, v127
    ds_write_b64 v3, v[124:125] offset:2912
    v_cvt_pk_bf16_f32 v128, v128, v129
    v_cvt_pk_bf16_f32 v129, v130, v131
    ds_write_b64 v3, v[128:129] offset:5728
    v_cvt_pk_bf16_f32 v132, v132, v133
    v_cvt_pk_bf16_f32 v133, v134, v135
    ds_write_b64 v3, v[132:133] offset:8544
    ds_write_b64 v5, v[18:19] offset:136
    s_waitcnt lgkmcnt(0)
    s_nop 3
    v_max3_f32 v124, v48, v49, v50
    v_min3_f32 v125, v48, v49, v50
    v_max3_f32 v124, v124, v51, v52
    v_min3_f32 v125, v125, v51, v52
    v_max3_f32 v124, v124, v53, v54
    v_min3_f32 v125, v125, v53, v54
    v_max3_f32 v124, v124, v55, v56
    v_min3_f32 v125, v125, v55, v56
    v_max3_f32 v124, v124, v57, v58
    v_min3_f32 v125, v125, v57, v58
    v_max3_f32 v124, v124, v59, v60
    v_min3_f32 v125, v125, v59, v60
    v_max3_f32 v124, v124, v61, v62
    v_min3_f32 v125, v125, v61, v62
    v_max3_f32 v124, v124, v63, v64
    v_min3_f32 v125, v125, v63, v64
    v_max3_f32 v124, v124, v65, v66
    v_min3_f32 v125, v125, v65, v66
    v_max_f32 v124, v124, v67
    v_min_f32 v125, v125, v67
    v_pk_mul_f32 v[124:125], v[124:125], v[16:17] op_sel_hi:[1,0]
    v_pk_fma_f32 v[104:105], v[48:49], v[16:17], v[124:125] op_sel:[0,0,1] op_sel_hi:[1,0,1] neg_lo:[1,0,0] neg_hi:[1,0,0]
    v_pk_fma_f32 v[48:49], v[48:49], v[16:17], v[124:125] op_sel_hi:[1,0,0] neg_lo:[0,0,1] neg_hi:[0,0,1]
    v_pk_fma_f32 v[106:107], v[50:51], v[16:17], v[124:125] op_sel:[0,0,1] op_sel_hi:[1,0,1] neg_lo:[1,0,0] neg_hi:[1,0,0]
    v_pk_fma_f32 v[50:51], v[50:51], v[16:17], v[124:125] op_sel_hi:[1,0,0] neg_lo:[0,0,1] neg_hi:[0,0,1]
    v_pk_fma_f32 v[108:109], v[52:53], v[16:17], v[124:125] op_sel:[0,0,1] op_sel_hi:[1,0,1] neg_lo:[1,0,0] neg_hi:[1,0,0]
    v_pk_fma_f32 v[52:53], v[52:53], v[16:17], v[124:125] op_sel_hi:[1,0,0] neg_lo:[0,0,1] neg_hi:[0,0,1]
    v_pk_fma_f32 v[110:111], v[54:55], v[16:17], v[124:125] op_sel:[0,0,1] op_sel_hi:[1,0,1] neg_lo:[1,0,0] neg_hi:[1,0,0]
    v_pk_fma_f32 v[54:55], v[54:55], v[16:17], v[124:125] op_sel_hi:[1,0,0] neg_lo:[0,0,1] neg_hi:[0,0,1]
    v_pk_fma_f32 v[112:113], v[56:57], v[16:17], v[124:125] op_sel:[0,0,1] op_sel_hi:[1,0,1] neg_lo:[1,0,0] neg_hi:[1,0,0]
    v_pk_fma_f32 v[56:57], v[56:57], v[16:17], v[124:125] op_sel_hi:[1,0,0] neg_lo:[0,0,1] neg_hi:[0,0,1]
    v_pk_fma_f32 v[114:115], v[58:59], v[16:17], v[124:125] op_sel:[0,0,1] op_sel_hi:[1,0,1] neg_lo:[1,0,0] neg_hi:[1,0,0]
    v_pk_fma_f32 v[58:59], v[58:59], v[16:17], v[124:125] op_sel_hi:[1,0,0] neg_lo:[0,0,1] neg_hi:[0,0,1]
    v_pk_fma_f32 v[116:117], v[60:61], v[16:17], v[124:125] op_sel:[0,0,1] op_sel_hi:[1,0,1] neg_lo:[1,0,0] neg_hi:[1,0,0]
    v_pk_fma_f32 v[60:61], v[60:61], v[16:17], v[124:125] op_sel_hi:[1,0,0] neg_lo:[0,0,1] neg_hi:[0,0,1]
    v_pk_fma_f32 v[118:119], v[62:63], v[16:17], v[124:125] op_sel:[0,0,1] op_sel_hi:[1,0,1] neg_lo:[1,0,0] neg_hi:[1,0,0]
    v_pk_fma_f32 v[62:63], v[62:63], v[16:17], v[124:125] op_sel_hi:[1,0,0] neg_lo:[0,0,1] neg_hi:[0,0,1]
    v_pk_fma_f32 v[120:121], v[64:65], v[16:17], v[124:125] op_sel:[0,0,1] op_sel_hi:[1,0,1] neg_lo:[1,0,0] neg_hi:[1,0,0]
    v_pk_fma_f32 v[64:65], v[64:65], v[16:17], v[124:125] op_sel_hi:[1,0,0] neg_lo:[0,0,1] neg_hi:[0,0,1]
    v_pk_fma_f32 v[122:123], v[66:67], v[16:17], v[124:125] op_sel:[0,0,1] op_sel_hi:[1,0,1] neg_lo:[1,0,0] neg_hi:[1,0,0]
    v_pk_fma_f32 v[66:67], v[66:67], v[16:17], v[124:125] op_sel_hi:[1,0,0] neg_lo:[0,0,1] neg_hi:[0,0,1]
    v_exp_f32 v48, v48
    v_exp_f32 v104, v104
    v_exp_f32 v49, v49
    v_exp_f32 v105, v105
    v_exp_f32 v50, v50
    v_exp_f32 v106, v106
    v_exp_f32 v51, v51
    v_exp_f32 v107, v107
    v_exp_f32 v52, v52
    v_exp_f32 v108, v108
    v_exp_f32 v53, v53
    v_exp_f32 v109, v109
    v_exp_f32 v54, v54
    v_exp_f32 v110, v110
    v_exp_f32 v55, v55
    v_exp_f32 v111, v111
    v_exp_f32 v56, v56
    v_exp_f32 v112, v112
    v_exp_f32 v57, v57
    v_exp_f32 v113, v113
    v_exp_f32 v58, v58
    v_exp_f32 v114, v114
    v_exp_f32 v59, v59
    v_exp_f32 v115, v115
    v_exp_f32 v60, v60
    v_exp_f32 v116, v116
    v_exp_f32 v61, v61
    v_exp_f32 v117, v117
    v_exp_f32 v62, v62
    v_exp_f32 v118, v118
    v_exp_f32 v63, v63
    v_exp_f32 v119, v119
    v_exp_f32 v64, v64
    v_exp_f32 v120, v120
    v_exp_f32 v65, v65
    v_exp_f32 v121, v121
    v_exp_f32 v66, v66
    v_exp_f32 v122, v122
    v_exp_f32 v67, v67
    v_exp_f32 v123, v123
    v_pk_add_f32 v[124:125], v[48:49], v[50:51]
    v_pk_add_f32 v[126:127], v[104:105], v[106:107]
    v_pk_add_f32 v[124:125], v[124:125], v[52:53]
    v_pk_add_f32 v[126:127], v[126:127], v[108:109]
    v_pk_add_f32 v[124:125], v[124:125], v[54:55]
    v_pk_add_f32 v[126:127], v[126:127], v[110:111]
    v_pk_add_f32 v[124:125], v[124:125], v[56:57]
    v_pk_add_f32 v[126:127], v[126:127], v[112:113]
    v_pk_add_f32 v[124:125], v[124:125], v[58:59]
    v_pk_add_f32 v[126:127], v[126:127], v[114:115]
    v_pk_add_f32 v[124:125], v[124:125], v[60:61]
    v_pk_add_f32 v[126:127], v[126:127], v[116:117]
    v_pk_add_f32 v[124:125], v[124:125], v[62:63]
    v_pk_add_f32 v[126:127], v[126:127], v[118:119]
    v_pk_add_f32 v[124:125], v[124:125], v[64:65]
    v_pk_add_f32 v[126:127], v[126:127], v[120:121]
    v_pk_add_f32 v[124:125], v[124:125], v[66:67]
    v_pk_add_f32 v[126:127], v[126:127], v[122:123]
    v_add_f32 v124, v124, v125
    v_add_f32 v125, v126, v127
    v_rcp_f32 v124, v124
    v_rcp_f32 v125, v125
    s_nop 0
    v_pk_mul_f32 v[124:125], v[124:125], v[16:17] op_sel:[0,1] op_sel_hi:[1,1]
    v_pk_mul_f32 v[48:49], v[48:49], v[124:125] op_sel_hi:[1,0]
    v_pk_mul_f32 v[104:105], v[104:105], v[124:125] op_sel:[0,1] op_sel_hi:[1,1]
    v_pk_mul_f32 v[50:51], v[50:51], v[124:125] op_sel_hi:[1,0]
    v_pk_mul_f32 v[106:107], v[106:107], v[124:125] op_sel:[0,1] op_sel_hi:[1,1]
    v_pk_mul_f32 v[52:53], v[52:53], v[124:125] op_sel_hi:[1,0]
    v_pk_mul_f32 v[108:109], v[108:109], v[124:125] op_sel:[0,1] op_sel_hi:[1,1]
    v_pk_mul_f32 v[54:55], v[54:55], v[124:125] op_sel_hi:[1,0]
    v_pk_mul_f32 v[110:111], v[110:111], v[124:125] op_sel:[0,1] op_sel_hi:[1,1]
    v_pk_mul_f32 v[56:57], v[56:57], v[124:125] op_sel_hi:[1,0]
    v_pk_mul_f32 v[112:113], v[112:113], v[124:125] op_sel:[0,1] op_sel_hi:[1,1]
    v_pk_mul_f32 v[58:59], v[58:59], v[124:125] op_sel_hi:[1,0]
    v_pk_mul_f32 v[114:115], v[114:115], v[124:125] op_sel:[0,1] op_sel_hi:[1,1]
    v_pk_mul_f32 v[60:61], v[60:61], v[124:125] op_sel_hi:[1,0]
    v_pk_mul_f32 v[116:117], v[116:117], v[124:125] op_sel:[0,1] op_sel_hi:[1,1]
    v_pk_mul_f32 v[62:63], v[62:63], v[124:125] op_sel_hi:[1,0]
    v_pk_mul_f32 v[118:119], v[118:119], v[124:125] op_sel:[0,1] op_sel_hi:[1,1]
    v_pk_mul_f32 v[64:65], v[64:65], v[124:125] op_sel_hi:[1,0]
    v_pk_mul_f32 v[120:121], v[120:121], v[124:125] op_sel:[0,1] op_sel_hi:[1,1]
    v_pk_mul_f32 v[66:67], v[66:67], v[124:125] op_sel_hi:[1,0]
    v_pk_mul_f32 v[122:123], v[122:123], v[124:125] op_sel:[0,1] op_sel_hi:[1,1]
    v_cvt_pk_bf16_f32 v20, v48, v49
    v_cvt_pk_bf16_f32 v154, v104, v105
    v_cvt_pk_bf16_f32 v21, v50, v51
    v_cvt_pk_bf16_f32 v155, v106, v107
    v_cvt_pk_bf16_f32 v22, v52, v53
    v_cvt_pk_bf16_f32 v156, v108, v109
    v_cvt_pk_bf16_f32 v23, v54, v55
    v_cvt_pk_bf16_f32 v157, v110, v111
    v_cvt_pk_bf16_f32 v24, v56, v57
    v_cvt_pk_bf16_f32 v158, v112, v113
    v_cvt_pk_bf16_f32 v25, v58, v59
    v_cvt_pk_bf16_f32 v159, v114, v115
    v_cvt_pk_bf16_f32 v26, v60, v61
    v_cvt_pk_bf16_f32 v160, v116, v117
    v_cvt_pk_bf16_f32 v27, v62, v63
    v_cvt_pk_bf16_f32 v161, v118, v119
    v_cvt_pk_bf16_f32 v28, v64, v65
    v_cvt_pk_bf16_f32 v162, v120, v121
    v_cvt_pk_bf16_f32 v29, v66, v67
    v_cvt_pk_bf16_f32 v163, v122, v123
    ds_write_b128 v6, v[20:23]
    ds_write_b128 v6, v[24:27] offset:16
    ds_write_b64 v6, v[28:29] offset:32
    ds_write_b64 v6, v[154:155] offset:40
    ds_write_b128 v6, v[156:159] offset:48
    ds_write_b128 v6, v[160:163] offset:64
    s_cmp_ge_u32 s40, 3
    s_cselect_b32 s52, 1, 0
    s_mul_i32 s53, s52, 3
    s_sub_u32 s53, s40, s53
    v_bfe_u32 v10, v1, 2, 2
    v_lshl_add_u32 v10, v9, 3, v10
    v_and_b32 v11, 3, v1
    v_lshlrev_b32 v11, 3, v11
    s_movk_i32 s50, 176
    v_mad_u32_u24 v10, v10, s50, v11
    s_mul_i32 s50, s52, 80
    s_lshl_b32 s51, s53, 5
    s_add_u32 s50, s50, s51
    s_add_u32 s50, s50, 90112
    v_add_u32 v11, s50, v10
    s_mul_i32 s50, s52, 45056
    s_add_u32 s50, s50, 96
    v_add_u32 v10, s50, v10
    s_waitcnt lgkmcnt(0)
    s_barrier
    s_cmp_ge_u32 s40, 6
    s_cbranch_scc1 K1_kv_23
    ds_read_b64_tr_b16 v[48:49], v11 offset:0
    ds_read_b64_tr_b16 v[50:51], v11 offset:704
    ds_read_b64_tr_b16 v[52:53], v10 offset:0
    ds_read_b64_tr_b16 v[54:55], v10 offset:704
    ds_read_b64_tr_b16 v[56:57], v10 offset:32
    ds_read_b64_tr_b16 v[58:59], v10 offset:736
    ds_read_b64_tr_b16 v[60:61], v11 offset:5632
    ds_read_b64_tr_b16 v[62:63], v11 offset:6336
    ds_read_b64_tr_b16 v[64:65], v10 offset:5632
    ds_read_b64_tr_b16 v[66:67], v10 offset:6336
    ds_read_b64_tr_b16 v[68:69], v10 offset:5664
    ds_read_b64_tr_b16 v[70:71], v10 offset:6368
    s_mov_b32 s54, 0x003f003f
    s_waitcnt lgkmcnt(6)
    v_mfma_f32_16x16x32_bf16 v[72:75], v[48:51], v[52:55], 0
    v_mfma_f32_16x16x32_bf16 v[76:79], v[48:51], v[56:59], 0
    ds_read_b64_tr_b16 v[104:105], v11 offset:11264
    ds_read_b64_tr_b16 v[106:107], v11 offset:11968
    ds_read_b64_tr_b16 v[108:109], v10 offset:11264
    ds_read_b64_tr_b16 v[110:111], v10 offset:11968
    ds_read_b64_tr_b16 v[112:113], v10 offset:11296
    ds_read_b64_tr_b16 v[114:115], v10 offset:12000
    s_waitcnt lgkmcnt(6)
    v_mfma_f32_16x16x32_bf16 v[72:75], v[60:63], v[64:67], v[72:75]
    v_mfma_f32_16x16x32_bf16 v[76:79], v[60:63], v[68:71], v[76:79]
    ds_read_b64_tr_b16 v[48:49], v11 offset:16896
    ds_read_b64_tr_b16 v[50:51], v11 offset:17600
    ds_read_b64_tr_b16 v[52:53], v10 offset:16896
    ds_read_b64_tr_b16 v[54:55], v10 offset:17600
    ds_read_b64_tr_b16 v[56:57], v10 offset:16928
    ds_read_b64_tr_b16 v[58:59], v10 offset:17632
    s_waitcnt lgkmcnt(6)
    v_mfma_f32_16x16x32_bf16 v[72:75], v[104:107], v[108:111], v[72:75]
    v_mfma_f32_16x16x32_bf16 v[76:79], v[104:107], v[112:115], v[76:79]
    ds_read_b64_tr_b16 v[60:61], v11 offset:22528
    ds_read_b64_tr_b16 v[62:63], v11 offset:23232
    ds_read_b64_tr_b16 v[64:65], v10 offset:22528
    ds_read_b64_tr_b16 v[66:67], v10 offset:23232
    ds_read_b64_tr_b16 v[68:69], v10 offset:22560
    ds_read_b64_tr_b16 v[70:71], v10 offset:23264
    s_waitcnt lgkmcnt(6)
    v_mfma_f32_16x16x32_bf16 v[72:75], v[48:51], v[52:55], v[72:75]
    v_mfma_f32_16x16x32_bf16 v[76:79], v[48:51], v[56:59], v[76:79]
    ds_read_b64_tr_b16 v[104:105], v11 offset:28160
    ds_read_b64_tr_b16 v[106:107], v11 offset:28864
    ds_read_b64_tr_b16 v[108:109], v10 offset:28160
    ds_read_b64_tr_b16 v[110:111], v10 offset:28864
    ds_read_b64_tr_b16 v[112:113], v10 offset:28192
    ds_read_b64_tr_b16 v[114:115], v10 offset:28896
    s_waitcnt lgkmcnt(6)
    v_mfma_f32_16x16x32_bf16 v[72:75], v[60:63], v[64:67], v[72:75]
    v_mfma_f32_16x16x32_bf16 v[76:79], v[60:63], v[68:71], v[76:79]
    ds_read_b64_tr_b16 v[48:49], v11 offset:33792
    ds_read_b64_tr_b16 v[50:51], v11 offset:34496
    ds_read_b64_tr_b16 v[52:53], v10 offset:33792
    ds_read_b64_tr_b16 v[54:55], v10 offset:34496
    ds_read_b64_tr_b16 v[56:57], v10 offset:33824
    ds_read_b64_tr_b16 v[58:59], v10 offset:34528
    s_waitcnt lgkmcnt(6)
    v_mfma_f32_16x16x32_bf16 v[72:75], v[104:107], v[108:111], v[72:75]
    v_mfma_f32_16x16x32_bf16 v[76:79], v[104:107], v[112:115], v[76:79]
    ds_read_b64_tr_b16 v[60:61], v11 offset:39424
    ds_read_b64_tr_b16 v[62:63], v11 offset:40128
    ds_read_b64_tr_b16 v[64:65], v10 offset:39424
    ds_read_b64_tr_b16 v[66:67], v10 offset:40128
    ds_read_b64_tr_b16 v[68:69], v10 offset:39456
    ds_read_b64_tr_b16 v[70:71], v10 offset:40160
    s_waitcnt lgkmcnt(6)
    v_mfma_f32_16x16x32_bf16 v[72:75], v[48:51], v[52:55], v[72:75]
    v_mfma_f32_16x16x32_bf16 v[76:79], v[48:51], v[56:59], v[76:79]
    s_waitcnt lgkmcnt(0)
    v_mfma_f32_16x16x32_bf16 v[72:75], v[60:63], v[64:67], v[72:75]
    v_mfma_f32_16x16x32_bf16 v[76:79], v[60:63], v[68:71], v[76:79]
    v_lshlrev_b32 v10, 4, v1
    s_mul_i32 s50, s52, 3584
    s_add_u32 s50, s50, s58
    s_lshl_b32 s51, s53, 10
    s_add_u32 s51, s51, s50
    s_mul_i32 s52, s53, 384
    s_add_u32 s50, s50, s52
    s_cmp_eq_u32 s53, 2
    s_cselect_b32 s52, 8, 6
    v_mul_u32_u24 v11, s52, v9
    v_add_lshl_u32 v11, v11, v8, 4
    s_cselect_b32 exec_hi, 0, -1
    s_cselect_b32 s52, 0x00ff00ff, s54
    buffer_store_dwordx4 v[72:75], v10, s[32:35], s51 offen sc1
    s_and_b32 exec_lo, exec_lo, s52
    s_and_b32 exec_hi, exec_hi, s52
    buffer_store_dwordx4 v[76:79], v11, s[32:35], s50 offen offset:2560 sc1
    s_mov_b64 exec, -1
K1_kv_23:
    v_pk_fma_f32 v[136:137], v[40:41], v[12:13], v[136:137] op_sel_hi:[1,0,1] neg_lo:[1,0,0] neg_hi:[1,0,0]
    v_pk_fma_f32 v[138:139], v[42:43], v[12:13], v[138:139] op_sel_hi:[1,0,1] neg_lo:[1,0,0] neg_hi:[1,0,0]
    v_pk_fma_f32 v[140:141], v[40:41], v[12:13], v[140:141] op_sel:[0,1,0] op_sel_hi:[1,1,1] neg_lo:[1,0,0] neg_hi:[1,0,0]
    v_pk_fma_f32 v[142:143], v[42:43], v[12:13], v[142:143] op_sel:[0,1,0] op_sel_hi:[1,1,1] neg_lo:[1,0,0] neg_hi:[1,0,0]
    v_pk_fma_f32 v[144:145], v[40:41], v[14:15], v[144:145] op_sel_hi:[1,0,1] neg_lo:[1,0,0] neg_hi:[1,0,0]
    v_pk_fma_f32 v[146:147], v[42:43], v[14:15], v[146:147] op_sel_hi:[1,0,1] neg_lo:[1,0,0] neg_hi:[1,0,0]
    v_pk_fma_f32 v[148:149], v[40:41], v[14:15], v[148:149] op_sel:[0,1,0] op_sel_hi:[1,1,1] neg_lo:[1,0,0] neg_hi:[1,0,0]
    v_pk_fma_f32 v[150:151], v[42:43], v[14:15], v[150:151] op_sel:[0,1,0] op_sel_hi:[1,1,1] neg_lo:[1,0,0] neg_hi:[1,0,0]
    v_cvt_pk_bf16_f32 v136, v136, v137
    v_cvt_pk_bf16_f32 v137, v138, v139
    ds_write_b64 v3, v[136:137] offset:48
    v_cvt_pk_bf16_f32 v140, v140, v141
    v_cvt_pk_bf16_f32 v141, v142, v143
    ds_write_b64 v3, v[140:141] offset:2864
    v_cvt_pk_bf16_f32 v144, v144, v145
    v_cvt_pk_bf16_f32 v145, v146, v147
    ds_write_b64 v3, v[144:145] offset:5680
    v_cvt_pk_bf16_f32 v148, v148, v149
    v_cvt_pk_bf16_f32 v149, v150, v151
    ds_write_b64 v3, v[148:149] offset:8496
    ds_read_b128 v[20:23], v5 offset:48
    ds_read_b128 v[24:27], v5 offset:64
    ds_read_b64 v[28:29], v5 offset:80
    s_waitcnt lgkmcnt(0)
    v_mfma_f32_32x32x16_bf16 v[48:63], v[80:83], v[20:23], 0
    v_mfma_f32_32x32x16_bf16 v[64:79], v[92:95], v[20:23], 0
    v_mfma_f32_32x32x16_bf16 v[48:63], v[84:87], v[24:27], v[48:63]
    v_mfma_f32_32x32x16_bf16 v[64:79], v[96:99], v[24:27], v[64:79]
    v_mfma_f32_32x32x16_bf16 v[48:63], v[88:91], v[28:31], v[48:63]
    v_mfma_f32_32x32x16_bf16 v[64:79], v[100:103], v[28:31], v[64:79]
    v_lshlrev_b32 v7, 4, v0
    s_mul_i32 s53, s46, 57344
    s_add_u32 s53, s53, 9764864
    s_nop 7
    s_nop 3
    v_max3_f32 v124, v48, v49, v50
    v_min3_f32 v125, v48, v49, v50
    v_max3_f32 v124, v124, v51, v52
    v_min3_f32 v125, v125, v51, v52
    v_max3_f32 v124, v124, v53, v54
    v_min3_f32 v125, v125, v53, v54
    v_max3_f32 v124, v124, v55, v56
    v_min3_f32 v125, v125, v55, v56
    v_max3_f32 v124, v124, v57, v58
    v_min3_f32 v125, v125, v57, v58
    v_max3_f32 v124, v124, v59, v60
    v_min3_f32 v125, v125, v59, v60
    v_max3_f32 v124, v124, v61, v62
    v_min3_f32 v125, v125, v61, v62
    v_max3_f32 v124, v124, v63, v64
    v_min3_f32 v125, v125, v63, v64
    v_max3_f32 v124, v124, v65, v66
    v_min3_f32 v125, v125, v65, v66
    v_max_f32 v124, v124, v67
    v_min_f32 v125, v125, v67
    v_pk_mul_f32 v[124:125], v[124:125], v[16:17] op_sel_hi:[1,0]
    v_pk_fma_f32 v[104:105], v[48:49], v[16:17], v[124:125] op_sel:[0,0,1] op_sel_hi:[1,0,1] neg_lo:[1,0,0] neg_hi:[1,0,0]
    v_pk_fma_f32 v[48:49], v[48:49], v[16:17], v[124:125] op_sel_hi:[1,0,0] neg_lo:[0,0,1] neg_hi:[0,0,1]
    v_pk_fma_f32 v[106:107], v[50:51], v[16:17], v[124:125] op_sel:[0,0,1] op_sel_hi:[1,0,1] neg_lo:[1,0,0] neg_hi:[1,0,0]
    v_pk_fma_f32 v[50:51], v[50:51], v[16:17], v[124:125] op_sel_hi:[1,0,0] neg_lo:[0,0,1] neg_hi:[0,0,1]
    v_pk_fma_f32 v[108:109], v[52:53], v[16:17], v[124:125] op_sel:[0,0,1] op_sel_hi:[1,0,1] neg_lo:[1,0,0] neg_hi:[1,0,0]
    v_pk_fma_f32 v[52:53], v[52:53], v[16:17], v[124:125] op_sel_hi:[1,0,0] neg_lo:[0,0,1] neg_hi:[0,0,1]
    v_pk_fma_f32 v[110:111], v[54:55], v[16:17], v[124:125] op_sel:[0,0,1] op_sel_hi:[1,0,1] neg_lo:[1,0,0] neg_hi:[1,0,0]
    v_pk_fma_f32 v[54:55], v[54:55], v[16:17], v[124:125] op_sel_hi:[1,0,0] neg_lo:[0,0,1] neg_hi:[0,0,1]
    v_pk_fma_f32 v[112:113], v[56:57], v[16:17], v[124:125] op_sel:[0,0,1] op_sel_hi:[1,0,1] neg_lo:[1,0,0] neg_hi:[1,0,0]
    v_pk_fma_f32 v[56:57], v[56:57], v[16:17], v[124:125] op_sel_hi:[1,0,0] neg_lo:[0,0,1] neg_hi:[0,0,1]
    v_pk_fma_f32 v[114:115], v[58:59], v[16:17], v[124:125] op_sel:[0,0,1] op_sel_hi:[1,0,1] neg_lo:[1,0,0] neg_hi:[1,0,0]
    v_pk_fma_f32 v[58:59], v[58:59], v[16:17], v[124:125] op_sel_hi:[1,0,0] neg_lo:[0,0,1] neg_hi:[0,0,1]
    v_pk_fma_f32 v[116:117], v[60:61], v[16:17], v[124:125] op_sel:[0,0,1] op_sel_hi:[1,0,1] neg_lo:[1,0,0] neg_hi:[1,0,0]
    v_pk_fma_f32 v[60:61], v[60:61], v[16:17], v[124:125] op_sel_hi:[1,0,0] neg_lo:[0,0,1] neg_hi:[0,0,1]
    v_pk_fma_f32 v[118:119], v[62:63], v[16:17], v[124:125] op_sel:[0,0,1] op_sel_hi:[1,0,1] neg_lo:[1,0,0] neg_hi:[1,0,0]
    v_pk_fma_f32 v[62:63], v[62:63], v[16:17], v[124:125] op_sel_hi:[1,0,0] neg_lo:[0,0,1] neg_hi:[0,0,1]
    v_pk_fma_f32 v[120:121], v[64:65], v[16:17], v[124:125] op_sel:[0,0,1] op_sel_hi:[1,0,1] neg_lo:[1,0,0] neg_hi:[1,0,0]
    v_pk_fma_f32 v[64:65], v[64:65], v[16:17], v[124:125] op_sel_hi:[1,0,0] neg_lo:[0,0,1] neg_hi:[0,0,1]
    v_pk_fma_f32 v[122:123], v[66:67], v[16:17], v[124:125] op_sel:[0,0,1] op_sel_hi:[1,0,1] neg_lo:[1,0,0] neg_hi:[1,0,0]
    v_pk_fma_f32 v[66:67], v[66:67], v[16:17], v[124:125] op_sel_hi:[1,0,0] neg_lo:[0,0,1] neg_hi:[0,0,1]
    v_exp_f32 v48, v48
    v_exp_f32 v104, v104
    v_exp_f32 v49, v49
    v_exp_f32 v105, v105
    v_exp_f32 v50, v50
    v_exp_f32 v106, v106
    v_exp_f32 v51, v51
    v_exp_f32 v107, v107
    v_exp_f32 v52, v52
    v_exp_f32 v108, v108
    v_exp_f32 v53, v53
    v_exp_f32 v109, v109
    v_exp_f32 v54, v54
    v_exp_f32 v110, v110
    v_exp_f32 v55, v55
    v_exp_f32 v111, v111
    v_exp_f32 v56, v56
    v_exp_f32 v112, v112
    v_exp_f32 v57, v57
    v_exp_f32 v113, v113
    v_exp_f32 v58, v58
    v_exp_f32 v114, v114
    v_exp_f32 v59, v59
    v_exp_f32 v115, v115
    v_exp_f32 v60, v60
    v_exp_f32 v116, v116
    v_exp_f32 v61, v61
    v_exp_f32 v117, v117
    v_exp_f32 v62, v62
    v_exp_f32 v118, v118
    v_exp_f32 v63, v63
    v_exp_f32 v119, v119
    v_exp_f32 v64, v64
    v_exp_f32 v120, v120
    v_exp_f32 v65, v65
    v_exp_f32 v121, v121
    v_exp_f32 v66, v66
    v_exp_f32 v122, v122
    v_exp_f32 v67, v67
    v_exp_f32 v123, v123
    v_pk_add_f32 v[124:125], v[48:49], v[50:51]
    v_pk_add_f32 v[126:127], v[104:105], v[106:107]
    v_pk_add_f32 v[124:125], v[124:125], v[52:53]
    v_pk_add_f32 v[126:127], v[126:127], v[108:109]
    v_pk_add_f32 v[124:125], v[124:125], v[54:55]
    v_pk_add_f32 v[126:127], v[126:127], v[110:111]
    v_pk_add_f32 v[124:125], v[124:125], v[56:57]
    v_pk_add_f32 v[126:127], v[126:127], v[112:113]
    v_pk_add_f32 v[124:125], v[124:125], v[58:59]
    v_pk_add_f32 v[126:127], v[126:127], v[114:115]
    v_pk_add_f32 v[124:125], v[124:125], v[60:61]
    v_pk_add_f32 v[126:127], v[126:127], v[116:117]
    v_pk_add_f32 v[124:125], v[124:125], v[62:63]
    v_pk_add_f32 v[126:127], v[126:127], v[118:119]
    v_pk_add_f32 v[124:125], v[124:125], v[64:65]
    v_pk_add_f32 v[126:127], v[126:127], v[120:121]
    v_pk_add_f32 v[124:125], v[124:125], v[66:67]
    v_pk_add_f32 v[126:127], v[126:127], v[122:123]
    v_add_f32 v124, v124, v125
    v_add_f32 v125, v126, v127
    v_rcp_f32 v124, v124
    v_rcp_f32 v125, v125
    s_nop 0
    v_pk_mul_f32 v[48:49], v[48:49], v[124:125] op_sel_hi:[1,0]
    v_pk_mul_f32 v[104:105], v[104:105], v[124:125] op_sel:[0,1] op_sel_hi:[1,1]
    v_pk_mul_f32 v[50:51], v[50:51], v[124:125] op_sel_hi:[1,0]
    v_pk_mul_f32 v[106:107], v[106:107], v[124:125] op_sel:[0,1] op_sel_hi:[1,1]
    v_pk_mul_f32 v[52:53], v[52:53], v[124:125] op_sel_hi:[1,0]
    v_pk_mul_f32 v[108:109], v[108:109], v[124:125] op_sel:[0,1] op_sel_hi:[1,1]
    v_pk_mul_f32 v[54:55], v[54:55], v[124:125] op_sel_hi:[1,0]
    v_pk_mul_f32 v[110:111], v[110:111], v[124:125] op_sel:[0,1] op_sel_hi:[1,1]
    v_pk_mul_f32 v[56:57], v[56:57], v[124:125] op_sel_hi:[1,0]
    v_pk_mul_f32 v[112:113], v[112:113], v[124:125] op_sel:[0,1] op_sel_hi:[1,1]
    v_pk_mul_f32 v[58:59], v[58:59], v[124:125] op_sel_hi:[1,0]
    v_pk_mul_f32 v[114:115], v[114:115], v[124:125] op_sel:[0,1] op_sel_hi:[1,1]
    v_pk_mul_f32 v[60:61], v[60:61], v[124:125] op_sel_hi:[1,0]
    v_pk_mul_f32 v[116:117], v[116:117], v[124:125] op_sel:[0,1] op_sel_hi:[1,1]
    v_pk_mul_f32 v[62:63], v[62:63], v[124:125] op_sel_hi:[1,0]
    v_pk_mul_f32 v[118:119], v[118:119], v[124:125] op_sel:[0,1] op_sel_hi:[1,1]
    v_pk_mul_f32 v[64:65], v[64:65], v[124:125] op_sel_hi:[1,0]
    v_pk_mul_f32 v[120:121], v[120:121], v[124:125] op_sel:[0,1] op_sel_hi:[1,1]
    v_pk_mul_f32 v[66:67], v[66:67], v[124:125] op_sel_hi:[1,0]
    v_pk_mul_f32 v[122:123], v[122:123], v[124:125] op_sel:[0,1] op_sel_hi:[1,1]
    v_cvt_pk_bf16_f32 v128, v48, v49
    v_cvt_pk_bf16_f32 v138, v104, v105
    v_cvt_pk_bf16_f32 v129, v50, v51
    v_cvt_pk_bf16_f32 v139, v106, v107
    v_cvt_pk_bf16_f32 v130, v52, v53
    v_cvt_pk_bf16_f32 v140, v108, v109
    v_cvt_pk_bf16_f32 v131, v54, v55
    v_cvt_pk_bf16_f32 v141, v110, v111
    v_cvt_pk_bf16_f32 v132, v56, v57
    v_cvt_pk_bf16_f32 v142, v112, v113
    v_cvt_pk_bf16_f32 v133, v58, v59
    v_cvt_pk_bf16_f32 v143, v114, v115
    v_cvt_pk_bf16_f32 v134, v60, v61
    v_cvt_pk_bf16_f32 v144, v116, v117
    v_cvt_pk_bf16_f32 v135, v62, v63
    v_cvt_pk_bf16_f32 v145, v118, v119
    v_cvt_pk_bf16_f32 v136, v64, v65
    v_cvt_pk_bf16_f32 v146, v120, v121
    v_cvt_pk_bf16_f32 v137, v66, v67
    v_cvt_pk_bf16_f32 v147, v122, v123
    s_and_saveexec_b64 s[54:55], s[56:57]
    s_cbranch_execz K1_g0_24
    s_mov_b32 s52, s53
    buffer_load_dwordx4 v[32:35], v7, s[32:35], s52 offen sc1
    s_add_u32 s52, s52, 7168
    buffer_load_dwordx4 v[36:39], v7, s[32:35], s52 offen sc1
    s_add_u32 s52, s52, 7168
    buffer_load_dwordx4 v[40:43], v7, s[32:35], s52 offen sc1
    s_add_u32 s52, s52, 7168
    buffer_load_dwordx4 v[44:47], v7, s[32:35], s52 offen sc1
    s_add_u32 s52, s52, 7168
    buffer_load_dwordx4 v[152:155], v7, s[32:35], s52 offen sc1
    s_add_u32 s52, s52, 7168
    buffer_load_dwordx4 v[156:159], v7, s[32:35], s52 offen sc1
    s_add_u32 s52, s52, 7168
    buffer_load_dwordx4 v[160:163], v7, s[32:35], s52 offen sc1
    s_add_u32 s52, s52, 7168
    buffer_load_dwordx4 v[164:167], v7, s[32:35], s52 offen sc1
K1_g0_24:
    s_mov_b64 exec, s[54:55]
    v_mov_b32 v148, 0
    v_mov_b32 v149, 0
    v_mov_b32 v150, 0
    v_mov_b32 v151, 0
    ds_write_b128 v5, v[128:131] offset:0
    ds_write_b128 v5, v[132:135] offset:16
    ds_write_b128 v5, v[136:139] offset:32
    ds_write_b128 v5, v[140:143] offset:48
    ds_write_b128 v5, v[144:147] offset:64
    ds_write_b128 v5, v[148:151] offset:80
    v_and_b32 v12, 31, v1
    v_lshrrev_b32 v19, 5, v1
    s_movk_i32 s50, 176
    v_mul_u32_u24 v13, s50, v12
    v_lshl_add_u32 v13, v19, 4, v13
    s_lshl1_add_u32 s50, s48, s49
    s_mul_i32 s50, s50, 5632
    v_add_u32 v13, s50, v13
    s_waitcnt lgkmcnt(0)
    s_barrier
    ds_read_b128 v[48:51], v13 offset:0
    ds_read_b128 v[52:55], v13 offset:32
    ds_read_b128 v[56:59], v13 offset:64
    ds_read_b128 v[60:63], v13 offset:45056
    ds_read_b128 v[64:67], v13 offset:45088
    ds_read_b128 v[68:71], v13 offset:45120
    s_waitcnt lgkmcnt(0)
    s_barrier
    v_bfe_u32 v10, v1, 4, 1
    s_mov_b32 s50, 69632
    v_mul_u32_u24 v10, s50, v10
    v_lshl_add_u32 v10, v8, 4, v10
    v_lshl_add_u32 v20, v19, 8, v10
    s_lshl_b32 s60, s45, 4
    s_lshl2_add_u32 s60, s48, s60
    s_lshl1_add_u32 s60, s49, s60
    s_mul_i32 s60, s60, 69632
    s_mul_i32 s50, s46, 1280
    s_add_u32 s60, s60, s50
    s_add_u32 s60, s60, 49152
    s_movk_i32 s50, 224
    v_cmp_le_u32 vcc, s50, v0
    v_subrev_u32 v21, s50, v0
    v_mov_b32 v22, 21
    v_cndmask_b32 v21, v0, v21, vcc
    v_cndmask_b32 v22, 0, v22, vcc
    v_lshrrev_b32 v23, 4, v21
    v_and_b32 v24, 15, v21
    v_subrev_u32 v25, 160, v21
    v_mul_u32_u24 v26, 43, v25
    v_lshrrev_b32 v26, 8, v26
    v_mul_u32_u24 v27, 6, v26
    v_sub_u32 v27, v25, v27
    v_add_u32 v27, 16, v27
    s_movk_i32 s50, 160
    v_cmp_le_u32 vcc, s50, v21
    v_bfe_u32 v25, v21, 3, 1
    v_add_u32 v25, 8, v25
    v_cndmask_b32 v23, v23, v26, vcc
    v_cndmask_b32 v24, v24, v27, vcc
    s_movk_i32 s50, 208
    v_cmp_le_u32 vcc, s50, v21
    v_and_b32 v26, 7, v21
    v_add_u32 v26, 16, v26
    v_cndmask_b32 v23, v23, v25, vcc
    v_cndmask_b32 v24, v24, v26, vcc
    v_cmp_lt_u32 vcc, 20, v24
    v_add_u32 v24, v24, v22
    s_movk_i32 s50, 112
    v_cndmask_b32 v24, v24, 42, vcc
    v_mul_u32_u24 v27, s50, v24
    v_lshl_add_u32 v27, v23, 3, v27
    v_add_u32 v27, 151552, v27
    v_min_u32 v28, 20, v12
    s_movk_i32 s50, 112
    v_mul_u32_u24 v28, s50, v28
    v_lshl_add_u32 v28, v19, 4, v28
    v_add_u32 v28, 151552, v28
    s_and_saveexec_b64 s[54:55], s[56:57]
    s_cbranch_execz K1_ga_25
    s_mov_b32 s51, 0
K1_gl_26:
    s_waitcnt vmcnt(0)
    s_mov_b32 s50, 0
    s_mov_b32 s52, s53
    v_max3_u32 v18, v32, v33, v34
    v_max_u32 v18, v18, v35
    v_cmp_eq_u32 vcc, -1, v18
    s_nop 0
    s_cmp_eq_u64 vcc, 0
    s_cbranch_scc1 K1_gp_28
    buffer_load_dwordx4 v[32:35], v7, s[32:35], s52 offen sc1
    s_mov_b32 s50, 1
K1_gp_28:
    v_max3_u32 v18, v36, v37, v38
    v_max_u32 v18, v18, v39
    v_cmp_eq_u32 vcc, -1, v18
    s_add_u32 s52, s52, 7168
    s_cmp_eq_u64 vcc, 0
    s_cbranch_scc1 K1_gp_29
    buffer_load_dwordx4 v[36:39], v7, s[32:35], s52 offen sc1
    s_mov_b32 s50, 1
K1_gp_29:
    v_max3_u32 v18, v40, v41, v42
    v_max_u32 v18, v18, v43
    v_cmp_eq_u32 vcc, -1, v18
    s_add_u32 s52, s52, 7168
    s_cmp_eq_u64 vcc, 0
    s_cbranch_scc1 K1_gp_30
    buffer_load_dwordx4 v[40:43], v7, s[32:35], s52 offen sc1
    s_mov_b32 s50, 1
K1_gp_30:
    v_max3_u32 v18, v44, v45, v46
    v_max_u32 v18, v18, v47
    v_cmp_eq_u32 vcc, -1, v18
    s_add_u32 s52, s52, 7168
    s_cmp_eq_u64 vcc, 0
    s_cbranch_scc1 K1_gp_31
    buffer_load_dwordx4 v[44:47], v7, s[32:35], s52 offen sc1
    s_mov_b32 s50, 1
K1_gp_31:
    v_max3_u32 v18, v152, v153, v154
    v_max_u32 v18, v18, v155
    v_cmp_eq_u32 vcc, -1, v18
    s_add_u32 s52, s52, 7168
    s_cmp_eq_u64 vcc, 0
    s_cbranch_scc1 K1_gp_32
    buffer_load_dwordx4 v[152:155], v7, s[32:35], s52 offen sc1
    s_mov_b32 s50, 1
K1_gp_32:
    v_max3_u32 v18, v156, v157, v158
    v_max_u32 v18, v18, v159
    v_cmp_eq_u32 vcc, -1, v18
    s_add_u32 s52, s52, 7168
    s_cmp_eq_u64 vcc, 0
    s_cbranch_scc1 K1_gp_33
    buffer_load_dwordx4 v[156:159], v7, s[32:35], s52 offen sc1
    s_mov_b32 s50, 1
K1_gp_33:
    v_max3_u32 v18, v160, v161, v162
    v_max_u32 v18, v18, v163
    v_cmp_eq_u32 vcc, -1, v18
    s_add_u32 s52, s52, 7168
    s_cmp_eq_u64 vcc, 0
    s_cbranch_scc1 K1_gp_34
    buffer_load_dwordx4 v[160:163], v7, s[32:35], s52 offen sc1
    s_mov_b32 s50, 1
K1_gp_34:
    v_max3_u32 v18, v164, v165, v166
    v_max_u32 v18, v18, v167
    v_cmp_eq_u32 vcc, -1, v18
    s_add_u32 s52, s52, 7168
    s_cmp_eq_u64 vcc, 0
    s_cbranch_scc1 K1_gp_35
    buffer_load_dwordx4 v[164:167], v7, s[32:35], s52 offen sc1
    s_mov_b32 s50, 1
K1_gp_35:
    s_add_u32 s51, s51, 1
    s_cmp_eq_u32 s50, 0
    s_cbranch_scc1 K1_go_27
    s_sleep 2
    s_cmp_lt_u32 s51, 65536
    s_cbranch_scc1 K1_gl_26
    s_waitcnt vmcnt(0)
K1_go_27:
    v_pk_add_f32 v[32:33], v[32:33], v[36:37]
    v_pk_add_f32 v[34:35], v[34:35], v[38:39]
    v_pk_add_f32 v[32:33], v[32:33], v[40:41]
    v_pk_add_f32 v[34:35], v[34:35], v[42:43]
    v_pk_add_f32 v[32:33], v[32:33], v[44:45]
    v_pk_add_f32 v[34:35], v[34:35], v[46:47]
    v_pk_add_f32 v[32:33], v[32:33], v[152:153]
    v_pk_add_f32 v[34:35], v[34:35], v[154:155]
    v_pk_add_f32 v[32:33], v[32:33], v[156:157]
    v_pk_add_f32 v[34:35], v[34:35], v[158:159]
    v_pk_add_f32 v[32:33], v[32:33], v[160:161]
    v_pk_add_f32 v[34:35], v[34:35], v[162:163]
    v_pk_add_f32 v[32:33], v[32:33], v[164:165]
    v_pk_add_f32 v[34:35], v[34:35], v[166:167]
    v_cvt_pk_bf16_f32 v32, v32, v33
    v_cvt_pk_bf16_f32 v33, v34, v35
    ds_write_b64 v27, v[32:33]
K1_ga_25:
    s_mov_b64 exec, s[54:55]
    s_waitcnt lgkmcnt(0)
    v_mov_b32 v16, 163832
    v_mov_b32 v17, 1
    s_mov_b64 exec, 1
    ds_add_rtn_u32 v18, v16, v17
    s_mov_b32 s51, 0
    s_waitcnt lgkmcnt(0)
    v_add_u32 v18, 1, v18
K1_sb_36:
    s_waitcnt lgkmcnt(0)
    v_readfirstlane_b32 s50, v18
    s_add_u32 s51, s51, 1
    s_cmp_ge_u32 s50, 8
    s_cbranch_scc1 K1_sk_37
    s_cmp_ge_u32 s51, 0x1000000
    s_cbranch_scc1 K1_sk_37
    s_sleep 1
    ds_read_b32 v18, v16
    s_branch K1_sb_36
K1_sk_37:
    s_mov_b64 exec, -1
    ds_read_b128 v[80:83], v28 offset:0
    ds_read_b128 v[92:95], v28 offset:2352
    ds_read_b128 v[84:87], v28 offset:32
    ds_read_b128 v[96:99], v28 offset:2384
    ds_read_b128 v[88:91], v28 offset:64
    ds_read_b128 v[100:103], v28 offset:2416
    s_waitcnt lgkmcnt(4)
    v_mfma_f32_32x32x16_bf16 v[104:119], v[80:83], v[48:51], 0
    v_mfma_f32_32x32x16_bf16 v[120:135], v[92:95], v[60:63], 0
    s_waitcnt lgkmcnt(2)
    v_mfma_f32_32x32x16_bf16 v[104:119], v[84:87], v[52:55], v[104:119]
    v_mfma_f32_32x32x16_bf16 v[120:135], v[96:99], v[64:67], v[120:135]
    s_waitcnt lgkmcnt(0)
    v_mfma_f32_32x32x16_bf16 v[104:119], v[88:91], v[56:59], v[104:119]
    v_mfma_f32_32x32x16_bf16 v[120:135], v[100:103], v[68:71], v[120:135]
    s_nop 7
    s_nop 3
    v_add_f32 v116, 0x358637bd, v116
    v_rcp_f32 v116, v116
    s_nop 0
    v_pk_mul_f32 v[104:105], v[104:105], v[116:117] op_sel_hi:[1,0]
    v_pk_mul_f32 v[106:107], v[106:107], v[116:117] op_sel_hi:[1,0]
    v_pk_mul_f32 v[108:109], v[108:109], v[116:117] op_sel_hi:[1,0]
    v_pk_mul_f32 v[110:111], v[110:111], v[116:117] op_sel_hi:[1,0]
    v_pk_mul_f32 v[112:113], v[112:113], v[116:117] op_sel_hi:[1,0]
    v_pk_mul_f32 v[114:115], v[114:115], v[116:117] op_sel_hi:[1,0]
    v_cvt_pk_bf16_f32 v104, v104, v105
    v_cvt_pk_bf16_f32 v105, v106, v107
    v_cvt_pk_bf16_f32 v106, v108, v109
    v_cvt_pk_bf16_f32 v107, v110, v111
    v_cvt_pk_bf16_f32 v32, v112, v113
    v_cvt_pk_bf16_f32 v33, v114, v115
    v_permlane32_swap_b32 v104, v106
    v_permlane32_swap_b32 v105, v107
    buffer_store_dwordx4 v[104:107], v20, s[32:35], s60 offen offset:0 sc1
    v_add_f32 v132, 0x358637bd, v132
    v_rcp_f32 v132, v132
    s_nop 0
    v_pk_mul_f32 v[120:121], v[120:121], v[132:133] op_sel_hi:[1,0]
    v_pk_mul_f32 v[122:123], v[122:123], v[132:133] op_sel_hi:[1,0]
    v_pk_mul_f32 v[124:125], v[124:125], v[132:133] op_sel_hi:[1,0]
    v_pk_mul_f32 v[126:127], v[126:127], v[132:133] op_sel_hi:[1,0]
    v_pk_mul_f32 v[128:129], v[128:129], v[132:133] op_sel_hi:[1,0]
    v_pk_mul_f32 v[130:131], v[130:131], v[132:133] op_sel_hi:[1,0]
    v_cvt_pk_bf16_f32 v120, v120, v121
    v_cvt_pk_bf16_f32 v121, v122, v123
    v_cvt_pk_bf16_f32 v122, v124, v125
    v_cvt_pk_bf16_f32 v123, v126, v127
    v_cvt_pk_bf16_f32 v34, v128, v129
    v_cvt_pk_bf16_f32 v35, v130, v131
    v_permlane32_swap_b32 v120, v122
    v_permlane32_swap_b32 v121, v123
    buffer_store_dwordx4 v[120:123], v20, s[32:35], s60 offen offset:768 sc1
    s_mov_b32 exec_hi, 0
    buffer_store_dwordx4 v[32:35], v20, s[32:35], s60 offen offset:512 sc1
    s_mov_b64 exec, -1
    v_mov_b32 v2, 163800
    v_mov_b32 v3, 1
    s_mov_b64 exec, 1
    ds_add_u32 v2, v3
    s_mov_b64 exec, -1
    v_mov_b32 v2, 163836
    v_mov_b32 v3, 1
    v_mov_b32 v4, 0
    s_mov_b64 exec, 1
    s_waitcnt vmcnt(0)
    ds_add_rtn_u32 v5, v2, v3
    s_waitcnt lgkmcnt(0)
    v_readfirstlane_b32 s50, v5
    s_cmp_lg_u32 s50, 7
    s_cbranch_scc1 K1_dn_38
    buffer_store_dword v3, v4, s[32:35], s63 offen sc1
K1_dn_38:
    s_mov_b64 exec, -1
    s_branch P2_exit
P2_ld:
    s_lshl2_add_u32 s42, s42, s43
    s_add_u32 s43, s42, 1
    s_sub_u32 s50, s44, 2
    s_mul_i32 s51, s50, 26
    s_lshr_b32 s51, s51, 8
    s_mul_i32 s46, s51, 10
    s_sub_u32 s46, s50, s46
    s_mul_i32 s45, s51, 6
    s_sub_u32 s45, s45, 6
    s_cmp_eq_u32 s51, 0
    s_cselect_b32 s45, 12, s45
    s_lshl4_add_u32 s45, s42, s45
    s_cmp_lt_u32 s44, 2
    s_cselect_b32 s41, 1, 0
    v_lshlrev_b32 v13, 4, v1
    v_lshrrev_b32 v7, 3, v1
    v_and_b32 v8, 2, v7
    v_lshlrev_b32 v8, 1, v8
    v_and_b32 v9, 7, v1
    v_xor_b32 v8, v8, v9
    v_lshlrev_b32 v8, 4, v8
    s_movk_i32 s50, 1280
    v_mad_u32_u24 v8, v7, s50, v8
    s_mul_i32 s50, s48, 20480
    s_lshl_b32 s51, s46, 7
    s_add_u32 s50, s50, s51
    v_add_u32 v5, s50, v8
    v_add_u32 v6, 9216, v5
    s_lshl_b32 s61, s48, 11
    s_lshl_b32 s56, s46, 1
    s_mov_b32 s57, s56
    s_mul_i32 s58, s46, 359
    s_lshr_b32 s58, s58, 8
    s_add_u32 s58, s58, 20
    s_mov_b32 s28, s16
    s_mov_b32 s29, s17
    s_mov_b32 s30, 1966080
    s_mov_b32 s59, 819200
    s_cmp_eq_u32 s41, 1
    s_cbranch_scc1 P2_exit
    s_mul_i32 s53, s57, 81920
    s_add_u32 m0, s61, 114688
    s_nop 0
    buffer_load_dwordx4 v5, s[28:31], s53 offen lds
    buffer_load_dwordx4 v6, s[28:31], s53 offen offset:1024 lds
    s_add_u32 s57, s57, 1
    s_cmp_eq_u32 s57, 20
    s_cselect_b32 s57, 0, s57
    s_mul_i32 s53, s57, 81920
    s_add_u32 m0, s61, 122880
    s_nop 0
    buffer_load_dwordx4 v5, s[28:31], s53 offen lds
    buffer_load_dwordx4 v6, s[28:31], s53 offen offset:1024 lds
    s_add_u32 s57, s57, 1
    s_cmp_eq_u32 s57, 20
    s_cselect_b32 s57, 0, s57
    s_mul_i32 s53, s57, 81920
    s_add_u32 m0, s61, 0
    s_nop 0
    buffer_load_dwordx4 v5, s[28:31], s53 offen lds
    buffer_load_dwordx4 v6, s[28:31], s53 offen offset:1024 lds
    s_add_u32 s57, s57, 1
    s_cmp_eq_u32 s57, 20
    s_cselect_b32 s57, 0, s57
    s_mul_i32 s53, s57, 81920
    s_add_u32 m0, s61, 8192
    s_nop 0
    buffer_load_dwordx4 v5, s[28:31], s53 offen lds
    buffer_load_dwordx4 v6, s[28:31], s53 offen offset:1024 lds
    s_add_u32 s57, s57, 1
    s_cmp_eq_u32 s57, 20
    s_cselect_b32 s57, 0, s57
    s_mul_i32 s53, s57, 81920
    s_add_u32 m0, s61, 16384
    s_nop 0
    buffer_load_dwordx4 v5, s[28:31], s53 offen lds
    buffer_load_dwordx4 v6, s[28:31], s53 offen offset:1024 lds
    s_add_u32 s57, s57, 1
    s_cmp_eq_u32 s57, 20
    s_cselect_b32 s57, 0, s57
    s_mul_i32 s53, s57, 81920
    s_add_u32 m0, s61, 24576
    s_nop 0
    buffer_load_dwordx4 v5, s[28:31], s53 offen lds
    buffer_load_dwordx4 v6, s[28:31], s53 offen offset:1024 lds
    s_add_u32 s57, s57, 1
    s_cmp_eq_u32 s57, 20
    s_cselect_b32 s57, 0, s57
    s_mul_i32 s53, s57, 81920
    s_add_u32 m0, s61, 32768
    s_nop 0
    buffer_load_dwordx4 v5, s[28:31], s53 offen lds
    buffer_load_dwordx4 v6, s[28:31], s53 offen offset:1024 lds
    s_add_u32 s57, s57, 1
    s_cmp_eq_u32 s57, 20
    s_cselect_b32 s57, 0, s57
    s_mul_i32 s53, s57, 81920
    s_add_u32 m0, s61, 40960
    s_nop 0
    buffer_load_dwordx4 v5, s[28:31], s53 offen lds
    buffer_load_dwordx4 v6, s[28:31], s53 offen offset:1024 lds
    s_add_u32 s57, s57, 1
    s_cmp_eq_u32 s57, 20
    s_cselect_b32 s57, 0, s57
    s_mul_i32 s53, s57, 81920
    s_add_u32 m0, s61, 131072
    s_nop 0
    buffer_load_dwordx4 v5, s[28:31], s53 offen lds
    buffer_load_dwordx4 v6, s[28:31], s53 offen offset:1024 lds
    s_add_u32 s57, s57, 1
    s_cmp_eq_u32 s57, 20
    s_cselect_b32 s57, 0, s57
    s_mul_i32 s53, s57, 81920
    s_add_u32 m0, s61, 139264
    s_nop 0
    buffer_load_dwordx4 v5, s[28:31], s53 offen lds
    buffer_load_dwordx4 v6, s[28:31], s53 offen offset:1024 lds
P2_ld10:
    s_lshl_b32 s62, s42, 12
    s_add_u32 s62, s62, 11534336
    v_and_b32 v10, 15, v1
    v_lshlrev_b32 v10, 7, v10
    v_mov_b32 v14, 163776
    v_mov_b32 v15, 1
    s_lshl1_add_u32 s60, s48, s45
    s_lshl_b32 s50, s43, 4
    s_cmp_ge_u32 s60, s50
    s_cselect_b32 s49, 1, 0
    s_cmp_lg_u32 s63, 0
    s_cbranch_scc1 P2_nb
    s_barrier
P2_nb:
    s_cmp_eq_u32 s63, 0
    s_cbranch_scc1 P2_og_39
    s_mov_b32 s51, 0
P2_sl_40:
    ds_read_b32 v160, v14 offset:24
    s_add_u32 s51, s51, 1
    s_waitcnt lgkmcnt(0)
    v_cmp_gt_u32 vcc, 8, v160
    s_cmp_ge_u32 s51, 0x1000000
    s_cbranch_scc1 P2_so_41
    s_cmp_eq_u64 vcc, 0
    s_cbranch_scc1 P2_so_41
    s_sleep 3
    s_branch P2_sl_40
P2_so_41:
P2_og_39:
    s_add_u32 s57, s57, 1
    s_cmp_eq_u32 s57, 20
    s_cselect_b32 s57, 0, s57
    s_mul_i32 s53, s57, 81920
    s_add_u32 m0, s61, 49152
    s_nop 0
    buffer_load_dwordx4 v5, s[28:31], s53 offen lds
    buffer_load_dwordx4 v6, s[28:31], s53 offen offset:1024 lds
    s_add_u32 s57, s57, 1
    s_cmp_eq_u32 s57, 20
    s_cselect_b32 s57, 0, s57
    s_mul_i32 s53, s57, 81920
    s_add_u32 m0, s61, 57344
    s_nop 0
    buffer_load_dwordx4 v5, s[28:31], s53 offen lds
    buffer_load_dwordx4 v6, s[28:31], s53 offen offset:1024 lds
    s_add_u32 s57, s57, 1
    s_cmp_eq_u32 s57, 20
    s_cselect_b32 s57, 0, s57
    s_mul_i32 s53, s57, 81920
    s_add_u32 m0, s61, 65536
    s_nop 0
    buffer_load_dwordx4 v5, s[28:31], s53 offen lds
    buffer_load_dwordx4 v6, s[28:31], s53 offen offset:1024 lds
    s_add_u32 s57, s57, 1
    s_cmp_eq_u32 s57, 20
    s_cselect_b32 s57, 0, s57
    s_mul_i32 s53, s57, 81920
    s_add_u32 m0, s61, 73728
    s_nop 0
    buffer_load_dwordx4 v5, s[28:31], s53 offen lds
    buffer_load_dwordx4 v6, s[28:31], s53 offen offset:1024 lds
    s_add_u32 s57, s57, 1
    s_cmp_eq_u32 s57, 20
    s_cselect_b32 s57, 0, s57
    s_mul_i32 s53, s57, 81920
    s_add_u32 m0, s61, 81920
    s_nop 0
    buffer_load_dwordx4 v5, s[28:31], s53 offen lds
    buffer_load_dwordx4 v6, s[28:31], s53 offen offset:1024 lds
    s_add_u32 s57, s57, 1
    s_cmp_eq_u32 s57, 20
    s_cselect_b32 s57, 0, s57
    s_mul_i32 s53, s57, 81920
    s_add_u32 m0, s61, 90112
    s_nop 0
    buffer_load_dwordx4 v5, s[28:31], s53 offen lds
    buffer_load_dwordx4 v6, s[28:31], s53 offen offset:1024 lds
    s_add_u32 s57, s57, 1
    s_cmp_eq_u32 s57, 20
    s_cselect_b32 s57, 0, s57
    s_mul_i32 s53, s57, 81920
    s_add_u32 m0, s61, 98304
    s_nop 0
    buffer_load_dwordx4 v5, s[28:31], s53 offen lds
    buffer_load_dwordx4 v6, s[28:31], s53 offen offset:1024 lds
    s_add_u32 s57, s57, 1
    s_cmp_eq_u32 s57, 20
    s_cselect_b32 s57, 0, s57
    s_mul_i32 s53, s57, 81920
    s_add_u32 m0, s61, 106496
    s_nop 0
    buffer_load_dwordx4 v5, s[28:31], s53 offen lds
    buffer_load_dwordx4 v6, s[28:31], s53 offen offset:1024 lds
    s_cmp_eq_u32 s48, 3
    s_cbranch_scc1 P2_ws
    s_cmp_eq_u32 s49, 1
    s_cbranch_scc1 P2_idle
    buffer_load_dword v11, v10, s[32:35], s62 offen sc1
    v_bfe_u32 v8, v1, 4, 1
    s_mov_b32 s50, 69632
    v_mul_u32_u24 v2, s50, v8
    v_lshrrev_b32 v3, 5, v1
    v_lshl_add_u32 v2, v3, 8, v2
    v_and_b32 v9, 15, v1
    v_lshl_add_u32 v2, v9, 4, v2
    s_mul_i32 s50, s60, 69632
    v_add_u32 v2, s50, v2
    s_mov_b32 s24, s22
    s_mov_b32 s25, s23
    s_mov_b32 s26, 8912896
    v_bfe_u32 v9, v1, 2, 2
    v_lshl_add_u32 v9, v3, 3, v9
    v_lshlrev_b32 v4, 7, v9
    v_bfe_u32 v9, v1, 3, 1
    v_lshl_add_u32 v4, v9, 6, v4
    v_and_b32 v9, 1, v1
    v_lshl_add_u32 v4, v9, 5, v4
    v_lshl_add_u32 v4, v8, 4, v4
    v_bfe_u32 v9, v1, 1, 1
    v_lshl_add_u32 v4, v9, 3, v4
    v_add_u32 v4, 65536, v4
    v_xor_b32 v5, 64, v4
    v_mov_b32 v48, 0
    v_mov_b32 v49, 0
    v_mov_b32 v50, 0
    v_mov_b32 v51, 0
    v_mov_b32 v52, 0
    v_mov_b32 v53, 0
    v_mov_b32 v54, 0
    v_mov_b32 v55, 0
    v_mov_b32 v56, 0
    v_mov_b32 v57, 0
    v_mov_b32 v58, 0
    v_mov_b32 v59, 0
    v_mov_b32 v60, 0
    v_mov_b32 v61, 0
    v_mov_b32 v62, 0
    v_mov_b32 v63, 0
    v_mov_b32 v64, 0
    v_mov_b32 v65, 0
    v_mov_b32 v66, 0
    v_mov_b32 v67, 0
    v_mov_b32 v68, 0
    v_mov_b32 v69, 0
    v_mov_b32 v70, 0
    v_mov_b32 v71, 0
    v_mov_b32 v72, 0
    v_mov_b32 v73, 0
    v_mov_b32 v74, 0
    v_mov_b32 v75, 0
    v_mov_b32 v76, 0
    v_mov_b32 v77, 0
    v_mov_b32 v78, 0
    v_mov_b32 v79, 0
    s_lshl_b32 s50, s48, 2
    v_add_u32 v13, s50, v14
    s_waitcnt vmcnt(0)
    s_mov_b64 exec, 1
    ds_add_u32 v14, v15 offset:16
    s_mov_b64 exec, -1
    s_mov_b32 s51, 0
P2_dl_43:
    v_cmp_ne_u32 vcc, 1, v11
    s_add_u32 s51, s51, 1
    s_cmp_eq_u64 vcc, 0
    s_cbranch_scc1 P2_dk_42
    s_cmp_ge_u32 s51, 65536
    s_cbranch_scc1 P2_dk_42
    s_sleep 2
    buffer_load_dword v11, v10, s[32:35], s62 offen sc1
    s_waitcnt vmcnt(0)
    s_branch P2_dl_43
P2_dk_42:
    s_setprio 0
    s_lshl_b32 s52, s56, 11
    buffer_load_dwordx4 v[80:83], v2, s[24:27], s52 offen offset:0 sc1
    buffer_load_dwordx4 v[84:87], v2, s[24:27], s52 offen offset:512 sc1
    buffer_load_dwordx4 v[88:91], v2, s[24:27], s52 offen offset:1024 sc1
    buffer_load_dwordx4 v[92:95], v2, s[24:27], s52 offen offset:1536 sc1
    s_add_u32 s56, s56, 1
    s_cmp_eq_u32 s56, 20
    s_cselect_b32 s56, 0, s56
    s_lshl_b32 s52, s56, 11
    buffer_load_dwordx4 v[96:99], v2, s[24:27], s52 offen offset:0 sc1
    buffer_load_dwordx4 v[100:103], v2, s[24:27], s52 offen offset:512 sc1
    buffer_load_dwordx4 v[104:107], v2, s[24:27], s52 offen offset:1024 sc1
    buffer_load_dwordx4 v[108:111], v2, s[24:27], s52 offen offset:1536 sc1
    s_add_u32 s56, s56, 1
    s_cmp_eq_u32 s56, 20
    s_cselect_b32 s56, 0, s56
    s_lshl_b32 s52, s56, 11
    buffer_load_dwordx4 v[112:115], v2, s[24:27], s52 offen offset:0 sc1
    buffer_load_dwordx4 v[116:119], v2, s[24:27], s52 offen offset:512 sc1
    buffer_load_dwordx4 v[120:123], v2, s[24:27], s52 offen offset:1024 sc1
    buffer_load_dwordx4 v[124:127], v2, s[24:27], s52 offen offset:1536 sc1
    s_add_u32 s56, s56, 1
    s_cmp_eq_u32 s56, 20
    s_cselect_b32 s56, 0, s56
    s_lshl_b32 s52, s56, 11
    buffer_load_dwordx4 v[128:131], v2, s[24:27], s52 offen offset:0 sc1
    buffer_load_dwordx4 v[132:135], v2, s[24:27], s52 offen offset:512 sc1
    buffer_load_dwordx4 v[136:139], v2, s[24:27], s52 offen offset:1024 sc1
    buffer_load_dwordx4 v[140:143], v2, s[24:27], s52 offen offset:1536 sc1
    s_add_u32 s56, s56, 1
    s_cmp_eq_u32 s56, 20
    s_cselect_b32 s56, 0, s56
    s_lshl_b32 s52, s56, 11
    buffer_load_dwordx4 v[144:147], v2, s[24:27], s52 offen offset:0 sc1
    buffer_load_dwordx4 v[148:151], v2, s[24:27], s52 offen offset:512 sc1
    buffer_load_dwordx4 v[152:155], v2, s[24:27], s52 offen offset:1024 sc1
    buffer_load_dwordx4 v[156:159], v2, s[24:27], s52 offen offset:1536 sc1
    s_mov_b32 s51, 0
P2_sl_44:
    ds_read_b32 v160, v14 offset:16
    s_add_u32 s51, s51, 1
    s_waitcnt lgkmcnt(0)
    v_cmp_gt_u32 vcc, 4, v160
    s_cmp_ge_u32 s51, 0x1000000
    s_cbranch_scc1 P2_so_45
    s_cmp_eq_u64 vcc, 0
    s_cbranch_scc1 P2_so_45
    s_sleep 1
    s_branch P2_sl_44
P2_so_45:
    ds_read_b64_tr_b16 v[16:17], v4 offset:49152
    ds_read_b64_tr_b16 v[18:19], v4 offset:49664
    ds_read_b64_tr_b16 v[20:21], v5 offset:49152
    ds_read_b64_tr_b16 v[22:23], v5 offset:49664
    ds_read_b64_tr_b16 v[24:25], v4 offset:51200
    ds_read_b64_tr_b16 v[26:27], v4 offset:51712
    ds_read_b64_tr_b16 v[28:29], v5 offset:51200
    ds_read_b64_tr_b16 v[30:31], v5 offset:51712
    s_waitcnt vmcnt(18)
    s_waitcnt lgkmcnt(0)
    v_mfma_f32_32x32x16_bf16 v[48:63], v[16:19], v[80:83], v[48:63]
    ds_read_b64_tr_b16 v[32:33], v4 offset:53248
    ds_read_b64_tr_b16 v[34:35], v4 offset:53760
    ds_read_b64_tr_b16 v[36:37], v5 offset:53248
    ds_read_b64_tr_b16 v[38:39], v5 offset:53760
    v_mfma_f32_32x32x16_bf16 v[64:79], v[20:23], v[80:83], v[64:79]
    ds_read_b64_tr_b16 v[40:41], v4 offset:55296
    ds_read_b64_tr_b16 v[42:43], v4 offset:55808
    ds_read_b64_tr_b16 v[44:45], v5 offset:55296
    ds_read_b64_tr_b16 v[46:47], v5 offset:55808
    v_mfma_f32_32x32x16_bf16 v[48:63], v[24:27], v[84:87], v[48:63]
    v_mfma_f32_32x32x16_bf16 v[64:79], v[28:31], v[84:87], v[64:79]
    s_waitcnt vmcnt(16)
    s_waitcnt lgkmcnt(0)
    v_mfma_f32_32x32x16_bf16 v[48:63], v[32:35], v[88:91], v[48:63]
    ds_read_b64_tr_b16 v[16:17], v4 offset:57344
    ds_read_b64_tr_b16 v[18:19], v4 offset:57856
    ds_read_b64_tr_b16 v[20:21], v5 offset:57344
    ds_read_b64_tr_b16 v[22:23], v5 offset:57856
    v_mfma_f32_32x32x16_bf16 v[64:79], v[36:39], v[88:91], v[64:79]
    ds_read_b64_tr_b16 v[24:25], v4 offset:59392
    ds_read_b64_tr_b16 v[26:27], v4 offset:59904
    ds_read_b64_tr_b16 v[28:29], v5 offset:59392
    ds_read_b64_tr_b16 v[30:31], v5 offset:59904
    v_mfma_f32_32x32x16_bf16 v[48:63], v[40:43], v[92:95], v[48:63]
    s_add_u32 s56, s56, 1
    s_cmp_eq_u32 s56, 20
    s_cselect_b32 s56, 0, s56
    s_lshl_b32 s52, s56, 11
    buffer_load_dwordx4 v[80:83], v2, s[24:27], s52 offen offset:0 sc1
    v_mfma_f32_32x32x16_bf16 v[64:79], v[44:47], v[92:95], v[64:79]
    buffer_load_dwordx4 v[84:87], v2, s[24:27], s52 offen offset:512 sc1
    s_waitcnt vmcnt(16)
    s_waitcnt lgkmcnt(0)
    v_mfma_f32_32x32x16_bf16 v[48:63], v[16:19], v[96:99], v[48:63]
    ds_read_b64_tr_b16 v[32:33], v4 offset:61440
    ds_read_b64_tr_b16 v[34:35], v4 offset:61952
    ds_read_b64_tr_b16 v[36:37], v5 offset:61440
    ds_read_b64_tr_b16 v[38:39], v5 offset:61952
    v_mfma_f32_32x32x16_bf16 v[64:79], v[20:23], v[96:99], v[64:79]
    ds_read_b64_tr_b16 v[40:41], v4 offset:63488
    ds_read_b64_tr_b16 v[42:43], v4 offset:64000
    ds_read_b64_tr_b16 v[44:45], v5 offset:63488
    ds_read_b64_tr_b16 v[46:47], v5 offset:64000
    v_mfma_f32_32x32x16_bf16 v[48:63], v[24:27], v[100:103], v[48:63]
    buffer_load_dwordx4 v[88:91], v2, s[24:27], s52 offen offset:1024 sc1
    v_mfma_f32_32x32x16_bf16 v[64:79], v[28:31], v[100:103], v[64:79]
    buffer_load_dwordx4 v[92:95], v2, s[24:27], s52 offen offset:1536 sc1
    s_waitcnt vmcnt(16)
    s_waitcnt lgkmcnt(0)
    v_mfma_f32_32x32x16_bf16 v[48:63], v[32:35], v[104:107], v[48:63]
    v_add_u32 v4, 0xffff0000, v4
    v_add_u32 v5, 0xffff0000, v5
    ds_read_b64_tr_b16 v[16:17], v4 offset:0
    ds_read_b64_tr_b16 v[18:19], v4 offset:512
    v_mfma_f32_32x32x16_bf16 v[64:79], v[36:39], v[104:107], v[64:79]
    ds_read_b64_tr_b16 v[20:21], v5 offset:0
    ds_read_b64_tr_b16 v[22:23], v5 offset:512
    ds_read_b64_tr_b16 v[24:25], v4 offset:2048
    ds_read_b64_tr_b16 v[26:27], v4 offset:2560
    v_mfma_f32_32x32x16_bf16 v[48:63], v[40:43], v[108:111], v[48:63]
    ds_read_b64_tr_b16 v[28:29], v5 offset:2048
    ds_read_b64_tr_b16 v[30:31], v5 offset:2560
    s_add_u32 s56, s56, 1
    s_cmp_eq_u32 s56, 20
    s_cselect_b32 s56, 0, s56
    s_lshl_b32 s52, s56, 11
    buffer_load_dwordx4 v[96:99], v2, s[24:27], s52 offen offset:0 sc1
    v_mfma_f32_32x32x16_bf16 v[64:79], v[44:47], v[108:111], v[64:79]
    buffer_load_dwordx4 v[100:103], v2, s[24:27], s52 offen offset:512 sc1
    s_waitcnt vmcnt(16)
    s_waitcnt lgkmcnt(0)
    v_mfma_f32_32x32x16_bf16 v[48:63], v[16:19], v[112:115], v[48:63]
    ds_read_b64_tr_b16 v[32:33], v4 offset:4096
    ds_read_b64_tr_b16 v[34:35], v4 offset:4608
    ds_read_b64_tr_b16 v[36:37], v5 offset:4096
    ds_read_b64_tr_b16 v[38:39], v5 offset:4608
    v_mfma_f32_32x32x16_bf16 v[64:79], v[20:23], v[112:115], v[64:79]
    ds_read_b64_tr_b16 v[40:41], v4 offset:6144
    ds_read_b64_tr_b16 v[42:43], v4 offset:6656
    ds_read_b64_tr_b16 v[44:45], v5 offset:6144
    ds_read_b64_tr_b16 v[46:47], v5 offset:6656
    v_mfma_f32_32x32x16_bf16 v[48:63], v[24:27], v[116:119], v[48:63]
    buffer_load_dwordx4 v[104:107], v2, s[24:27], s52 offen offset:1024 sc1
    v_mfma_f32_32x32x16_bf16 v[64:79], v[28:31], v[116:119], v[64:79]
    buffer_load_dwordx4 v[108:111], v2, s[24:27], s52 offen offset:1536 sc1
    s_waitcnt vmcnt(16)
    s_waitcnt lgkmcnt(0)
    v_mfma_f32_32x32x16_bf16 v[48:63], v[32:35], v[120:123], v[48:63]
    ds_read_b64_tr_b16 v[16:17], v4 offset:8192
    ds_read_b64_tr_b16 v[18:19], v4 offset:8704
    ds_read_b64_tr_b16 v[20:21], v5 offset:8192
    ds_read_b64_tr_b16 v[22:23], v5 offset:8704
    v_mfma_f32_32x32x16_bf16 v[64:79], v[36:39], v[120:123], v[64:79]
    ds_read_b64_tr_b16 v[24:25], v4 offset:10240
    ds_read_b64_tr_b16 v[26:27], v4 offset:10752
    ds_read_b64_tr_b16 v[28:29], v5 offset:10240
    ds_read_b64_tr_b16 v[30:31], v5 offset:10752
    v_mfma_f32_32x32x16_bf16 v[48:63], v[40:43], v[124:127], v[48:63]
    s_add_u32 s56, s56, 1
    s_cmp_eq_u32 s56, 20
    s_cselect_b32 s56, 0, s56
    s_lshl_b32 s52, s56, 11
    buffer_load_dwordx4 v[112:115], v2, s[24:27], s52 offen offset:0 sc1
    v_mfma_f32_32x32x16_bf16 v[64:79], v[44:47], v[124:127], v[64:79]
    buffer_load_dwordx4 v[116:119], v2, s[24:27], s52 offen offset:512 sc1
    s_waitcnt vmcnt(16)
    s_waitcnt lgkmcnt(0)
    v_mfma_f32_32x32x16_bf16 v[48:63], v[16:19], v[128:131], v[48:63]
    ds_read_b64_tr_b16 v[32:33], v4 offset:12288
    ds_read_b64_tr_b16 v[34:35], v4 offset:12800
    ds_read_b64_tr_b16 v[36:37], v5 offset:12288
    ds_read_b64_tr_b16 v[38:39], v5 offset:12800
    v_mfma_f32_32x32x16_bf16 v[64:79], v[20:23], v[128:131], v[64:79]
    ds_read_b64_tr_b16 v[40:41], v4 offset:14336
    ds_read_b64_tr_b16 v[42:43], v4 offset:14848
    ds_read_b64_tr_b16 v[44:45], v5 offset:14336
    ds_read_b64_tr_b16 v[46:47], v5 offset:14848
    v_mfma_f32_32x32x16_bf16 v[48:63], v[24:27], v[132:135], v[48:63]
    v_mov_b32 v15, 4
    ds_write_b32 v13, v15
    buffer_load_dwordx4 v[120:123], v2, s[24:27], s52 offen offset:1024 sc1
    v_mfma_f32_32x32x16_bf16 v[64:79], v[28:31], v[132:135], v[64:79]
    buffer_load_dwordx4 v[124:127], v2, s[24:27], s52 offen offset:1536 sc1
    s_waitcnt vmcnt(16)
    s_waitcnt lgkmcnt(1)
    v_mfma_f32_32x32x16_bf16 v[48:63], v[32:35], v[136:139], v[48:63]
    ds_read_b64_tr_b16 v[16:17], v4 offset:16384
    ds_read_b64_tr_b16 v[18:19], v4 offset:16896
    ds_read_b64_tr_b16 v[20:21], v5 offset:16384
    ds_read_b64_tr_b16 v[22:23], v5 offset:16896
    v_mfma_f32_32x32x16_bf16 v[64:79], v[36:39], v[136:139], v[64:79]
    ds_read_b64_tr_b16 v[24:25], v4 offset:18432
    ds_read_b64_tr_b16 v[26:27], v4 offset:18944
    ds_read_b64_tr_b16 v[28:29], v5 offset:18432
    ds_read_b64_tr_b16 v[30:31], v5 offset:18944
    v_mfma_f32_32x32x16_bf16 v[48:63], v[40:43], v[140:143], v[48:63]
    s_add_u32 s56, s56, 1
    s_cmp_eq_u32 s56, 20
    s_cselect_b32 s56, 0, s56
    s_lshl_b32 s52, s56, 11
    buffer_load_dwordx4 v[128:131], v2, s[24:27], s52 offen offset:0 sc1
    v_mfma_f32_32x32x16_bf16 v[64:79], v[44:47], v[140:143], v[64:79]
    buffer_load_dwordx4 v[132:135], v2, s[24:27], s52 offen offset:512 sc1
    s_waitcnt vmcnt(16)
    s_waitcnt lgkmcnt(0)
    v_mfma_f32_32x32x16_bf16 v[48:63], v[16:19], v[144:147], v[48:63]
    ds_read_b64_tr_b16 v[32:33], v4 offset:20480
    ds_read_b64_tr_b16 v[34:35], v4 offset:20992
    ds_read_b64_tr_b16 v[36:37], v5 offset:20480
    ds_read_b64_tr_b16 v[38:39], v5 offset:20992
    v_mfma_f32_32x32x16_bf16 v[64:79], v[20:23], v[144:147], v[64:79]
    ds_read_b64_tr_b16 v[40:41], v4 offset:22528
    ds_read_b64_tr_b16 v[42:43], v4 offset:23040
    ds_read_b64_tr_b16 v[44:45], v5 offset:22528
    ds_read_b64_tr_b16 v[46:47], v5 offset:23040
    v_mfma_f32_32x32x16_bf16 v[48:63], v[24:27], v[148:151], v[48:63]
    buffer_load_dwordx4 v[136:139], v2, s[24:27], s52 offen offset:1024 sc1
    v_mfma_f32_32x32x16_bf16 v[64:79], v[28:31], v[148:151], v[64:79]
    buffer_load_dwordx4 v[140:143], v2, s[24:27], s52 offen offset:1536 sc1
    s_waitcnt vmcnt(16)
    s_waitcnt lgkmcnt(0)
    v_mfma_f32_32x32x16_bf16 v[48:63], v[32:35], v[152:155], v[48:63]
    ds_read_b64_tr_b16 v[16:17], v4 offset:24576
    ds_read_b64_tr_b16 v[18:19], v4 offset:25088
    ds_read_b64_tr_b16 v[20:21], v5 offset:24576
    ds_read_b64_tr_b16 v[22:23], v5 offset:25088
    v_mfma_f32_32x32x16_bf16 v[64:79], v[36:39], v[152:155], v[64:79]
    ds_read_b64_tr_b16 v[24:25], v4 offset:26624
    ds_read_b64_tr_b16 v[26:27], v4 offset:27136
    ds_read_b64_tr_b16 v[28:29], v5 offset:26624
    ds_read_b64_tr_b16 v[30:31], v5 offset:27136
    v_mfma_f32_32x32x16_bf16 v[48:63], v[40:43], v[156:159], v[48:63]
    s_add_u32 s56, s56, 1
    s_cmp_eq_u32 s56, 20
    s_cselect_b32 s56, 0, s56
    s_lshl_b32 s52, s56, 11
    buffer_load_dwordx4 v[144:147], v2, s[24:27], s52 offen offset:0 sc1
    v_mfma_f32_32x32x16_bf16 v[64:79], v[44:47], v[156:159], v[64:79]
    buffer_load_dwordx4 v[148:151], v2, s[24:27], s52 offen offset:512 sc1
    s_waitcnt vmcnt(16)
    s_waitcnt lgkmcnt(0)
    v_mfma_f32_32x32x16_bf16 v[48:63], v[16:19], v[80:83], v[48:63]
    ds_read_b64_tr_b16 v[32:33], v4 offset:28672
    ds_read_b64_tr_b16 v[34:35], v4 offset:29184
    ds_read_b64_tr_b16 v[36:37], v5 offset:28672
    ds_read_b64_tr_b16 v[38:39], v5 offset:29184
    v_mfma_f32_32x32x16_bf16 v[64:79], v[20:23], v[80:83], v[64:79]
    ds_read_b64_tr_b16 v[40:41], v4 offset:30720
    ds_read_b64_tr_b16 v[42:43], v4 offset:31232
    ds_read_b64_tr_b16 v[44:45], v5 offset:30720
    ds_read_b64_tr_b16 v[46:47], v5 offset:31232
    v_mfma_f32_32x32x16_bf16 v[48:63], v[24:27], v[84:87], v[48:63]
    buffer_load_dwordx4 v[152:155], v2, s[24:27], s52 offen offset:1024 sc1
    v_mfma_f32_32x32x16_bf16 v[64:79], v[28:31], v[84:87], v[64:79]
    buffer_load_dwordx4 v[156:159], v2, s[24:27], s52 offen offset:1536 sc1
    s_waitcnt vmcnt(16)
    s_waitcnt lgkmcnt(0)
    v_mfma_f32_32x32x16_bf16 v[48:63], v[32:35], v[88:91], v[48:63]
    ds_read_b64_tr_b16 v[16:17], v4 offset:32768
    ds_read_b64_tr_b16 v[18:19], v4 offset:33280
    ds_read_b64_tr_b16 v[20:21], v5 offset:32768
    ds_read_b64_tr_b16 v[22:23], v5 offset:33280
    v_mfma_f32_32x32x16_bf16 v[64:79], v[36:39], v[88:91], v[64:79]
    ds_read_b64_tr_b16 v[24:25], v4 offset:34816
    ds_read_b64_tr_b16 v[26:27], v4 offset:35328
    ds_read_b64_tr_b16 v[28:29], v5 offset:34816
    ds_read_b64_tr_b16 v[30:31], v5 offset:35328
    v_mfma_f32_32x32x16_bf16 v[48:63], v[40:43], v[92:95], v[48:63]
    s_add_u32 s56, s56, 1
    s_cmp_eq_u32 s56, 20
    s_cselect_b32 s56, 0, s56
    s_lshl_b32 s52, s56, 11
    buffer_load_dwordx4 v[80:83], v2, s[24:27], s52 offen offset:0 sc1
    v_mfma_f32_32x32x16_bf16 v[64:79], v[44:47], v[92:95], v[64:79]
    buffer_load_dwordx4 v[84:87], v2, s[24:27], s52 offen offset:512 sc1
    s_waitcnt vmcnt(16)
    s_waitcnt lgkmcnt(0)
    v_mfma_f32_32x32x16_bf16 v[48:63], v[16:19], v[96:99], v[48:63]
    ds_read_b64_tr_b16 v[32:33], v4 offset:36864
    ds_read_b64_tr_b16 v[34:35], v4 offset:37376
    ds_read_b64_tr_b16 v[36:37], v5 offset:36864
    ds_read_b64_tr_b16 v[38:39], v5 offset:37376
    v_mfma_f32_32x32x16_bf16 v[64:79], v[20:23], v[96:99], v[64:79]
    ds_read_b64_tr_b16 v[40:41], v4 offset:38912
    ds_read_b64_tr_b16 v[42:43], v4 offset:39424
    ds_read_b64_tr_b16 v[44:45], v5 offset:38912
    ds_read_b64_tr_b16 v[46:47], v5 offset:39424
    v_mfma_f32_32x32x16_bf16 v[48:63], v[24:27], v[100:103], v[48:63]
    buffer_load_dwordx4 v[88:91], v2, s[24:27], s52 offen offset:1024 sc1
    v_mfma_f32_32x32x16_bf16 v[64:79], v[28:31], v[100:103], v[64:79]
    buffer_load_dwordx4 v[92:95], v2, s[24:27], s52 offen offset:1536 sc1
    s_waitcnt vmcnt(16)
    s_waitcnt lgkmcnt(0)
    v_mfma_f32_32x32x16_bf16 v[48:63], v[32:35], v[104:107], v[48:63]
    ds_read_b64_tr_b16 v[16:17], v4 offset:40960
    ds_read_b64_tr_b16 v[18:19], v4 offset:41472
    ds_read_b64_tr_b16 v[20:21], v5 offset:40960
    ds_read_b64_tr_b16 v[22:23], v5 offset:41472
    v_mfma_f32_32x32x16_bf16 v[64:79], v[36:39], v[104:107], v[64:79]
    ds_read_b64_tr_b16 v[24:25], v4 offset:43008
    ds_read_b64_tr_b16 v[26:27], v4 offset:43520
    ds_read_b64_tr_b16 v[28:29], v5 offset:43008
    ds_read_b64_tr_b16 v[30:31], v5 offset:43520
    v_mfma_f32_32x32x16_bf16 v[48:63], v[40:43], v[108:111], v[48:63]
    s_add_u32 s56, s56, 1
    s_cmp_eq_u32 s56, 20
    s_cselect_b32 s56, 0, s56
    s_lshl_b32 s52, s56, 11
    buffer_load_dwordx4 v[96:99], v2, s[24:27], s52 offen offset:0 sc1
    v_mfma_f32_32x32x16_bf16 v[64:79], v[44:47], v[108:111], v[64:79]
    buffer_load_dwordx4 v[100:103], v2, s[24:27], s52 offen offset:512 sc1
    s_waitcnt vmcnt(16)
    s_waitcnt lgkmcnt(0)
    v_mfma_f32_32x32x16_bf16 v[48:63], v[16:19], v[112:115], v[48:63]
    ds_read_b64_tr_b16 v[32:33], v4 offset:45056
    ds_read_b64_tr_b16 v[34:35], v4 offset:45568
    ds_read_b64_tr_b16 v[36:37], v5 offset:45056
    ds_read_b64_tr_b16 v[38:39], v5 offset:45568
    v_mfma_f32_32x32x16_bf16 v[64:79], v[20:23], v[112:115], v[64:79]
    ds_read_b64_tr_b16 v[40:41], v4 offset:47104
    ds_read_b64_tr_b16 v[42:43], v4 offset:47616
    ds_read_b64_tr_b16 v[44:45], v5 offset:47104
    ds_read_b64_tr_b16 v[46:47], v5 offset:47616
    v_mfma_f32_32x32x16_bf16 v[48:63], v[24:27], v[116:119], v[48:63]
    v_mov_b32 v15, 8
    ds_write_b32 v13, v15
    buffer_load_dwordx4 v[104:107], v2, s[24:27], s52 offen offset:1024 sc1
    v_mfma_f32_32x32x16_bf16 v[64:79], v[28:31], v[116:119], v[64:79]
    buffer_load_dwordx4 v[108:111], v2, s[24:27], s52 offen offset:1536 sc1
    s_waitcnt vmcnt(16)
    s_waitcnt lgkmcnt(1)
    v_mfma_f32_32x32x16_bf16 v[48:63], v[32:35], v[120:123], v[48:63]
    v_add_u32 v4, 0x20000, v4
    v_add_u32 v5, 0x20000, v5
    ds_read_b64_tr_b16 v[16:17], v4 offset:0
    ds_read_b64_tr_b16 v[18:19], v4 offset:512
    v_mfma_f32_32x32x16_bf16 v[64:79], v[36:39], v[120:123], v[64:79]
    ds_read_b64_tr_b16 v[20:21], v5 offset:0
    ds_read_b64_tr_b16 v[22:23], v5 offset:512
    ds_read_b64_tr_b16 v[24:25], v4 offset:2048
    ds_read_b64_tr_b16 v[26:27], v4 offset:2560
    v_mfma_f32_32x32x16_bf16 v[48:63], v[40:43], v[124:127], v[48:63]
    ds_read_b64_tr_b16 v[28:29], v5 offset:2048
    ds_read_b64_tr_b16 v[30:31], v5 offset:2560
    s_add_u32 s56, s56, 1
    s_cmp_eq_u32 s56, 20
    s_cselect_b32 s56, 0, s56
    s_lshl_b32 s52, s56, 11
    buffer_load_dwordx4 v[112:115], v2, s[24:27], s52 offen offset:0 sc1
    v_mfma_f32_32x32x16_bf16 v[64:79], v[44:47], v[124:127], v[64:79]
    buffer_load_dwordx4 v[116:119], v2, s[24:27], s52 offen offset:512 sc1
    s_waitcnt vmcnt(16)
    s_waitcnt lgkmcnt(0)
    v_mfma_f32_32x32x16_bf16 v[48:63], v[16:19], v[128:131], v[48:63]
    ds_read_b64_tr_b16 v[32:33], v4 offset:4096
    ds_read_b64_tr_b16 v[34:35], v4 offset:4608
    ds_read_b64_tr_b16 v[36:37], v5 offset:4096
    ds_read_b64_tr_b16 v[38:39], v5 offset:4608
    v_mfma_f32_32x32x16_bf16 v[64:79], v[20:23], v[128:131], v[64:79]
    ds_read_b64_tr_b16 v[40:41], v4 offset:6144
    ds_read_b64_tr_b16 v[42:43], v4 offset:6656
    ds_read_b64_tr_b16 v[44:45], v5 offset:6144
    ds_read_b64_tr_b16 v[46:47], v5 offset:6656
    v_mfma_f32_32x32x16_bf16 v[48:63], v[24:27], v[132:135], v[48:63]
    buffer_load_dwordx4 v[120:123], v2, s[24:27], s52 offen offset:1024 sc1
    v_mfma_f32_32x32x16_bf16 v[64:79], v[28:31], v[132:135], v[64:79]
    buffer_load_dwordx4 v[124:127], v2, s[24:27], s52 offen offset:1536 sc1
    s_waitcnt vmcnt(16)
    s_waitcnt lgkmcnt(0)
    v_mfma_f32_32x32x16_bf16 v[48:63], v[32:35], v[136:139], v[48:63]
    ds_read_b64_tr_b16 v[16:17], v4 offset:8192
    ds_read_b64_tr_b16 v[18:19], v4 offset:8704
    ds_read_b64_tr_b16 v[20:21], v5 offset:8192
    ds_read_b64_tr_b16 v[22:23], v5 offset:8704
    v_mfma_f32_32x32x16_bf16 v[64:79], v[36:39], v[136:139], v[64:79]
    ds_read_b64_tr_b16 v[24:25], v4 offset:10240
    ds_read_b64_tr_b16 v[26:27], v4 offset:10752
    ds_read_b64_tr_b16 v[28:29], v5 offset:10240
    ds_read_b64_tr_b16 v[30:31], v5 offset:10752
    v_mfma_f32_32x32x16_bf16 v[48:63], v[40:43], v[140:143], v[48:63]
    s_add_u32 s56, s56, 1
    s_cmp_eq_u32 s56, 20
    s_cselect_b32 s56, 0, s56
    s_lshl_b32 s52, s56, 11
    buffer_load_dwordx4 v[128:131], v2, s[24:27], s52 offen offset:0 sc1
    v_mfma_f32_32x32x16_bf16 v[64:79], v[44:47], v[140:143], v[64:79]
    buffer_load_dwordx4 v[132:135], v2, s[24:27], s52 offen offset:512 sc1
    s_waitcnt vmcnt(16)
    s_waitcnt lgkmcnt(0)
    v_mfma_f32_32x32x16_bf16 v[48:63], v[16:19], v[144:147], v[48:63]
    ds_read_b64_tr_b16 v[32:33], v4 offset:12288
    ds_read_b64_tr_b16 v[34:35], v4 offset:12800
    ds_read_b64_tr_b16 v[36:37], v5 offset:12288
    ds_read_b64_tr_b16 v[38:39], v5 offset:12800
    v_mfma_f32_32x32x16_bf16 v[64:79], v[20:23], v[144:147], v[64:79]
    ds_read_b64_tr_b16 v[40:41], v4 offset:14336
    ds_read_b64_tr_b16 v[42:43], v4 offset:14848
    ds_read_b64_tr_b16 v[44:45], v5 offset:14336
    ds_read_b64_tr_b16 v[46:47], v5 offset:14848
    v_mfma_f32_32x32x16_bf16 v[48:63], v[24:27], v[148:151], v[48:63]
    buffer_load_dwordx4 v[136:139], v2, s[24:27], s52 offen offset:1024 sc1
    v_mfma_f32_32x32x16_bf16 v[64:79], v[28:31], v[148:151], v[64:79]
    buffer_load_dwordx4 v[140:143], v2, s[24:27], s52 offen offset:1536 sc1
    s_waitcnt vmcnt(16)
    s_waitcnt lgkmcnt(0)
    v_mfma_f32_32x32x16_bf16 v[48:63], v[32:35], v[152:155], v[48:63]
    v_add_u32 v4, 0xfffe0000, v4
    v_add_u32 v5, 0xfffe0000, v5
    ds_read_b64_tr_b16 v[16:17], v4 offset:49152
    ds_read_b64_tr_b16 v[18:19], v4 offset:49664
    v_mfma_f32_32x32x16_bf16 v[64:79], v[36:39], v[152:155], v[64:79]
    ds_read_b64_tr_b16 v[20:21], v5 offset:49152
    ds_read_b64_tr_b16 v[22:23], v5 offset:49664
    ds_read_b64_tr_b16 v[24:25], v4 offset:51200
    ds_read_b64_tr_b16 v[26:27], v4 offset:51712
    v_mfma_f32_32x32x16_bf16 v[48:63], v[40:43], v[156:159], v[48:63]
    ds_read_b64_tr_b16 v[28:29], v5 offset:51200
    ds_read_b64_tr_b16 v[30:31], v5 offset:51712
    s_add_u32 s56, s56, 1
    s_cmp_eq_u32 s56, 20
    s_cselect_b32 s56, 0, s56
    s_lshl_b32 s52, s56, 11
    buffer_load_dwordx4 v[144:147], v2, s[24:27], s52 offen offset:0 sc1
    v_mfma_f32_32x32x16_bf16 v[64:79], v[44:47], v[156:159], v[64:79]
    buffer_load_dwordx4 v[148:151], v2, s[24:27], s52 offen offset:512 sc1
    s_waitcnt vmcnt(16)
    s_waitcnt lgkmcnt(0)
    v_mfma_f32_32x32x16_bf16 v[48:63], v[16:19], v[80:83], v[48:63]
    ds_read_b64_tr_b16 v[32:33], v4 offset:53248
    ds_read_b64_tr_b16 v[34:35], v4 offset:53760
    ds_read_b64_tr_b16 v[36:37], v5 offset:53248
    ds_read_b64_tr_b16 v[38:39], v5 offset:53760
    v_mfma_f32_32x32x16_bf16 v[64:79], v[20:23], v[80:83], v[64:79]
    ds_read_b64_tr_b16 v[40:41], v4 offset:55296
    ds_read_b64_tr_b16 v[42:43], v4 offset:55808
    ds_read_b64_tr_b16 v[44:45], v5 offset:55296
    ds_read_b64_tr_b16 v[46:47], v5 offset:55808
    v_mfma_f32_32x32x16_bf16 v[48:63], v[24:27], v[84:87], v[48:63]
    buffer_load_dwordx4 v[152:155], v2, s[24:27], s52 offen offset:1024 sc1
    v_mfma_f32_32x32x16_bf16 v[64:79], v[28:31], v[84:87], v[64:79]
    buffer_load_dwordx4 v[156:159], v2, s[24:27], s52 offen offset:1536 sc1
    s_waitcnt vmcnt(16)
    s_waitcnt lgkmcnt(0)
    v_mfma_f32_32x32x16_bf16 v[48:63], v[32:35], v[88:91], v[48:63]
    ds_read_b64_tr_b16 v[16:17], v4 offset:57344
    ds_read_b64_tr_b16 v[18:19], v4 offset:57856
    ds_read_b64_tr_b16 v[20:21], v5 offset:57344
    ds_read_b64_tr_b16 v[22:23], v5 offset:57856
    v_mfma_f32_32x32x16_bf16 v[64:79], v[36:39], v[88:91], v[64:79]
    ds_read_b64_tr_b16 v[24:25], v4 offset:59392
    ds_read_b64_tr_b16 v[26:27], v4 offset:59904
    ds_read_b64_tr_b16 v[28:29], v5 offset:59392
    ds_read_b64_tr_b16 v[30:31], v5 offset:59904
    v_mfma_f32_32x32x16_bf16 v[48:63], v[40:43], v[92:95], v[48:63]
    s_add_u32 s56, s56, 1
    s_cmp_eq_u32 s56, 20
    s_cselect_b32 s56, 0, s56
    s_lshl_b32 s52, s56, 11
    buffer_load_dwordx4 v[80:83], v2, s[24:27], s52 offen offset:0 sc1
    v_mfma_f32_32x32x16_bf16 v[64:79], v[44:47], v[92:95], v[64:79]
    buffer_load_dwordx4 v[84:87], v2, s[24:27], s52 offen offset:512 sc1
    s_waitcnt vmcnt(16)
    s_waitcnt lgkmcnt(0)
    v_mfma_f32_32x32x16_bf16 v[48:63], v[16:19], v[96:99], v[48:63]
    ds_read_b64_tr_b16 v[32:33], v4 offset:61440
    ds_read_b64_tr_b16 v[34:35], v4 offset:61952
    ds_read_b64_tr_b16 v[36:37], v5 offset:61440
    ds_read_b64_tr_b16 v[38:39], v5 offset:61952
    v_mfma_f32_32x32x16_bf16 v[64:79], v[20:23], v[96:99], v[64:79]
    ds_read_b64_tr_b16 v[40:41], v4 offset:63488
    ds_read_b64_tr_b16 v[42:43], v4 offset:64000
    ds_read_b64_tr_b16 v[44:45], v5 offset:63488
    ds_read_b64_tr_b16 v[46:47], v5 offset:64000
    v_mfma_f32_32x32x16_bf16 v[48:63], v[24:27], v[100:103], v[48:63]
    v_mov_b32 v15, 12
    ds_write_b32 v13, v15
    buffer_load_dwordx4 v[88:91], v2, s[24:27], s52 offen offset:1024 sc1
    v_mfma_f32_32x32x16_bf16 v[64:79], v[28:31], v[100:103], v[64:79]
    buffer_load_dwordx4 v[92:95], v2, s[24:27], s52 offen offset:1536 sc1
    s_waitcnt vmcnt(16)
    s_waitcnt lgkmcnt(1)
    v_mfma_f32_32x32x16_bf16 v[48:63], v[32:35], v[104:107], v[48:63]
    v_add_u32 v4, 0x10000, v4
    v_add_u32 v5, 0x10000, v5
    ds_read_b64_tr_b16 v[16:17], v4 offset:0
    ds_read_b64_tr_b16 v[18:19], v4 offset:512
    v_mfma_f32_32x32x16_bf16 v[64:79], v[36:39], v[104:107], v[64:79]
    ds_read_b64_tr_b16 v[20:21], v5 offset:0
    ds_read_b64_tr_b16 v[22:23], v5 offset:512
    ds_read_b64_tr_b16 v[24:25], v4 offset:2048
    ds_read_b64_tr_b16 v[26:27], v4 offset:2560
    v_mfma_f32_32x32x16_bf16 v[48:63], v[40:43], v[108:111], v[48:63]
    ds_read_b64_tr_b16 v[28:29], v5 offset:2048
    ds_read_b64_tr_b16 v[30:31], v5 offset:2560
    s_add_u32 s56, s56, 1
    s_cmp_eq_u32 s56, 20
    s_cselect_b32 s56, 0, s56
    s_lshl_b32 s52, s56, 11
    buffer_load_dwordx4 v[96:99], v2, s[24:27], s52 offen offset:0 sc1
    v_mfma_f32_32x32x16_bf16 v[64:79], v[44:47], v[108:111], v[64:79]
    buffer_load_dwordx4 v[100:103], v2, s[24:27], s52 offen offset:512 sc1
    s_waitcnt vmcnt(16)
    s_waitcnt lgkmcnt(0)
    v_mfma_f32_32x32x16_bf16 v[48:63], v[16:19], v[112:115], v[48:63]
    ds_read_b64_tr_b16 v[32:33], v4 offset:4096
    ds_read_b64_tr_b16 v[34:35], v4 offset:4608
    ds_read_b64_tr_b16 v[36:37], v5 offset:4096
    ds_read_b64_tr_b16 v[38:39], v5 offset:4608
    v_mfma_f32_32x32x16_bf16 v[64:79], v[20:23], v[112:115], v[64:79]
    ds_read_b64_tr_b16 v[40:41], v4 offset:6144
    ds_read_b64_tr_b16 v[42:43], v4 offset:6656
    ds_read_b64_tr_b16 v[44:45], v5 offset:6144
    ds_read_b64_tr_b16 v[46:47], v5 offset:6656
    v_mfma_f32_32x32x16_bf16 v[48:63], v[24:27], v[116:119], v[48:63]
    buffer_load_dwordx4 v[104:107], v2, s[24:27], s52 offen offset:1024 sc1
    v_mfma_f32_32x32x16_bf16 v[64:79], v[28:31], v[116:119], v[64:79]
    buffer_load_dwordx4 v[108:111], v2, s[24:27], s52 offen offset:1536 sc1
    s_waitcnt vmcnt(16)
    s_waitcnt lgkmcnt(0)
    v_mfma_f32_32x32x16_bf16 v[48:63], v[32:35], v[120:123], v[48:63]
    ds_read_b64_tr_b16 v[16:17], v4 offset:8192
    ds_read_b64_tr_b16 v[18:19], v4 offset:8704
    ds_read_b64_tr_b16 v[20:21], v5 offset:8192
    ds_read_b64_tr_b16 v[22:23], v5 offset:8704
    v_mfma_f32_32x32x16_bf16 v[64:79], v[36:39], v[120:123], v[64:79]
    ds_read_b64_tr_b16 v[24:25], v4 offset:10240
    ds_read_b64_tr_b16 v[26:27], v4 offset:10752
    ds_read_b64_tr_b16 v[28:29], v5 offset:10240
    ds_read_b64_tr_b16 v[30:31], v5 offset:10752
    v_mfma_f32_32x32x16_bf16 v[48:63], v[40:43], v[124:127], v[48:63]
    s_add_u32 s56, s56, 1
    s_cmp_eq_u32 s56, 20
    s_cselect_b32 s56, 0, s56
    s_lshl_b32 s52, s56, 11
    buffer_load_dwordx4 v[112:115], v2, s[24:27], s52 offen offset:0 sc1
    v_mfma_f32_32x32x16_bf16 v[64:79], v[44:47], v[124:127], v[64:79]
    buffer_load_dwordx4 v[116:119], v2, s[24:27], s52 offen offset:512 sc1
    s_waitcnt vmcnt(16)
    s_waitcnt lgkmcnt(0)
    v_mfma_f32_32x32x16_bf16 v[48:63], v[16:19], v[128:131], v[48:63]
    ds_read_b64_tr_b16 v[32:33], v4 offset:12288
    ds_read_b64_tr_b16 v[34:35], v4 offset:12800
    ds_read_b64_tr_b16 v[36:37], v5 offset:12288
    ds_read_b64_tr_b16 v[38:39], v5 offset:12800
    v_mfma_f32_32x32x16_bf16 v[64:79], v[20:23], v[128:131], v[64:79]
    ds_read_b64_tr_b16 v[40:41], v4 offset:14336
    ds_read_b64_tr_b16 v[42:43], v4 offset:14848
    ds_read_b64_tr_b16 v[44:45], v5 offset:14336
    ds_read_b64_tr_b16 v[46:47], v5 offset:14848
    v_mfma_f32_32x32x16_bf16 v[48:63], v[24:27], v[132:135], v[48:63]
    buffer_load_dwordx4 v[120:123], v2, s[24:27], s52 offen offset:1024 sc1
    v_mfma_f32_32x32x16_bf16 v[64:79], v[28:31], v[132:135], v[64:79]
    buffer_load_dwordx4 v[124:127], v2, s[24:27], s52 offen offset:1536 sc1
    s_waitcnt vmcnt(16)
    s_waitcnt lgkmcnt(0)
    v_mfma_f32_32x32x16_bf16 v[48:63], v[32:35], v[136:139], v[48:63]
    ds_read_b64_tr_b16 v[16:17], v4 offset:16384
    ds_read_b64_tr_b16 v[18:19], v4 offset:16896
    ds_read_b64_tr_b16 v[20:21], v5 offset:16384
    ds_read_b64_tr_b16 v[22:23], v5 offset:16896
    v_mfma_f32_32x32x16_bf16 v[64:79], v[36:39], v[136:139], v[64:79]
    ds_read_b64_tr_b16 v[24:25], v4 offset:18432
    ds_read_b64_tr_b16 v[26:27], v4 offset:18944
    ds_read_b64_tr_b16 v[28:29], v5 offset:18432
    ds_read_b64_tr_b16 v[30:31], v5 offset:18944
    v_mfma_f32_32x32x16_bf16 v[48:63], v[40:43], v[140:143], v[48:63]
    s_add_u32 s56, s56, 1
    s_cmp_eq_u32 s56, 20
    s_cselect_b32 s56, 0, s56
    s_lshl_b32 s52, s56, 11
    buffer_load_dwordx4 v[128:131], v2, s[24:27], s52 offen offset:0 sc1
    v_mfma_f32_32x32x16_bf16 v[64:79], v[44:47], v[140:143], v[64:79]
    buffer_load_dwordx4 v[132:135], v2, s[24:27], s52 offen offset:512 sc1
    s_waitcnt vmcnt(16)
    s_waitcnt lgkmcnt(0)
    v_mfma_f32_32x32x16_bf16 v[48:63], v[16:19], v[144:147], v[48:63]
    ds_read_b64_tr_b16 v[32:33], v4 offset:20480
    ds_read_b64_tr_b16 v[34:35], v4 offset:20992
    ds_read_b64_tr_b16 v[36:37], v5 offset:20480
    ds_read_b64_tr_b16 v[38:39], v5 offset:20992
    v_mfma_f32_32x32x16_bf16 v[64:79], v[20:23], v[144:147], v[64:79]
    ds_read_b64_tr_b16 v[40:41], v4 offset:22528
    ds_read_b64_tr_b16 v[42:43], v4 offset:23040
    ds_read_b64_tr_b16 v[44:45], v5 offset:22528
    ds_read_b64_tr_b16 v[46:47], v5 offset:23040
    v_mfma_f32_32x32x16_bf16 v[48:63], v[24:27], v[148:151], v[48:63]
    buffer_load_dwordx4 v[136:139], v2, s[24:27], s52 offen offset:1024 sc1
    v_mfma_f32_32x32x16_bf16 v[64:79], v[28:31], v[148:151], v[64:79]
    buffer_load_dwordx4 v[140:143], v2, s[24:27], s52 offen offset:1536 sc1
    s_waitcnt vmcnt(16)
    s_waitcnt lgkmcnt(0)
    v_mfma_f32_32x32x16_bf16 v[48:63], v[32:35], v[152:155], v[48:63]
    ds_read_b64_tr_b16 v[16:17], v4 offset:24576
    ds_read_b64_tr_b16 v[18:19], v4 offset:25088
    ds_read_b64_tr_b16 v[20:21], v5 offset:24576
    ds_read_b64_tr_b16 v[22:23], v5 offset:25088
    v_mfma_f32_32x32x16_bf16 v[64:79], v[36:39], v[152:155], v[64:79]
    ds_read_b64_tr_b16 v[24:25], v4 offset:26624
    ds_read_b64_tr_b16 v[26:27], v4 offset:27136
    ds_read_b64_tr_b16 v[28:29], v5 offset:26624
    ds_read_b64_tr_b16 v[30:31], v5 offset:27136
    v_mfma_f32_32x32x16_bf16 v[48:63], v[40:43], v[156:159], v[48:63]
    s_add_u32 s56, s56, 1
    s_cmp_eq_u32 s56, 20
    s_cselect_b32 s56, 0, s56
    s_lshl_b32 s52, s56, 11
    buffer_load_dwordx4 v[144:147], v2, s[24:27], s52 offen offset:0 sc1
    v_mfma_f32_32x32x16_bf16 v[64:79], v[44:47], v[156:159], v[64:79]
    buffer_load_dwordx4 v[148:151], v2, s[24:27], s52 offen offset:512 sc1
    s_waitcnt vmcnt(16)
    s_waitcnt lgkmcnt(0)
    v_mfma_f32_32x32x16_bf16 v[48:63], v[16:19], v[80:83], v[48:63]
    ds_read_b64_tr_b16 v[32:33], v4 offset:28672
    ds_read_b64_tr_b16 v[34:35], v4 offset:29184
    ds_read_b64_tr_b16 v[36:37], v5 offset:28672
    ds_read_b64_tr_b16 v[38:39], v5 offset:29184
    v_mfma_f32_32x32x16_bf16 v[64:79], v[20:23], v[80:83], v[64:79]
    ds_read_b64_tr_b16 v[40:41], v4 offset:30720
    ds_read_b64_tr_b16 v[42:43], v4 offset:31232
    ds_read_b64_tr_b16 v[44:45], v5 offset:30720
    ds_read_b64_tr_b16 v[46:47], v5 offset:31232
    v_mfma_f32_32x32x16_bf16 v[48:63], v[24:27], v[84:87], v[48:63]
    v_mov_b32 v15, 16
    ds_write_b32 v13, v15
    buffer_load_dwordx4 v[152:155], v2, s[24:27], s52 offen offset:1024 sc1
    v_mfma_f32_32x32x16_bf16 v[64:79], v[28:31], v[84:87], v[64:79]
    buffer_load_dwordx4 v[156:159], v2, s[24:27], s52 offen offset:1536 sc1
    buffer_load_dword v11, v10, s[32:35], s62 offen offset:2048 sc1
    s_waitcnt vmcnt(17)
    s_waitcnt lgkmcnt(1)
    v_mfma_f32_32x32x16_bf16 v[48:63], v[32:35], v[88:91], v[48:63]
    ds_read_b64_tr_b16 v[16:17], v4 offset:32768
    ds_read_b64_tr_b16 v[18:19], v4 offset:33280
    ds_read_b64_tr_b16 v[20:21], v5 offset:32768
    ds_read_b64_tr_b16 v[22:23], v5 offset:33280
    v_mfma_f32_32x32x16_bf16 v[64:79], v[36:39], v[88:91], v[64:79]
    ds_read_b64_tr_b16 v[24:25], v4 offset:34816
    ds_read_b64_tr_b16 v[26:27], v4 offset:35328
    ds_read_b64_tr_b16 v[28:29], v5 offset:34816
    ds_read_b64_tr_b16 v[30:31], v5 offset:35328
    v_mfma_f32_32x32x16_bf16 v[48:63], v[40:43], v[92:95], v[48:63]
    s_and_b32 s56, s46, 3
    s_add_u32 s56, s56, 20
    s_lshl_b32 s52, s56, 11
    buffer_load_dwordx4 v[80:83], v2, s[24:27], s52 offen offset:0 sc1
    v_mfma_f32_32x32x16_bf16 v[64:79], v[44:47], v[92:95], v[64:79]
    buffer_load_dwordx4 v[84:87], v2, s[24:27], s52 offen offset:512 sc1
    s_waitcnt vmcnt(17)
    s_waitcnt lgkmcnt(0)
    v_mfma_f32_32x32x16_bf16 v[48:63], v[16:19], v[96:99], v[48:63]
    ds_read_b64_tr_b16 v[32:33], v4 offset:36864
    ds_read_b64_tr_b16 v[34:35], v4 offset:37376
    ds_read_b64_tr_b16 v[36:37], v5 offset:36864
    ds_read_b64_tr_b16 v[38:39], v5 offset:37376
    v_mfma_f32_32x32x16_bf16 v[64:79], v[20:23], v[96:99], v[64:79]
    ds_read_b64_tr_b16 v[40:41], v4 offset:38912
    ds_read_b64_tr_b16 v[42:43], v4 offset:39424
    ds_read_b64_tr_b16 v[44:45], v5 offset:38912
    ds_read_b64_tr_b16 v[46:47], v5 offset:39424
    v_mfma_f32_32x32x16_bf16 v[48:63], v[24:27], v[100:103], v[48:63]
    buffer_load_dwordx4 v[88:91], v2, s[24:27], s52 offen offset:1024 sc1
    v_mfma_f32_32x32x16_bf16 v[64:79], v[28:31], v[100:103], v[64:79]
    buffer_load_dwordx4 v[92:95], v2, s[24:27], s52 offen offset:1536 sc1
    s_waitcnt vmcnt(17)
    s_waitcnt lgkmcnt(0)
    v_mfma_f32_32x32x16_bf16 v[48:63], v[32:35], v[104:107], v[48:63]
    ds_read_b64_tr_b16 v[16:17], v4 offset:40960
    ds_read_b64_tr_b16 v[18:19], v4 offset:41472
    ds_read_b64_tr_b16 v[20:21], v5 offset:40960
    ds_read_b64_tr_b16 v[22:23], v5 offset:41472
    v_mfma_f32_32x32x16_bf16 v[64:79], v[36:39], v[104:107], v[64:79]
    ds_read_b64_tr_b16 v[24:25], v4 offset:43008
    ds_read_b64_tr_b16 v[26:27], v4 offset:43520
    ds_read_b64_tr_b16 v[28:29], v5 offset:43008
    ds_read_b64_tr_b16 v[30:31], v5 offset:43520
    v_mfma_f32_32x32x16_bf16 v[48:63], v[40:43], v[108:111], v[48:63]
    s_add_u32 s56, s56, 1
    s_cmp_eq_u32 s56, 24
    s_cselect_b32 s56, 20, s56
    s_lshl_b32 s52, s56, 11
    buffer_load_dwordx4 v[96:99], v2, s[24:27], s52 offen offset:0 sc1
    v_mfma_f32_32x32x16_bf16 v[64:79], v[44:47], v[108:111], v[64:79]
    buffer_load_dwordx4 v[100:103], v2, s[24:27], s52 offen offset:512 sc1
    s_waitcnt vmcnt(17)
    s_waitcnt lgkmcnt(0)
    v_mfma_f32_32x32x16_bf16 v[48:63], v[16:19], v[112:115], v[48:63]
    ds_read_b64_tr_b16 v[32:33], v4 offset:45056
    ds_read_b64_tr_b16 v[34:35], v4 offset:45568
    ds_read_b64_tr_b16 v[36:37], v5 offset:45056
    ds_read_b64_tr_b16 v[38:39], v5 offset:45568
    v_mfma_f32_32x32x16_bf16 v[64:79], v[20:23], v[112:115], v[64:79]
    ds_read_b64_tr_b16 v[40:41], v4 offset:47104
    ds_read_b64_tr_b16 v[42:43], v4 offset:47616
    ds_read_b64_tr_b16 v[44:45], v5 offset:47104
    ds_read_b64_tr_b16 v[46:47], v5 offset:47616
    v_mfma_f32_32x32x16_bf16 v[48:63], v[24:27], v[116:119], v[48:63]
    v_mov_b32 v15, 18
    ds_write_b32 v13, v15
    ds_read_b32 v160, v14 offset:20
    buffer_load_dwordx4 v[104:107], v2, s[24:27], s52 offen offset:1024 sc1
    v_mfma_f32_32x32x16_bf16 v[64:79], v[28:31], v[116:119], v[64:79]
    buffer_load_dwordx4 v[108:111], v2, s[24:27], s52 offen offset:1536 sc1
    s_waitcnt lgkmcnt(0)
    v_cmp_gt_u32 vcc, 1, v160
    s_mov_b32 s51, 0
    s_cmp_eq_u64 vcc, 0
    s_cbranch_scc1 P2_so_47
P2_sl_46:
    ds_read_b32 v160, v14 offset:20
    s_add_u32 s51, s51, 1
    s_waitcnt lgkmcnt(0)
    v_cmp_gt_u32 vcc, 1, v160
    s_cmp_ge_u32 s51, 0x1000000
    s_cbranch_scc1 P2_so_47
    s_cmp_eq_u64 vcc, 0
    s_cbranch_scc1 P2_so_47
    s_sleep 1
    s_branch P2_sl_46
P2_so_47:
    s_waitcnt vmcnt(17)
    v_mfma_f32_32x32x16_bf16 v[48:63], v[32:35], v[120:123], v[48:63]
    ds_read_b64_tr_b16 v[16:17], v4 offset:49152
    ds_read_b64_tr_b16 v[18:19], v4 offset:49664
    ds_read_b64_tr_b16 v[20:21], v5 offset:49152
    ds_read_b64_tr_b16 v[22:23], v5 offset:49664
    v_mfma_f32_32x32x16_bf16 v[64:79], v[36:39], v[120:123], v[64:79]
    ds_read_b64_tr_b16 v[24:25], v4 offset:51200
    ds_read_b64_tr_b16 v[26:27], v4 offset:51712
    ds_read_b64_tr_b16 v[28:29], v5 offset:51200
    ds_read_b64_tr_b16 v[30:31], v5 offset:51712
    v_mfma_f32_32x32x16_bf16 v[48:63], v[40:43], v[124:127], v[48:63]
    s_add_u32 s56, s56, 1
    s_cmp_eq_u32 s56, 24
    s_cselect_b32 s56, 20, s56
    s_lshl_b32 s52, s56, 11
    buffer_load_dwordx4 v[112:115], v2, s[24:27], s52 offen offset:0 sc1
    v_mfma_f32_32x32x16_bf16 v[64:79], v[44:47], v[124:127], v[64:79]
    buffer_load_dwordx4 v[116:119], v2, s[24:27], s52 offen offset:512 sc1
    s_waitcnt vmcnt(17)
    s_waitcnt lgkmcnt(0)
    v_mfma_f32_32x32x16_bf16 v[48:63], v[16:19], v[128:131], v[48:63]
    ds_read_b64_tr_b16 v[32:33], v4 offset:53248
    ds_read_b64_tr_b16 v[34:35], v4 offset:53760
    ds_read_b64_tr_b16 v[36:37], v5 offset:53248
    ds_read_b64_tr_b16 v[38:39], v5 offset:53760
    v_mfma_f32_32x32x16_bf16 v[64:79], v[20:23], v[128:131], v[64:79]
    ds_read_b64_tr_b16 v[40:41], v4 offset:55296
    ds_read_b64_tr_b16 v[42:43], v4 offset:55808
    ds_read_b64_tr_b16 v[44:45], v5 offset:55296
    ds_read_b64_tr_b16 v[46:47], v5 offset:55808
    v_mfma_f32_32x32x16_bf16 v[48:63], v[24:27], v[132:135], v[48:63]
    buffer_load_dwordx4 v[120:123], v2, s[24:27], s52 offen offset:1024 sc1
    v_mfma_f32_32x32x16_bf16 v[64:79], v[28:31], v[132:135], v[64:79]
    buffer_load_dwordx4 v[124:127], v2, s[24:27], s52 offen offset:1536 sc1
    s_waitcnt vmcnt(17)
    s_waitcnt lgkmcnt(0)
    v_mfma_f32_32x32x16_bf16 v[48:63], v[32:35], v[136:139], v[48:63]
    ds_read_b64_tr_b16 v[16:17], v4 offset:57344
    ds_read_b64_tr_b16 v[18:19], v4 offset:57856
    ds_read_b64_tr_b16 v[20:21], v5 offset:57344
    ds_read_b64_tr_b16 v[22:23], v5 offset:57856
    v_mfma_f32_32x32x16_bf16 v[64:79], v[36:39], v[136:139], v[64:79]
    ds_read_b64_tr_b16 v[24:25], v4 offset:59392
    ds_read_b64_tr_b16 v[26:27], v4 offset:59904
    ds_read_b64_tr_b16 v[28:29], v5 offset:59392
    ds_read_b64_tr_b16 v[30:31], v5 offset:59904
    v_mfma_f32_32x32x16_bf16 v[48:63], v[40:43], v[140:143], v[48:63]
    s_add_u32 s56, s56, 1
    s_cmp_eq_u32 s56, 24
    s_cselect_b32 s56, 20, s56
    s_lshl_b32 s52, s56, 11
    buffer_load_dwordx4 v[128:131], v2, s[24:27], s52 offen offset:0 sc1
    v_mfma_f32_32x32x16_bf16 v[64:79], v[44:47], v[140:143], v[64:79]
    buffer_load_dwordx4 v[132:135], v2, s[24:27], s52 offen offset:512 sc1
    s_waitcnt vmcnt(17)
    s_waitcnt lgkmcnt(0)
    v_mfma_f32_32x32x16_bf16 v[48:63], v[16:19], v[144:147], v[48:63]
    ds_read_b64_tr_b16 v[32:33], v4 offset:61440
    ds_read_b64_tr_b16 v[34:35], v4 offset:61952
    ds_read_b64_tr_b16 v[36:37], v5 offset:61440
    ds_read_b64_tr_b16 v[38:39], v5 offset:61952
    v_mfma_f32_32x32x16_bf16 v[64:79], v[20:23], v[144:147], v[64:79]
    ds_read_b64_tr_b16 v[40:41], v4 offset:63488
    ds_read_b64_tr_b16 v[42:43], v4 offset:64000
    ds_read_b64_tr_b16 v[44:45], v5 offset:63488
    ds_read_b64_tr_b16 v[46:47], v5 offset:64000
    v_mfma_f32_32x32x16_bf16 v[48:63], v[24:27], v[148:151], v[48:63]
    buffer_load_dwordx4 v[136:139], v2, s[24:27], s52 offen offset:1024 sc1
    v_mfma_f32_32x32x16_bf16 v[64:79], v[28:31], v[148:151], v[64:79]
    buffer_load_dwordx4 v[140:143], v2, s[24:27], s52 offen offset:1536 sc1
    s_mov_b32 s51, 0
    s_waitcnt vmcnt(16)
P2_dl_49:
    v_cmp_ne_u32 vcc, 1, v11
    s_add_u32 s51, s51, 1
    s_cmp_eq_u64 vcc, 0
    s_cbranch_scc1 P2_dk_48
    s_cmp_ge_u32 s51, 65536
    s_cbranch_scc1 P2_dk_48
    s_sleep 2
    buffer_load_dword v11, v10, s[32:35], s62 offen offset:2048 sc1
    s_waitcnt vmcnt(0)
    s_branch P2_dl_49
P2_dk_48:
    s_waitcnt vmcnt(17)
    s_waitcnt lgkmcnt(0)
    v_mfma_f32_32x32x16_bf16 v[48:63], v[32:35], v[152:155], v[48:63]
    v_add_u32 v4, 0xffff0000, v4
    v_add_u32 v5, 0xffff0000, v5
    ds_read_b64_tr_b16 v[16:17], v4 offset:0
    ds_read_b64_tr_b16 v[18:19], v4 offset:512
    v_mfma_f32_32x32x16_bf16 v[64:79], v[36:39], v[152:155], v[64:79]
    ds_read_b64_tr_b16 v[20:21], v5 offset:0
    ds_read_b64_tr_b16 v[22:23], v5 offset:512
    ds_read_b64_tr_b16 v[24:25], v4 offset:2048
    ds_read_b64_tr_b16 v[26:27], v4 offset:2560
    v_mfma_f32_32x32x16_bf16 v[48:63], v[40:43], v[156:159], v[48:63]
    ds_read_b64_tr_b16 v[28:29], v5 offset:2048
    ds_read_b64_tr_b16 v[30:31], v5 offset:2560
    s_add_u32 s56, s46, 24
    s_lshl_b32 s52, s56, 11
    buffer_load_dwordx4 v[144:147], v2, s[24:27], s52 offen offset:0 sc1
    v_mfma_f32_32x32x16_bf16 v[64:79], v[44:47], v[156:159], v[64:79]
    buffer_load_dwordx4 v[148:151], v2, s[24:27], s52 offen offset:512 sc1
    s_waitcnt vmcnt(16)
    s_waitcnt lgkmcnt(0)
    v_mfma_f32_32x32x16_bf16 v[48:63], v[16:19], v[80:83], v[48:63]
    ds_read_b64_tr_b16 v[32:33], v4 offset:4096
    ds_read_b64_tr_b16 v[34:35], v4 offset:4608
    ds_read_b64_tr_b16 v[36:37], v5 offset:4096
    ds_read_b64_tr_b16 v[38:39], v5 offset:4608
    v_mfma_f32_32x32x16_bf16 v[64:79], v[20:23], v[80:83], v[64:79]
    ds_read_b64_tr_b16 v[40:41], v4 offset:6144
    ds_read_b64_tr_b16 v[42:43], v4 offset:6656
    ds_read_b64_tr_b16 v[44:45], v5 offset:6144
    ds_read_b64_tr_b16 v[46:47], v5 offset:6656
    v_mfma_f32_32x32x16_bf16 v[48:63], v[24:27], v[84:87], v[48:63]
    buffer_load_dwordx4 v[152:155], v2, s[24:27], s52 offen offset:1024 sc1
    v_mfma_f32_32x32x16_bf16 v[64:79], v[28:31], v[84:87], v[64:79]
    buffer_load_dwordx4 v[156:159], v2, s[24:27], s52 offen offset:1536 sc1
    s_waitcnt vmcnt(16)
    s_waitcnt lgkmcnt(0)
    v_mfma_f32_32x32x16_bf16 v[48:63], v[32:35], v[88:91], v[48:63]
    ds_read_b64_tr_b16 v[16:17], v4 offset:8192
    ds_read_b64_tr_b16 v[18:19], v4 offset:8704
    ds_read_b64_tr_b16 v[20:21], v5 offset:8192
    ds_read_b64_tr_b16 v[22:23], v5 offset:8704
    v_mfma_f32_32x32x16_bf16 v[64:79], v[36:39], v[88:91], v[64:79]
    ds_read_b64_tr_b16 v[24:25], v4 offset:10240
    ds_read_b64_tr_b16 v[26:27], v4 offset:10752
    ds_read_b64_tr_b16 v[28:29], v5 offset:10240
    ds_read_b64_tr_b16 v[30:31], v5 offset:10752
    v_mfma_f32_32x32x16_bf16 v[48:63], v[40:43], v[92:95], v[48:63]
    s_add_u32 s56, s56, 1
    s_cmp_eq_u32 s56, 34
    s_cselect_b32 s56, 24, s56
    s_lshl_b32 s52, s56, 11
    buffer_load_dwordx4 v[80:83], v2, s[24:27], s52 offen offset:0 sc1
    v_mfma_f32_32x32x16_bf16 v[64:79], v[44:47], v[92:95], v[64:79]
    buffer_load_dwordx4 v[84:87], v2, s[24:27], s52 offen offset:512 sc1
    s_waitcnt vmcnt(16)
    s_waitcnt lgkmcnt(0)
    v_mfma_f32_32x32x16_bf16 v[48:63], v[16:19], v[96:99], v[48:63]
    ds_read_b64_tr_b16 v[32:33], v4 offset:12288
    ds_read_b64_tr_b16 v[34:35], v4 offset:12800
    ds_read_b64_tr_b16 v[36:37], v5 offset:12288
    ds_read_b64_tr_b16 v[38:39], v5 offset:12800
    v_mfma_f32_32x32x16_bf16 v[64:79], v[20:23], v[96:99], v[64:79]
    ds_read_b64_tr_b16 v[40:41], v4 offset:14336
    ds_read_b64_tr_b16 v[42:43], v4 offset:14848
    ds_read_b64_tr_b16 v[44:45], v5 offset:14336
    ds_read_b64_tr_b16 v[46:47], v5 offset:14848
    v_mfma_f32_32x32x16_bf16 v[48:63], v[24:27], v[100:103], v[48:63]
    ds_read_b32 v160, v14 offset:20
    buffer_load_dwordx4 v[88:91], v2, s[24:27], s52 offen offset:1024 sc1
    v_mfma_f32_32x32x16_bf16 v[64:79], v[28:31], v[100:103], v[64:79]
    buffer_load_dwordx4 v[92:95], v2, s[24:27], s52 offen offset:1536 sc1
    s_waitcnt lgkmcnt(0)
    v_cmp_gt_u32 vcc, 2, v160
    s_mov_b32 s51, 0
    s_cmp_eq_u64 vcc, 0
    s_cbranch_scc1 P2_so_51
P2_sl_50:
    ds_read_b32 v160, v14 offset:20
    s_add_u32 s51, s51, 1
    s_waitcnt lgkmcnt(0)
    v_cmp_gt_u32 vcc, 2, v160
    s_cmp_ge_u32 s51, 0x1000000
    s_cbranch_scc1 P2_so_51
    s_cmp_eq_u64 vcc, 0
    s_cbranch_scc1 P2_so_51
    s_sleep 1
    s_branch P2_sl_50
P2_so_51:
    s_waitcnt vmcnt(16)
    v_mfma_f32_32x32x16_bf16 v[48:63], v[32:35], v[104:107], v[48:63]
    ds_read_b64_tr_b16 v[16:17], v4 offset:16384
    ds_read_b64_tr_b16 v[18:19], v4 offset:16896
    ds_read_b64_tr_b16 v[20:21], v5 offset:16384
    ds_read_b64_tr_b16 v[22:23], v5 offset:16896
    v_mfma_f32_32x32x16_bf16 v[64:79], v[36:39], v[104:107], v[64:79]
    ds_read_b64_tr_b16 v[24:25], v4 offset:18432
    ds_read_b64_tr_b16 v[26:27], v4 offset:18944
    ds_read_b64_tr_b16 v[28:29], v5 offset:18432
    ds_read_b64_tr_b16 v[30:31], v5 offset:18944
    v_mfma_f32_32x32x16_bf16 v[48:63], v[40:43], v[108:111], v[48:63]
    s_add_u32 s56, s56, 1
    s_cmp_eq_u32 s56, 34
    s_cselect_b32 s56, 24, s56
    s_lshl_b32 s52, s56, 11
    buffer_load_dwordx4 v[96:99], v2, s[24:27], s52 offen offset:0 sc1
    v_mfma_f32_32x32x16_bf16 v[64:79], v[44:47], v[108:111], v[64:79]
    buffer_load_dwordx4 v[100:103], v2, s[24:27], s52 offen offset:512 sc1
    s_waitcnt vmcnt(16)
    s_waitcnt lgkmcnt(0)
    v_mfma_f32_32x32x16_bf16 v[48:63], v[16:19], v[112:115], v[48:63]
    ds_read_b64_tr_b16 v[32:33], v4 offset:20480
    ds_read_b64_tr_b16 v[34:35], v4 offset:20992
    ds_read_b64_tr_b16 v[36:37], v5 offset:20480
    ds_read_b64_tr_b16 v[38:39], v5 offset:20992
    v_mfma_f32_32x32x16_bf16 v[64:79], v[20:23], v[112:115], v[64:79]
    ds_read_b64_tr_b16 v[40:41], v4 offset:22528
    ds_read_b64_tr_b16 v[42:43], v4 offset:23040
    ds_read_b64_tr_b16 v[44:45], v5 offset:22528
    ds_read_b64_tr_b16 v[46:47], v5 offset:23040
    v_mfma_f32_32x32x16_bf16 v[48:63], v[24:27], v[116:119], v[48:63]
    buffer_load_dwordx4 v[104:107], v2, s[24:27], s52 offen offset:1024 sc1
    v_mfma_f32_32x32x16_bf16 v[64:79], v[28:31], v[116:119], v[64:79]
    buffer_load_dwordx4 v[108:111], v2, s[24:27], s52 offen offset:1536 sc1
    s_waitcnt vmcnt(16)
    s_waitcnt lgkmcnt(0)
    v_mfma_f32_32x32x16_bf16 v[48:63], v[32:35], v[120:123], v[48:63]
    ds_read_b64_tr_b16 v[16:17], v4 offset:24576
    ds_read_b64_tr_b16 v[18:19], v4 offset:25088
    ds_read_b64_tr_b16 v[20:21], v5 offset:24576
    ds_read_b64_tr_b16 v[22:23], v5 offset:25088
    v_mfma_f32_32x32x16_bf16 v[64:79], v[36:39], v[120:123], v[64:79]
    ds_read_b64_tr_b16 v[24:25], v4 offset:26624
    ds_read_b64_tr_b16 v[26:27], v4 offset:27136
    ds_read_b64_tr_b16 v[28:29], v5 offset:26624
    ds_read_b64_tr_b16 v[30:31], v5 offset:27136
    v_mfma_f32_32x32x16_bf16 v[48:63], v[40:43], v[124:127], v[48:63]
    s_add_u32 s56, s56, 1
    s_cmp_eq_u32 s56, 34
    s_cselect_b32 s56, 24, s56
    s_lshl_b32 s52, s56, 11
    buffer_load_dwordx4 v[112:115], v2, s[24:27], s52 offen offset:0 sc1
    v_mfma_f32_32x32x16_bf16 v[64:79], v[44:47], v[124:127], v[64:79]
    buffer_load_dwordx4 v[116:119], v2, s[24:27], s52 offen offset:512 sc1
    s_waitcnt vmcnt(16)
    s_waitcnt lgkmcnt(0)
    v_mfma_f32_32x32x16_bf16 v[48:63], v[16:19], v[128:131], v[48:63]
    ds_read_b64_tr_b16 v[32:33], v4 offset:28672
    ds_read_b64_tr_b16 v[34:35], v4 offset:29184
    ds_read_b64_tr_b16 v[36:37], v5 offset:28672
    ds_read_b64_tr_b16 v[38:39], v5 offset:29184
    v_mfma_f32_32x32x16_bf16 v[64:79], v[20:23], v[128:131], v[64:79]
    ds_read_b64_tr_b16 v[40:41], v4 offset:30720
    ds_read_b64_tr_b16 v[42:43], v4 offset:31232
    ds_read_b64_tr_b16 v[44:45], v5 offset:30720
    ds_read_b64_tr_b16 v[46:47], v5 offset:31232
    v_mfma_f32_32x32x16_bf16 v[48:63], v[24:27], v[132:135], v[48:63]
    buffer_load_dwordx4 v[120:123], v2, s[24:27], s52 offen offset:1024 sc1
    v_mfma_f32_32x32x16_bf16 v[64:79], v[28:31], v[132:135], v[64:79]
    buffer_load_dwordx4 v[124:127], v2, s[24:27], s52 offen offset:1536 sc1
    s_waitcnt vmcnt(16)
    s_waitcnt lgkmcnt(0)
    v_mfma_f32_32x32x16_bf16 v[48:63], v[32:35], v[136:139], v[48:63]
    ds_read_b64_tr_b16 v[16:17], v4 offset:32768
    ds_read_b64_tr_b16 v[18:19], v4 offset:33280
    ds_read_b64_tr_b16 v[20:21], v5 offset:32768
    ds_read_b64_tr_b16 v[22:23], v5 offset:33280
    v_mfma_f32_32x32x16_bf16 v[64:79], v[36:39], v[136:139], v[64:79]
    ds_read_b64_tr_b16 v[24:25], v4 offset:34816
    ds_read_b64_tr_b16 v[26:27], v4 offset:35328
    ds_read_b64_tr_b16 v[28:29], v5 offset:34816
    ds_read_b64_tr_b16 v[30:31], v5 offset:35328
    v_mfma_f32_32x32x16_bf16 v[48:63], v[40:43], v[140:143], v[48:63]
    s_add_u32 s56, s56, 1
    s_cmp_eq_u32 s56, 34
    s_cselect_b32 s56, 24, s56
    s_lshl_b32 s52, s56, 11
    buffer_load_dwordx4 v[128:131], v2, s[24:27], s52 offen offset:0 sc1
    v_mfma_f32_32x32x16_bf16 v[64:79], v[44:47], v[140:143], v[64:79]
    buffer_load_dwordx4 v[132:135], v2, s[24:27], s52 offen offset:512 sc1
    s_waitcnt vmcnt(16)
    s_waitcnt lgkmcnt(0)
    v_mfma_f32_32x32x16_bf16 v[48:63], v[16:19], v[144:147], v[48:63]
    ds_read_b64_tr_b16 v[32:33], v4 offset:36864
    ds_read_b64_tr_b16 v[34:35], v4 offset:37376
    ds_read_b64_tr_b16 v[36:37], v5 offset:36864
    ds_read_b64_tr_b16 v[38:39], v5 offset:37376
    v_mfma_f32_32x32x16_bf16 v[64:79], v[20:23], v[144:147], v[64:79]
    ds_read_b64_tr_b16 v[40:41], v4 offset:38912
    ds_read_b64_tr_b16 v[42:43], v4 offset:39424
    ds_read_b64_tr_b16 v[44:45], v5 offset:38912
    ds_read_b64_tr_b16 v[46:47], v5 offset:39424
    v_mfma_f32_32x32x16_bf16 v[48:63], v[24:27], v[148:151], v[48:63]
    buffer_load_dwordx4 v[136:139], v2, s[24:27], s52 offen offset:1024 sc1
    v_mfma_f32_32x32x16_bf16 v[64:79], v[28:31], v[148:151], v[64:79]
    buffer_load_dwordx4 v[140:143], v2, s[24:27], s52 offen offset:1536 sc1
    s_waitcnt vmcnt(16)
    s_waitcnt lgkmcnt(0)
    v_mfma_f32_32x32x16_bf16 v[48:63], v[32:35], v[152:155], v[48:63]
    ds_read_b64_tr_b16 v[16:17], v4 offset:40960
    ds_read_b64_tr_b16 v[18:19], v4 offset:41472
    ds_read_b64_tr_b16 v[20:21], v5 offset:40960
    ds_read_b64_tr_b16 v[22:23], v5 offset:41472
    v_mfma_f32_32x32x16_bf16 v[64:79], v[36:39], v[152:155], v[64:79]
    ds_read_b64_tr_b16 v[24:25], v4 offset:43008
    ds_read_b64_tr_b16 v[26:27], v4 offset:43520
    ds_read_b64_tr_b16 v[28:29], v5 offset:43008
    ds_read_b64_tr_b16 v[30:31], v5 offset:43520
    v_mfma_f32_32x32x16_bf16 v[48:63], v[40:43], v[156:159], v[48:63]
    s_add_u32 s56, s56, 1
    s_cmp_eq_u32 s56, 34
    s_cselect_b32 s56, 24, s56
    s_lshl_b32 s52, s56, 11
    buffer_load_dwordx4 v[144:147], v2, s[24:27], s52 offen offset:0 sc1
    v_mfma_f32_32x32x16_bf16 v[64:79], v[44:47], v[156:159], v[64:79]
    buffer_load_dwordx4 v[148:151], v2, s[24:27], s52 offen offset:512 sc1
    s_waitcnt vmcnt(16)
    s_waitcnt lgkmcnt(0)
    v_mfma_f32_32x32x16_bf16 v[48:63], v[16:19], v[80:83], v[48:63]
    ds_read_b64_tr_b16 v[32:33], v4 offset:45056
    ds_read_b64_tr_b16 v[34:35], v4 offset:45568
    ds_read_b64_tr_b16 v[36:37], v5 offset:45056
    ds_read_b64_tr_b16 v[38:39], v5 offset:45568
    v_mfma_f32_32x32x16_bf16 v[64:79], v[20:23], v[80:83], v[64:79]
    ds_read_b64_tr_b16 v[40:41], v4 offset:47104
    ds_read_b64_tr_b16 v[42:43], v4 offset:47616
    ds_read_b64_tr_b16 v[44:45], v5 offset:47104
    ds_read_b64_tr_b16 v[46:47], v5 offset:47616
    v_mfma_f32_32x32x16_bf16 v[48:63], v[24:27], v[84:87], v[48:63]
    ds_read_b32 v160, v14 offset:20
    buffer_load_dwordx4 v[152:155], v2, s[24:27], s52 offen offset:1024 sc1
    v_mfma_f32_32x32x16_bf16 v[64:79], v[28:31], v[84:87], v[64:79]
    buffer_load_dwordx4 v[156:159], v2, s[24:27], s52 offen offset:1536 sc1
    s_waitcnt lgkmcnt(0)
    v_cmp_gt_u32 vcc, 3, v160
    s_mov_b32 s51, 0
    s_cmp_eq_u64 vcc, 0
    s_cbranch_scc1 P2_so_53
P2_sl_52:
    ds_read_b32 v160, v14 offset:20
    s_add_u32 s51, s51, 1
    s_waitcnt lgkmcnt(0)
    v_cmp_gt_u32 vcc, 3, v160
    s_cmp_ge_u32 s51, 0x1000000
    s_cbranch_scc1 P2_so_53
    s_cmp_eq_u64 vcc, 0
    s_cbranch_scc1 P2_so_53
    s_sleep 1
    s_branch P2_sl_52
P2_so_53:
    s_waitcnt vmcnt(16)
    v_mfma_f32_32x32x16_bf16 v[48:63], v[32:35], v[88:91], v[48:63]
    v_add_u32 v4, 0x20000, v4
    v_add_u32 v5, 0x20000, v5
    ds_read_b64_tr_b16 v[16:17], v4 offset:0
    ds_read_b64_tr_b16 v[18:19], v4 offset:512
    v_mfma_f32_32x32x16_bf16 v[64:79], v[36:39], v[88:91], v[64:79]
    ds_read_b64_tr_b16 v[20:21], v5 offset:0
    ds_read_b64_tr_b16 v[22:23], v5 offset:512
    ds_read_b64_tr_b16 v[24:25], v4 offset:2048
    ds_read_b64_tr_b16 v[26:27], v4 offset:2560
    v_mfma_f32_32x32x16_bf16 v[48:63], v[40:43], v[92:95], v[48:63]
    ds_read_b64_tr_b16 v[28:29], v5 offset:2048
    ds_read_b64_tr_b16 v[30:31], v5 offset:2560
    s_add_u32 s56, s56, 1
    s_cmp_eq_u32 s56, 34
    s_cselect_b32 s56, 24, s56
    s_lshl_b32 s52, s56, 11
    buffer_load_dwordx4 v[80:83], v2, s[24:27], s52 offen offset:0 sc1
    v_mfma_f32_32x32x16_bf16 v[64:79], v[44:47], v[92:95], v[64:79]
    buffer_load_dwordx4 v[84:87], v2, s[24:27], s52 offen offset:512 sc1
    s_waitcnt vmcnt(16)
    s_waitcnt lgkmcnt(0)
    v_mfma_f32_32x32x16_bf16 v[48:63], v[16:19], v[96:99], v[48:63]
    ds_read_b64_tr_b16 v[32:33], v4 offset:4096
    ds_read_b64_tr_b16 v[34:35], v4 offset:4608
    ds_read_b64_tr_b16 v[36:37], v5 offset:4096
    ds_read_b64_tr_b16 v[38:39], v5 offset:4608
    v_mfma_f32_32x32x16_bf16 v[64:79], v[20:23], v[96:99], v[64:79]
    ds_read_b64_tr_b16 v[40:41], v4 offset:6144
    ds_read_b64_tr_b16 v[42:43], v4 offset:6656
    ds_read_b64_tr_b16 v[44:45], v5 offset:6144
    ds_read_b64_tr_b16 v[46:47], v5 offset:6656
    v_mfma_f32_32x32x16_bf16 v[48:63], v[24:27], v[100:103], v[48:63]
    buffer_load_dwordx4 v[88:91], v2, s[24:27], s52 offen offset:1024 sc1
    v_mfma_f32_32x32x16_bf16 v[64:79], v[28:31], v[100:103], v[64:79]
    buffer_load_dwordx4 v[92:95], v2, s[24:27], s52 offen offset:1536 sc1
    s_waitcnt vmcnt(16)
    s_waitcnt lgkmcnt(0)
    v_mfma_f32_32x32x16_bf16 v[48:63], v[32:35], v[104:107], v[48:63]
    ds_read_b64_tr_b16 v[16:17], v4 offset:8192
    ds_read_b64_tr_b16 v[18:19], v4 offset:8704
    ds_read_b64_tr_b16 v[20:21], v5 offset:8192
    ds_read_b64_tr_b16 v[22:23], v5 offset:8704
    v_mfma_f32_32x32x16_bf16 v[64:79], v[36:39], v[104:107], v[64:79]
    ds_read_b64_tr_b16 v[24:25], v4 offset:10240
    ds_read_b64_tr_b16 v[26:27], v4 offset:10752
    ds_read_b64_tr_b16 v[28:29], v5 offset:10240
    ds_read_b64_tr_b16 v[30:31], v5 offset:10752
    v_mfma_f32_32x32x16_bf16 v[48:63], v[40:43], v[108:111], v[48:63]
    s_add_u32 s56, s56, 1
    s_cmp_eq_u32 s56, 34
    s_cselect_b32 s56, 24, s56
    s_lshl_b32 s52, s56, 11
    buffer_load_dwordx4 v[96:99], v2, s[24:27], s52 offen offset:0 sc1
    v_mfma_f32_32x32x16_bf16 v[64:79], v[44:47], v[108:111], v[64:79]
    buffer_load_dwordx4 v[100:103], v2, s[24:27], s52 offen offset:512 sc1
    s_waitcnt vmcnt(16)
    s_waitcnt lgkmcnt(0)
    v_mfma_f32_32x32x16_bf16 v[48:63], v[16:19], v[112:115], v[48:63]
    ds_read_b64_tr_b16 v[32:33], v4 offset:12288
    ds_read_b64_tr_b16 v[34:35], v4 offset:12800
    ds_read_b64_tr_b16 v[36:37], v5 offset:12288
    ds_read_b64_tr_b16 v[38:39], v5 offset:12800
    v_mfma_f32_32x32x16_bf16 v[64:79], v[20:23], v[112:115], v[64:79]
    ds_read_b64_tr_b16 v[40:41], v4 offset:14336
    ds_read_b64_tr_b16 v[42:43], v4 offset:14848
    ds_read_b64_tr_b16 v[44:45], v5 offset:14336
    ds_read_b64_tr_b16 v[46:47], v5 offset:14848
    v_mfma_f32_32x32x16_bf16 v[48:63], v[24:27], v[116:119], v[48:63]
    buffer_load_dwordx4 v[104:107], v2, s[24:27], s52 offen offset:1024 sc1
    v_mfma_f32_32x32x16_bf16 v[64:79], v[28:31], v[116:119], v[64:79]
    buffer_load_dwordx4 v[108:111], v2, s[24:27], s52 offen offset:1536 sc1
    s_waitcnt vmcnt(16)
    s_waitcnt lgkmcnt(0)
    v_mfma_f32_32x32x16_bf16 v[48:63], v[32:35], v[120:123], v[48:63]
    v_add_u32 v4, 0xfffe0000, v4
    v_add_u32 v5, 0xfffe0000, v5
    ds_read_b64_tr_b16 v[16:17], v4 offset:49152
    ds_read_b64_tr_b16 v[18:19], v4 offset:49664
    v_mfma_f32_32x32x16_bf16 v[64:79], v[36:39], v[120:123], v[64:79]
    ds_read_b64_tr_b16 v[20:21], v5 offset:49152
    ds_read_b64_tr_b16 v[22:23], v5 offset:49664
    ds_read_b64_tr_b16 v[24:25], v4 offset:51200
    ds_read_b64_tr_b16 v[26:27], v4 offset:51712
    v_mfma_f32_32x32x16_bf16 v[48:63], v[40:43], v[124:127], v[48:63]
    ds_read_b64_tr_b16 v[28:29], v5 offset:51200
    ds_read_b64_tr_b16 v[30:31], v5 offset:51712
    s_add_u32 s56, s56, 1
    s_cmp_eq_u32 s56, 34
    s_cselect_b32 s56, 24, s56
    s_lshl_b32 s52, s56, 11
    buffer_load_dwordx4 v[112:115], v2, s[24:27], s52 offen offset:0 sc1
    v_mfma_f32_32x32x16_bf16 v[64:79], v[44:47], v[124:127], v[64:79]
    buffer_load_dwordx4 v[116:119], v2, s[24:27], s52 offen offset:512 sc1
    s_waitcnt vmcnt(16)
    s_waitcnt lgkmcnt(0)
    v_mfma_f32_32x32x16_bf16 v[48:63], v[16:19], v[128:131], v[48:63]
    ds_read_b64_tr_b16 v[32:33], v4 offset:53248
    ds_read_b64_tr_b16 v[34:35], v4 offset:53760
    ds_read_b64_tr_b16 v[36:37], v5 offset:53248
    ds_read_b64_tr_b16 v[38:39], v5 offset:53760
    v_mfma_f32_32x32x16_bf16 v[64:79], v[20:23], v[128:131], v[64:79]
    ds_read_b64_tr_b16 v[40:41], v4 offset:55296
    ds_read_b64_tr_b16 v[42:43], v4 offset:55808
    ds_read_b64_tr_b16 v[44:45], v5 offset:55296
    ds_read_b64_tr_b16 v[46:47], v5 offset:55808
    v_mfma_f32_32x32x16_bf16 v[48:63], v[24:27], v[132:135], v[48:63]
    buffer_load_dwordx4 v[120:123], v2, s[24:27], s52 offen offset:1024 sc1
    v_mfma_f32_32x32x16_bf16 v[64:79], v[28:31], v[132:135], v[64:79]
    buffer_load_dwordx4 v[124:127], v2, s[24:27], s52 offen offset:1536 sc1
    s_waitcnt vmcnt(16)
    s_waitcnt lgkmcnt(0)
    v_mfma_f32_32x32x16_bf16 v[48:63], v[32:35], v[136:139], v[48:63]
    ds_read_b64_tr_b16 v[16:17], v4 offset:57344
    ds_read_b64_tr_b16 v[18:19], v4 offset:57856
    ds_read_b64_tr_b16 v[20:21], v5 offset:57344
    ds_read_b64_tr_b16 v[22:23], v5 offset:57856
    v_mfma_f32_32x32x16_bf16 v[64:79], v[36:39], v[136:139], v[64:79]
    ds_read_b64_tr_b16 v[24:25], v4 offset:59392
    ds_read_b64_tr_b16 v[26:27], v4 offset:59904
    ds_read_b64_tr_b16 v[28:29], v5 offset:59392
    ds_read_b64_tr_b16 v[30:31], v5 offset:59904
    v_mfma_f32_32x32x16_bf16 v[48:63], v[40:43], v[140:143], v[48:63]
    s_add_u32 s56, s56, 1
    s_cmp_eq_u32 s56, 34
    s_cselect_b32 s56, 24, s56
    s_lshl_b32 s52, s56, 11
    buffer_load_dwordx4 v[128:131], v2, s[24:27], s52 offen offset:0 sc1
    v_mfma_f32_32x32x16_bf16 v[64:79], v[44:47], v[140:143], v[64:79]
    buffer_load_dwordx4 v[132:135], v2, s[24:27], s52 offen offset:512 sc1
    s_waitcnt vmcnt(16)
    s_waitcnt lgkmcnt(0)
    v_mfma_f32_32x32x16_bf16 v[48:63], v[16:19], v[144:147], v[48:63]
    ds_read_b64_tr_b16 v[32:33], v4 offset:61440
    ds_read_b64_tr_b16 v[34:35], v4 offset:61952
    ds_read_b64_tr_b16 v[36:37], v5 offset:61440
    ds_read_b64_tr_b16 v[38:39], v5 offset:61952
    v_mfma_f32_32x32x16_bf16 v[64:79], v[20:23], v[144:147], v[64:79]
    ds_read_b64_tr_b16 v[40:41], v4 offset:63488
    ds_read_b64_tr_b16 v[42:43], v4 offset:64000
    ds_read_b64_tr_b16 v[44:45], v5 offset:63488
    ds_read_b64_tr_b16 v[46:47], v5 offset:64000
    v_mfma_f32_32x32x16_bf16 v[48:63], v[24:27], v[148:151], v[48:63]
    ds_read_b32 v160, v14 offset:20
    buffer_load_dwordx4 v[136:139], v2, s[24:27], s52 offen offset:1024 sc1
    v_mfma_f32_32x32x16_bf16 v[64:79], v[28:31], v[148:151], v[64:79]
    buffer_load_dwordx4 v[140:143], v2, s[24:27], s52 offen offset:1536 sc1
    s_waitcnt lgkmcnt(0)
    v_cmp_gt_u32 vcc, 4, v160
    s_mov_b32 s51, 0
    s_cmp_eq_u64 vcc, 0
    s_cbranch_scc1 P2_so_55
P2_sl_54:
    ds_read_b32 v160, v14 offset:20
    s_add_u32 s51, s51, 1
    s_waitcnt lgkmcnt(0)
    v_cmp_gt_u32 vcc, 4, v160
    s_cmp_ge_u32 s51, 0x1000000
    s_cbranch_scc1 P2_so_55
    s_cmp_eq_u64 vcc, 0
    s_cbranch_scc1 P2_so_55
    s_sleep 1
    s_branch P2_sl_54
P2_so_55:
    s_waitcnt vmcnt(16)
    v_mfma_f32_32x32x16_bf16 v[48:63], v[32:35], v[152:155], v[48:63]
    v_add_u32 v4, 0x10000, v4
    v_add_u32 v5, 0x10000, v5
    ds_read_b64_tr_b16 v[16:17], v4 offset:0
    ds_read_b64_tr_b16 v[18:19], v4 offset:512
    v_mfma_f32_32x32x16_bf16 v[64:79], v[36:39], v[152:155], v[64:79]
    ds_read_b64_tr_b16 v[20:21], v5 offset:0
    ds_read_b64_tr_b16 v[22:23], v5 offset:512
    ds_read_b64_tr_b16 v[24:25], v4 offset:2048
    ds_read_b64_tr_b16 v[26:27], v4 offset:2560
    v_mfma_f32_32x32x16_bf16 v[48:63], v[40:43], v[156:159], v[48:63]
    ds_read_b64_tr_b16 v[28:29], v5 offset:2048
    ds_read_b64_tr_b16 v[30:31], v5 offset:2560
    v_mfma_f32_32x32x16_bf16 v[64:79], v[44:47], v[156:159], v[64:79]
    s_waitcnt vmcnt(14)
    s_waitcnt lgkmcnt(0)
    v_mfma_f32_32x32x16_bf16 v[48:63], v[16:19], v[80:83], v[48:63]
    ds_read_b64_tr_b16 v[32:33], v4 offset:4096
    ds_read_b64_tr_b16 v[34:35], v4 offset:4608
    ds_read_b64_tr_b16 v[36:37], v5 offset:4096
    ds_read_b64_tr_b16 v[38:39], v5 offset:4608
    v_mfma_f32_32x32x16_bf16 v[64:79], v[20:23], v[80:83], v[64:79]
    ds_read_b64_tr_b16 v[40:41], v4 offset:6144
    ds_read_b64_tr_b16 v[42:43], v4 offset:6656
    ds_read_b64_tr_b16 v[44:45], v5 offset:6144
    ds_read_b64_tr_b16 v[46:47], v5 offset:6656
    v_mfma_f32_32x32x16_bf16 v[48:63], v[24:27], v[84:87], v[48:63]
    v_mfma_f32_32x32x16_bf16 v[64:79], v[28:31], v[84:87], v[64:79]
    s_waitcnt vmcnt(12)
    s_waitcnt lgkmcnt(0)
    v_mfma_f32_32x32x16_bf16 v[48:63], v[32:35], v[88:91], v[48:63]
    ds_read_b64_tr_b16 v[16:17], v4 offset:8192
    ds_read_b64_tr_b16 v[18:19], v4 offset:8704
    ds_read_b64_tr_b16 v[20:21], v5 offset:8192
    ds_read_b64_tr_b16 v[22:23], v5 offset:8704
    v_mfma_f32_32x32x16_bf16 v[64:79], v[36:39], v[88:91], v[64:79]
    ds_read_b64_tr_b16 v[24:25], v4 offset:10240
    ds_read_b64_tr_b16 v[26:27], v4 offset:10752
    ds_read_b64_tr_b16 v[28:29], v5 offset:10240
    ds_read_b64_tr_b16 v[30:31], v5 offset:10752
    v_mfma_f32_32x32x16_bf16 v[48:63], v[40:43], v[92:95], v[48:63]
    v_mfma_f32_32x32x16_bf16 v[64:79], v[44:47], v[92:95], v[64:79]
    s_waitcnt vmcnt(10)
    s_waitcnt lgkmcnt(0)
    v_mfma_f32_32x32x16_bf16 v[48:63], v[16:19], v[96:99], v[48:63]
    ds_read_b64_tr_b16 v[32:33], v4 offset:12288
    ds_read_b64_tr_b16 v[34:35], v4 offset:12800
    ds_read_b64_tr_b16 v[36:37], v5 offset:12288
    ds_read_b64_tr_b16 v[38:39], v5 offset:12800
    v_mfma_f32_32x32x16_bf16 v[64:79], v[20:23], v[96:99], v[64:79]
    ds_read_b64_tr_b16 v[40:41], v4 offset:14336
    ds_read_b64_tr_b16 v[42:43], v4 offset:14848
    ds_read_b64_tr_b16 v[44:45], v5 offset:14336
    ds_read_b64_tr_b16 v[46:47], v5 offset:14848
    v_mfma_f32_32x32x16_bf16 v[48:63], v[24:27], v[100:103], v[48:63]
    v_mfma_f32_32x32x16_bf16 v[64:79], v[28:31], v[100:103], v[64:79]
    s_waitcnt vmcnt(8)
    s_waitcnt lgkmcnt(0)
    v_mfma_f32_32x32x16_bf16 v[48:63], v[32:35], v[104:107], v[48:63]
    ds_read_b64_tr_b16 v[16:17], v4 offset:16384
    ds_read_b64_tr_b16 v[18:19], v4 offset:16896
    ds_read_b64_tr_b16 v[20:21], v5 offset:16384
    ds_read_b64_tr_b16 v[22:23], v5 offset:16896
    v_mfma_f32_32x32x16_bf16 v[64:79], v[36:39], v[104:107], v[64:79]
    ds_read_b64_tr_b16 v[24:25], v4 offset:18432
    ds_read_b64_tr_b16 v[26:27], v4 offset:18944
    ds_read_b64_tr_b16 v[28:29], v5 offset:18432
    ds_read_b64_tr_b16 v[30:31], v5 offset:18944
    v_mfma_f32_32x32x16_bf16 v[48:63], v[40:43], v[108:111], v[48:63]
    v_mfma_f32_32x32x16_bf16 v[64:79], v[44:47], v[108:111], v[64:79]
    s_waitcnt vmcnt(6)
    s_waitcnt lgkmcnt(0)
    v_mfma_f32_32x32x16_bf16 v[48:63], v[16:19], v[112:115], v[48:63]
    ds_read_b64_tr_b16 v[32:33], v4 offset:20480
    ds_read_b64_tr_b16 v[34:35], v4 offset:20992
    ds_read_b64_tr_b16 v[36:37], v5 offset:20480
    ds_read_b64_tr_b16 v[38:39], v5 offset:20992
    v_mfma_f32_32x32x16_bf16 v[64:79], v[20:23], v[112:115], v[64:79]
    ds_read_b64_tr_b16 v[40:41], v4 offset:22528
    ds_read_b64_tr_b16 v[42:43], v4 offset:23040
    ds_read_b64_tr_b16 v[44:45], v5 offset:22528
    ds_read_b64_tr_b16 v[46:47], v5 offset:23040
    v_mfma_f32_32x32x16_bf16 v[48:63], v[24:27], v[116:119], v[48:63]
    v_mfma_f32_32x32x16_bf16 v[64:79], v[28:31], v[116:119], v[64:79]
    s_waitcnt vmcnt(4)
    s_waitcnt lgkmcnt(0)
    v_mfma_f32_32x32x16_bf16 v[48:63], v[32:35], v[120:123], v[48:63]
    ds_read_b64_tr_b16 v[16:17], v4 offset:24576
    ds_read_b64_tr_b16 v[18:19], v4 offset:25088
    ds_read_b64_tr_b16 v[20:21], v5 offset:24576
    ds_read_b64_tr_b16 v[22:23], v5 offset:25088
    v_mfma_f32_32x32x16_bf16 v[64:79], v[36:39], v[120:123], v[64:79]
    ds_read_b64_tr_b16 v[24:25], v4 offset:26624
    ds_read_b64_tr_b16 v[26:27], v4 offset:27136
    ds_read_b64_tr_b16 v[28:29], v5 offset:26624
    ds_read_b64_tr_b16 v[30:31], v5 offset:27136
    v_mfma_f32_32x32x16_bf16 v[48:63], v[40:43], v[124:127], v[48:63]
    v_mfma_f32_32x32x16_bf16 v[64:79], v[44:47], v[124:127], v[64:79]
    s_waitcnt vmcnt(2)
    s_waitcnt lgkmcnt(0)
    v_mfma_f32_32x32x16_bf16 v[48:63], v[16:19], v[128:131], v[48:63]
    ds_read_b64_tr_b16 v[32:33], v4 offset:28672
    ds_read_b64_tr_b16 v[34:35], v4 offset:29184
    ds_read_b64_tr_b16 v[36:37], v5 offset:28672
    ds_read_b64_tr_b16 v[38:39], v5 offset:29184
    v_mfma_f32_32x32x16_bf16 v[64:79], v[20:23], v[128:131], v[64:79]
    ds_read_b64_tr_b16 v[40:41], v4 offset:30720
    ds_read_b64_tr_b16 v[42:43], v4 offset:31232
    ds_read_b64_tr_b16 v[44:45], v5 offset:30720
    ds_read_b64_tr_b16 v[46:47], v5 offset:31232
    v_mfma_f32_32x32x16_bf16 v[48:63], v[24:27], v[132:135], v[48:63]
    ds_read_b32 v160, v14 offset:20
    v_mfma_f32_32x32x16_bf16 v[64:79], v[28:31], v[132:135], v[64:79]
    s_waitcnt lgkmcnt(0)
    v_cmp_gt_u32 vcc, 5, v160
    s_mov_b32 s51, 0
    s_cmp_eq_u64 vcc, 0
    s_cbranch_scc1 P2_so_57
P2_sl_56:
    ds_read_b32 v160, v14 offset:20
    s_add_u32 s51, s51, 1
    s_waitcnt lgkmcnt(0)
    v_cmp_gt_u32 vcc, 5, v160
    s_cmp_ge_u32 s51, 0x1000000
    s_cbranch_scc1 P2_so_57
    s_cmp_eq_u64 vcc, 0
    s_cbranch_scc1 P2_so_57
    s_sleep 1
    s_branch P2_sl_56
P2_so_57:
    s_waitcnt vmcnt(0)
    v_mfma_f32_32x32x16_bf16 v[48:63], v[32:35], v[136:139], v[48:63]
    v_mfma_f32_32x32x16_bf16 v[64:79], v[36:39], v[136:139], v[64:79]
    v_mfma_f32_32x32x16_bf16 v[48:63], v[40:43], v[140:143], v[48:63]
    v_mfma_f32_32x32x16_bf16 v[64:79], v[44:47], v[140:143], v[64:79]
    v_and_b32 v9, 31, v1
    v_and_b32 v2, 7, v1
    v_lshlrev_b32 v12, 1, v3
    v_xor_b32 v2, v2, v12
    v_lshlrev_b32 v2, 4, v2
    v_lshl_add_u32 v2, v9, 7, v2
    s_lshl_b32 s50, s48, 12
    s_add_u32 s50, s50, 98304
    v_add_u32 v4, s50, v2
    v_xor_b32 v5, 16, v4
    v_xor_b32 v6, 64, v4
    v_xor_b32 v7, 80, v4
    ds_read_b128 v[80:83], v4
    ds_read_b128 v[84:87], v5
    ds_read_b128 v[88:91], v6
    ds_read_b128 v[92:95], v7
    v_lshrrev_b32 v9, 3, v1
    v_and_b32 v12, 7, v1
    v_xor_b32 v12, v12, v9
    s_movk_i32 s51, 1280
    v_mul_u32_u24 v3, s51, v9
    v_lshl_add_u32 v3, v12, 4, v3
    v_lshlrev_b32 v8, 4, v1
    v_add_u32 v8, s50, v8
    s_mul_i32 s53, s60, 20480
    s_lshl_b32 s51, s46, 7
    s_add_u32 s53, s53, s51
    s_mov_b32 s28, s18
    s_mov_b32 s29, s19
    s_mov_b32 s30, 2621440
    s_mov_b32 s50, 0xffff0000
    s_waitcnt lgkmcnt(3)
    v_lshlrev_b32 v100, 16, v80
    v_and_b32 v101, s50, v80
    v_lshlrev_b32 v102, 16, v81
    v_and_b32 v103, s50, v81
    v_lshlrev_b32 v104, 16, v82
    v_and_b32 v105, s50, v82
    v_lshlrev_b32 v106, 16, v83
    v_and_b32 v107, s50, v83
    v_pk_add_f32 v[48:49], v[48:49], v[100:101]
    v_pk_add_f32 v[50:51], v[50:51], v[102:103]
    v_pk_add_f32 v[52:53], v[52:53], v[104:105]
    v_pk_add_f32 v[54:55], v[54:55], v[106:107]
    v_cvt_pk_bf16_f32 v80, v48, v49
    v_cvt_pk_bf16_f32 v81, v50, v51
    v_cvt_pk_bf16_f32 v82, v52, v53
    v_cvt_pk_bf16_f32 v83, v54, v55
    ds_write_b128 v4, v[80:83]
    s_waitcnt lgkmcnt(3)
    v_lshlrev_b32 v100, 16, v84
    v_and_b32 v101, s50, v84
    v_lshlrev_b32 v102, 16, v85
    v_and_b32 v103, s50, v85
    v_lshlrev_b32 v104, 16, v86
    v_and_b32 v105, s50, v86
    v_lshlrev_b32 v106, 16, v87
    v_and_b32 v107, s50, v87
    v_pk_add_f32 v[56:57], v[56:57], v[100:101]
    v_pk_add_f32 v[58:59], v[58:59], v[102:103]
    v_pk_add_f32 v[60:61], v[60:61], v[104:105]
    v_pk_add_f32 v[62:63], v[62:63], v[106:107]
    v_cvt_pk_bf16_f32 v84, v56, v57
    v_cvt_pk_bf16_f32 v85, v58, v59
    v_cvt_pk_bf16_f32 v86, v60, v61
    v_cvt_pk_bf16_f32 v87, v62, v63
    ds_write_b128 v5, v[84:87]
    s_waitcnt lgkmcnt(3)
    v_lshlrev_b32 v100, 16, v88
    v_and_b32 v101, s50, v88
    v_lshlrev_b32 v102, 16, v89
    v_and_b32 v103, s50, v89
    v_lshlrev_b32 v104, 16, v90
    v_and_b32 v105, s50, v90
    v_lshlrev_b32 v106, 16, v91
    v_and_b32 v107, s50, v91
    v_pk_add_f32 v[64:65], v[64:65], v[100:101]
    v_pk_add_f32 v[66:67], v[66:67], v[102:103]
    v_pk_add_f32 v[68:69], v[68:69], v[104:105]
    v_pk_add_f32 v[70:71], v[70:71], v[106:107]
    v_cvt_pk_bf16_f32 v88, v64, v65
    v_cvt_pk_bf16_f32 v89, v66, v67
    v_cvt_pk_bf16_f32 v90, v68, v69
    v_cvt_pk_bf16_f32 v91, v70, v71
    ds_write_b128 v6, v[88:91]
    s_waitcnt lgkmcnt(3)
    v_lshlrev_b32 v100, 16, v92
    v_and_b32 v101, s50, v92
    v_lshlrev_b32 v102, 16, v93
    v_and_b32 v103, s50, v93
    v_lshlrev_b32 v104, 16, v94
    v_and_b32 v105, s50, v94
    v_lshlrev_b32 v106, 16, v95
    v_and_b32 v107, s50, v95
    v_pk_add_f32 v[72:73], v[72:73], v[100:101]
    v_pk_add_f32 v[74:75], v[74:75], v[102:103]
    v_pk_add_f32 v[76:77], v[76:77], v[104:105]
    v_pk_add_f32 v[78:79], v[78:79], v[106:107]
    v_cvt_pk_bf16_f32 v92, v72, v73
    v_cvt_pk_bf16_f32 v93, v74, v75
    v_cvt_pk_bf16_f32 v94, v76, v77
    v_cvt_pk_bf16_f32 v95, v78, v79
    ds_write_b128 v7, v[92:95]
    ds_read_b128 v[112:115], v8 offset:0
    ds_read_b128 v[116:119], v8 offset:1024
    ds_read_b128 v[120:123], v8 offset:2048
    ds_read_b128 v[124:127], v8 offset:3072
    s_waitcnt lgkmcnt(3)
    buffer_store_dwordx4 v[112:115], v3, s[28:31], s53 offen
    s_add_u32 s53, s53, 10240
    s_waitcnt lgkmcnt(2)
    buffer_store_dwordx4 v[116:119], v3, s[28:31], s53 offen
    s_add_u32 s53, s53, 10240
    s_waitcnt lgkmcnt(1)
    buffer_store_dwordx4 v[120:123], v3, s[28:31], s53 offen
    s_add_u32 s53, s53, 10240
    s_waitcnt lgkmcnt(0)
    buffer_store_dwordx4 v[124:127], v3, s[28:31], s53 offen
    s_branch P2_exit
P2_idle:
    v_mov_b32 v16, 99
    s_waitcnt vmcnt(0)
    s_mov_b64 exec, 1
    ds_write_b32 v14, v16 offset:8
    ds_add_u32 v14, v15 offset:16
    s_mov_b64 exec, -1
    s_waitcnt lgkmcnt(0)
    s_branch P2_exit
P2_ws:
    v_subrev_u32 v5, 61440, v5
    v_subrev_u32 v6, 61440, v6
    v_min_u32 v16, 2, v1
    v_lshl_add_u32 v16, v16, 2, v14
    s_waitcnt vmcnt(0)
    s_mov_b64 exec, 1
    ds_add_u32 v14, v15 offset:16
    s_mov_b64 exec, -1
    s_mov_b32 s51, 0
P2_sl_58:
    ds_read_b32 v17, v16 offset:0
    s_add_u32 s51, s51, 1
    s_waitcnt lgkmcnt(0)
    v_cmp_gt_u32 vcc, 4, v17
    s_cmp_ge_u32 s51, 0x1000000
    s_cbranch_scc1 P2_so_59
    s_cmp_eq_u64 vcc, 0
    s_cbranch_scc1 P2_so_59
    s_sleep 4
    s_branch P2_sl_58
P2_so_59:
    s_add_u32 s57, s57, 1
    s_cmp_eq_u32 s57, 20
    s_cselect_b32 s57, 0, s57
    s_mul_i32 s53, s57, 81920
    s_mov_b32 m0, 114688
    s_nop 0
    buffer_load_dwordx4 v5, s[28:31], s53 offen lds
    buffer_load_dwordx4 v6, s[28:31], s53 offen offset:1024 lds
    s_mov_b32 m0, 116736
    s_add_u32 s53, s53, 20480
    buffer_load_dwordx4 v5, s[28:31], s53 offen lds
    buffer_load_dwordx4 v6, s[28:31], s53 offen offset:1024 lds
    s_mov_b32 m0, 118784
    s_add_u32 s53, s53, 20480
    buffer_load_dwordx4 v5, s[28:31], s53 offen lds
    buffer_load_dwordx4 v6, s[28:31], s53 offen offset:1024 lds
    s_mov_b32 m0, 120832
    s_add_u32 s53, s53, 20480
    buffer_load_dwordx4 v5, s[28:31], s53 offen lds
    buffer_load_dwordx4 v6, s[28:31], s53 offen offset:1024 lds
    s_add_u32 s57, s57, 1
    s_cmp_eq_u32 s57, 20
    s_cselect_b32 s57, 0, s57
    s_mul_i32 s53, s57, 81920
    s_mov_b32 m0, 122880
    s_nop 0
    buffer_load_dwordx4 v5, s[28:31], s53 offen lds
    buffer_load_dwordx4 v6, s[28:31], s53 offen offset:1024 lds
    s_mov_b32 m0, 124928
    s_add_u32 s53, s53, 20480
    buffer_load_dwordx4 v5, s[28:31], s53 offen lds
    buffer_load_dwordx4 v6, s[28:31], s53 offen offset:1024 lds
    s_mov_b32 m0, 126976
    s_add_u32 s53, s53, 20480
    buffer_load_dwordx4 v5, s[28:31], s53 offen lds
    buffer_load_dwordx4 v6, s[28:31], s53 offen offset:1024 lds
    s_mov_b32 m0, 129024
    s_add_u32 s53, s53, 20480
    buffer_load_dwordx4 v5, s[28:31], s53 offen lds
    buffer_load_dwordx4 v6, s[28:31], s53 offen offset:1024 lds
    s_and_b32 s57, s46, 3
    s_add_u32 s57, s57, 20
    s_mul_i32 s53, s57, 81920
    s_mov_b32 m0, 0
    s_nop 0
    buffer_load_dwordx4 v5, s[28:31], s53 offen lds
    buffer_load_dwordx4 v6, s[28:31], s53 offen offset:1024 lds
    s_mov_b32 m0, 2048
    s_add_u32 s53, s53, 20480
    buffer_load_dwordx4 v5, s[28:31], s53 offen lds
    buffer_load_dwordx4 v6, s[28:31], s53 offen offset:1024 lds
    s_mov_b32 m0, 4096
    s_add_u32 s53, s53, 20480
    buffer_load_dwordx4 v5, s[28:31], s53 offen lds
    buffer_load_dwordx4 v6, s[28:31], s53 offen offset:1024 lds
    s_mov_b32 m0, 6144
    s_add_u32 s53, s53, 20480
    buffer_load_dwordx4 v5, s[28:31], s53 offen lds
    buffer_load_dwordx4 v6, s[28:31], s53 offen offset:1024 lds
    s_add_u32 s57, s57, 1
    s_cmp_eq_u32 s57, 24
    s_cselect_b32 s57, 20, s57
    s_mul_i32 s53, s57, 81920
    s_mov_b32 m0, 8192
    s_nop 0
    buffer_load_dwordx4 v5, s[28:31], s53 offen lds
    buffer_load_dwordx4 v6, s[28:31], s53 offen offset:1024 lds
    s_mov_b32 m0, 10240
    s_add_u32 s53, s53, 20480
    buffer_load_dwordx4 v5, s[28:31], s53 offen lds
    buffer_load_dwordx4 v6, s[28:31], s53 offen offset:1024 lds
    s_mov_b32 m0, 12288
    s_add_u32 s53, s53, 20480
    buffer_load_dwordx4 v5, s[28:31], s53 offen lds
    buffer_load_dwordx4 v6, s[28:31], s53 offen offset:1024 lds
    s_mov_b32 m0, 14336
    s_add_u32 s53, s53, 20480
    buffer_load_dwordx4 v5, s[28:31], s53 offen lds
    buffer_load_dwordx4 v6, s[28:31], s53 offen offset:1024 lds
    v_mov_b32 v15, 1
    s_waitcnt vmcnt(0)
    ds_write_b32 v14, v15 offset:20
    s_mov_b32 s51, 0
P2_sl_60:
    ds_read_b32 v17, v16 offset:0
    s_add_u32 s51, s51, 1
    s_waitcnt lgkmcnt(0)
    v_cmp_gt_u32 vcc, 8, v17
    s_cmp_ge_u32 s51, 0x1000000
    s_cbranch_scc1 P2_so_61
    s_cmp_eq_u64 vcc, 0
    s_cbranch_scc1 P2_so_61
    s_sleep 4
    s_branch P2_sl_60
P2_so_61:
    s_add_u32 s57, s57, 1
    s_cmp_eq_u32 s57, 24
    s_cselect_b32 s57, 20, s57
    s_mul_i32 s53, s57, 81920
    s_mov_b32 m0, 16384
    s_nop 0
    buffer_load_dwordx4 v5, s[28:31], s53 offen lds
    buffer_load_dwordx4 v6, s[28:31], s53 offen offset:1024 lds
    s_mov_b32 m0, 18432
    s_add_u32 s53, s53, 20480
    buffer_load_dwordx4 v5, s[28:31], s53 offen lds
    buffer_load_dwordx4 v6, s[28:31], s53 offen offset:1024 lds
    s_mov_b32 m0, 20480
    s_add_u32 s53, s53, 20480
    buffer_load_dwordx4 v5, s[28:31], s53 offen lds
    buffer_load_dwordx4 v6, s[28:31], s53 offen offset:1024 lds
    s_mov_b32 m0, 22528
    s_add_u32 s53, s53, 20480
    buffer_load_dwordx4 v5, s[28:31], s53 offen lds
    buffer_load_dwordx4 v6, s[28:31], s53 offen offset:1024 lds
    s_add_u32 s57, s57, 1
    s_cmp_eq_u32 s57, 24
    s_cselect_b32 s57, 20, s57
    s_mul_i32 s53, s57, 81920
    s_mov_b32 m0, 24576
    s_nop 0
    buffer_load_dwordx4 v5, s[28:31], s53 offen lds
    buffer_load_dwordx4 v6, s[28:31], s53 offen offset:1024 lds
    s_mov_b32 m0, 26624
    s_add_u32 s53, s53, 20480
    buffer_load_dwordx4 v5, s[28:31], s53 offen lds
    buffer_load_dwordx4 v6, s[28:31], s53 offen offset:1024 lds
    s_mov_b32 m0, 28672
    s_add_u32 s53, s53, 20480
    buffer_load_dwordx4 v5, s[28:31], s53 offen lds
    buffer_load_dwordx4 v6, s[28:31], s53 offen offset:1024 lds
    s_mov_b32 m0, 30720
    s_add_u32 s53, s53, 20480
    buffer_load_dwordx4 v5, s[28:31], s53 offen lds
    buffer_load_dwordx4 v6, s[28:31], s53 offen offset:1024 lds
    s_add_u32 s57, s46, 24
    s_mov_b32 s28, s10
    s_mov_b32 s29, s11
    s_mov_b32 s30, 819200
    s_mul_i32 s53, s57, 81920
    s_sub_u32 s53, s53, 1966080
    s_mov_b32 m0, 32768
    s_nop 0
    buffer_load_dwordx4 v5, s[28:31], s53 offen lds
    buffer_load_dwordx4 v6, s[28:31], s53 offen offset:1024 lds
    s_mov_b32 m0, 34816
    s_add_u32 s53, s53, 20480
    buffer_load_dwordx4 v5, s[28:31], s53 offen lds
    buffer_load_dwordx4 v6, s[28:31], s53 offen offset:1024 lds
    s_mov_b32 m0, 36864
    s_add_u32 s53, s53, 20480
    buffer_load_dwordx4 v5, s[28:31], s53 offen lds
    buffer_load_dwordx4 v6, s[28:31], s53 offen offset:1024 lds
    s_mov_b32 m0, 38912
    s_add_u32 s53, s53, 20480
    buffer_load_dwordx4 v5, s[28:31], s53 offen lds
    buffer_load_dwordx4 v6, s[28:31], s53 offen offset:1024 lds
    s_add_u32 s57, s57, 1
    s_cmp_eq_u32 s57, 34
    s_cselect_b32 s57, 24, s57
    s_mul_i32 s53, s57, 81920
    s_sub_u32 s53, s53, 1966080
    s_mov_b32 m0, 40960
    s_nop 0
    buffer_load_dwordx4 v5, s[28:31], s53 offen lds
    buffer_load_dwordx4 v6, s[28:31], s53 offen offset:1024 lds
    s_mov_b32 m0, 43008
    s_add_u32 s53, s53, 20480
    buffer_load_dwordx4 v5, s[28:31], s53 offen lds
    buffer_load_dwordx4 v6, s[28:31], s53 offen offset:1024 lds
    s_mov_b32 m0, 45056
    s_add_u32 s53, s53, 20480
    buffer_load_dwordx4 v5, s[28:31], s53 offen lds
    buffer_load_dwordx4 v6, s[28:31], s53 offen offset:1024 lds
    s_mov_b32 m0, 47104
    s_add_u32 s53, s53, 20480
    buffer_load_dwordx4 v5, s[28:31], s53 offen lds
    buffer_load_dwordx4 v6, s[28:31], s53 offen offset:1024 lds
    v_mov_b32 v15, 2
    s_waitcnt vmcnt(0)
    ds_write_b32 v14, v15 offset:20
    s_mov_b32 s51, 0
P2_sl_62:
    ds_read_b32 v17, v16 offset:0
    s_add_u32 s51, s51, 1
    s_waitcnt lgkmcnt(0)
    v_cmp_gt_u32 vcc, 12, v17
    s_cmp_ge_u32 s51, 0x1000000
    s_cbranch_scc1 P2_so_63
    s_cmp_eq_u64 vcc, 0
    s_cbranch_scc1 P2_so_63
    s_sleep 4
    s_branch P2_sl_62
P2_so_63:
    s_add_u32 s57, s57, 1
    s_cmp_eq_u32 s57, 34
    s_cselect_b32 s57, 24, s57
    s_mul_i32 s53, s57, 81920
    s_sub_u32 s53, s53, 1966080
    s_mov_b32 m0, 131072
    s_nop 0
    buffer_load_dwordx4 v5, s[28:31], s53 offen lds
    buffer_load_dwordx4 v6, s[28:31], s53 offen offset:1024 lds
    s_mov_b32 m0, 133120
    s_add_u32 s53, s53, 20480
    buffer_load_dwordx4 v5, s[28:31], s53 offen lds
    buffer_load_dwordx4 v6, s[28:31], s53 offen offset:1024 lds
    s_mov_b32 m0, 135168
    s_add_u32 s53, s53, 20480
    buffer_load_dwordx4 v5, s[28:31], s53 offen lds
    buffer_load_dwordx4 v6, s[28:31], s53 offen offset:1024 lds
    s_mov_b32 m0, 137216
    s_add_u32 s53, s53, 20480
    buffer_load_dwordx4 v5, s[28:31], s53 offen lds
    buffer_load_dwordx4 v6, s[28:31], s53 offen offset:1024 lds
    s_add_u32 s57, s57, 1
    s_cmp_eq_u32 s57, 34
    s_cselect_b32 s57, 24, s57
    s_mul_i32 s53, s57, 81920
    s_sub_u32 s53, s53, 1966080
    s_mov_b32 m0, 139264
    s_nop 0
    buffer_load_dwordx4 v5, s[28:31], s53 offen lds
    buffer_load_dwordx4 v6, s[28:31], s53 offen offset:1024 lds
    s_mov_b32 m0, 141312
    s_add_u32 s53, s53, 20480
    buffer_load_dwordx4 v5, s[28:31], s53 offen lds
    buffer_load_dwordx4 v6, s[28:31], s53 offen offset:1024 lds
    s_mov_b32 m0, 143360
    s_add_u32 s53, s53, 20480
    buffer_load_dwordx4 v5, s[28:31], s53 offen lds
    buffer_load_dwordx4 v6, s[28:31], s53 offen offset:1024 lds
    s_mov_b32 m0, 145408
    s_add_u32 s53, s53, 20480
    buffer_load_dwordx4 v5, s[28:31], s53 offen lds
    buffer_load_dwordx4 v6, s[28:31], s53 offen offset:1024 lds
    s_add_u32 s57, s57, 1
    s_cmp_eq_u32 s57, 34
    s_cselect_b32 s57, 24, s57
    s_mul_i32 s53, s57, 81920
    s_sub_u32 s53, s53, 1966080
    s_mov_b32 m0, 49152
    s_nop 0
    buffer_load_dwordx4 v5, s[28:31], s53 offen lds
    buffer_load_dwordx4 v6, s[28:31], s53 offen offset:1024 lds
    s_mov_b32 m0, 51200
    s_add_u32 s53, s53, 20480
    buffer_load_dwordx4 v5, s[28:31], s53 offen lds
    buffer_load_dwordx4 v6, s[28:31], s53 offen offset:1024 lds
    s_mov_b32 m0, 53248
    s_add_u32 s53, s53, 20480
    buffer_load_dwordx4 v5, s[28:31], s53 offen lds
    buffer_load_dwordx4 v6, s[28:31], s53 offen offset:1024 lds
    s_mov_b32 m0, 55296
    s_add_u32 s53, s53, 20480
    buffer_load_dwordx4 v5, s[28:31], s53 offen lds
    buffer_load_dwordx4 v6, s[28:31], s53 offen offset:1024 lds
    s_add_u32 s57, s57, 1
    s_cmp_eq_u32 s57, 34
    s_cselect_b32 s57, 24, s57
    s_mul_i32 s53, s57, 81920
    s_sub_u32 s53, s53, 1966080
    s_mov_b32 m0, 57344
    s_nop 0
    buffer_load_dwordx4 v5, s[28:31], s53 offen lds
    buffer_load_dwordx4 v6, s[28:31], s53 offen offset:1024 lds
    s_mov_b32 m0, 59392
    s_add_u32 s53, s53, 20480
    buffer_load_dwordx4 v5, s[28:31], s53 offen lds
    buffer_load_dwordx4 v6, s[28:31], s53 offen offset:1024 lds
    s_mov_b32 m0, 61440
    s_add_u32 s53, s53, 20480
    buffer_load_dwordx4 v5, s[28:31], s53 offen lds
    buffer_load_dwordx4 v6, s[28:31], s53 offen offset:1024 lds
    s_mov_b32 m0, 63488
    s_add_u32 s53, s53, 20480
    buffer_load_dwordx4 v5, s[28:31], s53 offen lds
    buffer_load_dwordx4 v6, s[28:31], s53 offen offset:1024 lds
    v_mov_b32 v15, 3
    s_waitcnt vmcnt(0)
    ds_write_b32 v14, v15 offset:20
    s_mov_b32 s51, 0
P2_sl_64:
    ds_read_b32 v17, v16 offset:0
    s_add_u32 s51, s51, 1
    s_waitcnt lgkmcnt(0)
    v_cmp_gt_u32 vcc, 16, v17
    s_cmp_ge_u32 s51, 0x1000000
    s_cbranch_scc1 P2_so_65
    s_cmp_eq_u64 vcc, 0
    s_cbranch_scc1 P2_so_65
    s_sleep 4
    s_branch P2_sl_64
P2_so_65:
    s_add_u32 s57, s57, 1
    s_cmp_eq_u32 s57, 34
    s_cselect_b32 s57, 24, s57
    s_mul_i32 s53, s57, 81920
    s_sub_u32 s53, s53, 1966080
    s_mov_b32 m0, 65536
    s_nop 0
    buffer_load_dwordx4 v5, s[28:31], s53 offen lds
    buffer_load_dwordx4 v6, s[28:31], s53 offen offset:1024 lds
    s_mov_b32 m0, 67584
    s_add_u32 s53, s53, 20480
    buffer_load_dwordx4 v5, s[28:31], s53 offen lds
    buffer_load_dwordx4 v6, s[28:31], s53 offen offset:1024 lds
    s_mov_b32 m0, 69632
    s_add_u32 s53, s53, 20480
    buffer_load_dwordx4 v5, s[28:31], s53 offen lds
    buffer_load_dwordx4 v6, s[28:31], s53 offen offset:1024 lds
    s_mov_b32 m0, 71680
    s_add_u32 s53, s53, 20480
    buffer_load_dwordx4 v5, s[28:31], s53 offen lds
    buffer_load_dwordx4 v6, s[28:31], s53 offen offset:1024 lds
    s_add_u32 s57, s57, 1
    s_cmp_eq_u32 s57, 34
    s_cselect_b32 s57, 24, s57
    s_mul_i32 s53, s57, 81920
    s_sub_u32 s53, s53, 1966080
    s_mov_b32 m0, 73728
    s_nop 0
    buffer_load_dwordx4 v5, s[28:31], s53 offen lds
    buffer_load_dwordx4 v6, s[28:31], s53 offen offset:1024 lds
    s_mov_b32 m0, 75776
    s_add_u32 s53, s53, 20480
    buffer_load_dwordx4 v5, s[28:31], s53 offen lds
    buffer_load_dwordx4 v6, s[28:31], s53 offen offset:1024 lds
    s_mov_b32 m0, 77824
    s_add_u32 s53, s53, 20480
    buffer_load_dwordx4 v5, s[28:31], s53 offen lds
    buffer_load_dwordx4 v6, s[28:31], s53 offen offset:1024 lds
    s_mov_b32 m0, 79872
    s_add_u32 s53, s53, 20480
    buffer_load_dwordx4 v5, s[28:31], s53 offen lds
    buffer_load_dwordx4 v6, s[28:31], s53 offen offset:1024 lds
    s_add_u32 s57, s57, 1
    s_cmp_eq_u32 s57, 34
    s_cselect_b32 s57, 24, s57
    s_mul_i32 s53, s57, 81920
    s_sub_u32 s53, s53, 1966080
    s_mov_b32 m0, 81920
    s_nop 0
    buffer_load_dwordx4 v5, s[28:31], s53 offen lds
    buffer_load_dwordx4 v6, s[28:31], s53 offen offset:1024 lds
    s_mov_b32 m0, 83968
    s_add_u32 s53, s53, 20480
    buffer_load_dwordx4 v5, s[28:31], s53 offen lds
    buffer_load_dwordx4 v6, s[28:31], s53 offen offset:1024 lds
    s_mov_b32 m0, 86016
    s_add_u32 s53, s53, 20480
    buffer_load_dwordx4 v5, s[28:31], s53 offen lds
    buffer_load_dwordx4 v6, s[28:31], s53 offen offset:1024 lds
    s_mov_b32 m0, 88064
    s_add_u32 s53, s53, 20480
    buffer_load_dwordx4 v5, s[28:31], s53 offen lds
    buffer_load_dwordx4 v6, s[28:31], s53 offen offset:1024 lds
    s_add_u32 s57, s57, 1
    s_cmp_eq_u32 s57, 34
    s_cselect_b32 s57, 24, s57
    s_mul_i32 s53, s57, 81920
    s_sub_u32 s53, s53, 1966080
    s_mov_b32 m0, 90112
    s_nop 0
    buffer_load_dwordx4 v5, s[28:31], s53 offen lds
    buffer_load_dwordx4 v6, s[28:31], s53 offen offset:1024 lds
    s_mov_b32 m0, 92160
    s_add_u32 s53, s53, 20480
    buffer_load_dwordx4 v5, s[28:31], s53 offen lds
    buffer_load_dwordx4 v6, s[28:31], s53 offen offset:1024 lds
    s_mov_b32 m0, 94208
    s_add_u32 s53, s53, 20480
    buffer_load_dwordx4 v5, s[28:31], s53 offen lds
    buffer_load_dwordx4 v6, s[28:31], s53 offen offset:1024 lds
    s_mov_b32 m0, 96256
    s_add_u32 s53, s53, 20480
    buffer_load_dwordx4 v5, s[28:31], s53 offen lds
    buffer_load_dwordx4 v6, s[28:31], s53 offen offset:1024 lds
    v_mov_b32 v15, 4
    s_waitcnt vmcnt(0)
    ds_write_b32 v14, v15 offset:20
    s_mov_b32 s51, 0
P2_sl_66:
    ds_read_b32 v17, v16 offset:0
    s_add_u32 s51, s51, 1
    s_waitcnt lgkmcnt(0)
    v_cmp_gt_u32 vcc, 18, v17
    s_cmp_ge_u32 s51, 0x1000000
    s_cbranch_scc1 P2_so_67
    s_cmp_eq_u64 vcc, 0
    s_cbranch_scc1 P2_so_67
    s_sleep 4
    s_branch P2_sl_66
P2_so_67:
    v_xor_b32 v8, v7, v9
    v_lshlrev_b32 v8, 4, v8
    s_movk_i32 s50, 1280
    v_mad_u32_u24 v8, v7, s50, v8
    s_mul_i32 s50, s45, 20480
    s_lshl_b32 s53, s46, 7
    s_add_u32 s50, s50, s53
    s_mov_b32 s36, s4
    s_mov_b32 s37, s5
    s_mul_i32 s38, s43, 327680
    s_mov_b32 m0, 98304
    s_nop 0
    buffer_load_dwordx4 v8, s[36:39], s50 offen lds
    s_mov_b32 m0, 99328
    s_add_u32 s50, s50, 10240
    buffer_load_dwordx4 v8, s[36:39], s50 offen lds
    s_mov_b32 m0, 100352
    s_add_u32 s50, s50, 10240
    buffer_load_dwordx4 v8, s[36:39], s50 offen lds
    s_mov_b32 m0, 101376
    s_add_u32 s50, s50, 10240
    buffer_load_dwordx4 v8, s[36:39], s50 offen lds
    s_mov_b32 m0, 102400
    s_add_u32 s50, s50, 10240
    buffer_load_dwordx4 v8, s[36:39], s50 offen lds
    s_mov_b32 m0, 103424
    s_add_u32 s50, s50, 10240
    buffer_load_dwordx4 v8, s[36:39], s50 offen lds
    s_mov_b32 m0, 104448
    s_add_u32 s50, s50, 10240
    buffer_load_dwordx4 v8, s[36:39], s50 offen lds
    s_mov_b32 m0, 105472
    s_add_u32 s50, s50, 10240
    buffer_load_dwordx4 v8, s[36:39], s50 offen lds
    s_mov_b32 m0, 106496
    s_add_u32 s50, s50, 10240
    buffer_load_dwordx4 v8, s[36:39], s50 offen lds
    s_mov_b32 m0, 107520
    s_add_u32 s50, s50, 10240
    buffer_load_dwordx4 v8, s[36:39], s50 offen lds
    s_mov_b32 m0, 108544
    s_add_u32 s50, s50, 10240
    buffer_load_dwordx4 v8, s[36:39], s50 offen lds
    s_mov_b32 m0, 109568
    s_add_u32 s50, s50, 10240
    buffer_load_dwordx4 v8, s[36:39], s50 offen lds
    v_mov_b32 v15, 5
    s_waitcnt vmcnt(0)
    ds_write_b32 v14, v15 offset:20
    s_waitcnt lgkmcnt(0)
P2_exit:
    s_endpgm
K1_done:
    s_endpgm
.section .rodata,"a"
.p2align 6
.amdhsa_kernel parallel_sum__linear_kernel_hedgehog__glu_gated_glu__prompt_kernel
  .amdhsa_next_free_vgpr 168
  .amdhsa_next_free_sgpr 64
  .amdhsa_accum_offset 168
  .amdhsa_group_segment_fixed_size 0
  .amdhsa_kernarg_size 88
  .amdhsa_user_sgpr_count 2
  .amdhsa_user_sgpr_kernarg_segment_ptr 1
  .amdhsa_system_sgpr_workgroup_id_x 1
.end_amdhsa_kernel
```
